```python
import torch

def _softmax(x, axis=-1):
    return torch.softmax(x, dim=axis)
def _gelu(x):
    return torch.nn.functional.gelu(x, approximate="tanh")
def _silu(x):
    return torch.nn.functional.silu(x)
def _sigmoid(x):
    return torch.sigmoid(x)
def _layernorm(x, axis=-1, eps=1e-5):
    m = x.mean(dim=axis, keepdim=True)
    v = x.var(dim=axis, keepdim=True, unbiased=False)
    return (x - m) / torch.sqrt(v + eps)
def _scatter_add(tgt, idx, src, axis=0):
    return tgt.clone().index_add_(axis, idx, src)
def _segment_sum(src, seg, n):
    out = torch.zeros((n,) + src.shape[1:], dtype=src.dtype)
    return out.index_add_(0, seg, src)
def _pad(x, pw):
    flat = tuple(v for pair in reversed(pw) for v in pair)
    return torch.nn.functional.pad(x, flat)

kernel_name = 'parallel_sum__grouped_kv_mqa__mixer_token_mlp__prompt'

def setup_inputs():

    _w = (lambda a: (lambda t: t.to(torch.bfloat16) if t.is_floating_point() else t)(torch.as_tensor(a)))
    def _A_setup():
        B, S, D, H = 1, 2048, 640, 32
        Dh = D // H
        return {
            "x": _w((lambda *s: torch.randn(*s, dtype=torch.bfloat16) * 0.05)(B, S, D)),
            "wq": _w((lambda *s: torch.randn(*s, dtype=torch.bfloat16) * 0.05)(D, H * Dh)),
            "wk": _w((lambda *s: torch.randn(*s, dtype=torch.bfloat16) * 0.05)(D, Dh)),
            "wv": _w((lambda *s: torch.randn(*s, dtype=torch.bfloat16) * 0.05)(D, Dh)),
            "wo": _w((lambda *s: torch.randn(*s, dtype=torch.bfloat16) * 0.05)(H * Dh, D)),
        }
    _A_in = _A_setup()

    def _B_setup():
        B, S, D, F = 1, 2048, 640, 1728
        return {
            "x": _w((lambda *s: torch.randn(*s, dtype=torch.bfloat16) * 0.05)(B, S, D)),
            "w1": _w((lambda *s: torch.randn(*s, dtype=torch.bfloat16) * 1.6)(S, F) * (S ** -0.5)),
            "b1": _w((lambda *s: torch.randn(*s, dtype=torch.bfloat16) * 12.8)(F) * 0.02),
            "w2": _w((lambda *s: torch.randn(*s, dtype=torch.bfloat16) * 0.8)(F, S) * (F ** -0.5)),
            "b2": _w((lambda *s: torch.randn(*s, dtype=torch.bfloat16) * 12.8)(S) * 0.02),
        }
    _B_in = _B_setup()

    return {
        "A_x": _A_in["x"],
        "A_wq": _A_in["wq"],
        "A_wk": _A_in["wk"],
        "A_wv": _A_in["wv"],
        "A_wo": _A_in["wo"],
        "B_x": _B_in["x"],
        "B_w1": _B_in["w1"],
        "B_b1": _B_in["b1"],
        "B_w2": _B_in["w2"],
        "B_b2": _B_in["b2"],
    }

def reference(A_x, A_wq, A_wk, A_wv, A_wo, B_x, B_w1, B_b1, B_w2, B_b2):
    def _A_ref(x, wq, wk, wv, wo):
        B, S, D = x.shape
        H = 32
        Dh = D // H
        q = (lambda x, *d: x.permute(*d))((x @ wq).reshape(B, S, H, Dh), 0, 2, 1, 3)
        k = x @ wk
        v = x @ wv
        scores = torch.einsum("bhqd,bkd->bhqk", q, k) * (Dh ** -0.5)
        p = _softmax(scores, axis=-1)
        o = torch.einsum("bhqk,bkd->bhqd", p, v)
        return (lambda x, *d: x.permute(*d))(o, 0, 2, 1, 3).reshape(B, S, H * Dh) @ wo

    def _B_ref(x, w1, b1, w2, b2):
        B, S, D = x.shape
        h = _layernorm(x, axis=-1)
        u = torch.einsum("bsd,sf->bdf", h, w1) + b1
        u = _gelu(u)
        y = torch.einsum("bdf,fs->bds", u, w2) + b2
        return (lambda x, *d: x.permute(*d))(y, 0, 2, 1)

    x = A_x
    xn = _layernorm(x, axis=-1)
    return x + _A_ref(xn, A_wq, A_wk, A_wv, A_wo) + _B_ref(xn, B_w1, B_b1, B_w2, B_b2)
```

```asm
; @launch grid=(256,1,1) block=(576,1,1) lds=163840
.amdgcn_target "amdgcn-amd-amdhsa--gfx950"
.text
.globl parallel_sum__grouped_kv_mqa__mixer_token_mlp__prompt_kernel
.p2align 8
.type parallel_sum__grouped_kv_mqa__mixer_token_mlp__prompt_kernel,@function
parallel_sum__grouped_kv_mqa__mixer_token_mlp__prompt_kernel:
    s_cmp_ge_u32 s2, 256
    s_cbranch_scc1 parallel_sum__grouped_kv_mqa__mixer_token_mlp__prompt_kernel_end
    s_load_dwordx4 s[56:59], s[0:1], 0
    s_load_dwordx2 s[4:5], s[0:1], 96
    s_load_dwordx4 s[80:83], s[0:1], 16
    s_load_dwordx4 s[40:43], s[0:1], 48
    s_load_dwordx2 s[44:45], s[0:1], 32
    s_load_dwordx2 s[76:77], s[0:1], 64
    s_load_dwordx4 s[72:75], s[0:1], 72
    s_load_dwordx2 s[78:79], s[0:1], 88
    s_getpc_b64 s[20:21]
    s_lshr_b32 s7, s2, 3
    s_lshl_b32 s7, s7, 7
    v_lshl_add_u32 v1, v0, 12, s7
    v_cmp_gt_u32 vcc, code_end-parallel_sum__grouped_kv_mqa__mixer_token_mlp__prompt_kernel-128, v1
    s_nop 0
    s_and_saveexec_b64 s[22:23], vcc
    s_cbranch_execz parallel_sum__grouped_kv_mqa__mixer_token_mlp__prompt_kernel_npc
    global_load_dword v167, v1, s[20:21]
parallel_sum__grouped_kv_mqa__mixer_token_mlp__prompt_kernel_npc:
    s_mov_b64 exec, s[22:23]
    v_lshrrev_b32 v1, 6, v0
    s_and_b32 s46, s2, 7
    v_readfirstlane_b32 s6, v1
    s_bfe_u32 s47, s2, 0x20003
    s_lshr_b32 s49, s2, 5
    s_lshl_b32 s7, s46, 3
    s_add_u32 s49, s49, s7
    s_lshr_b32 s48, s49, 1
    s_mov_b32 s60, 0x3f803f80
    s_mov_b32 s61, 0x3acccccd
    s_mov_b32 s62, 0x3727c5ac
    s_mov_b32 s70, s6
    s_cmp_eq_u32 s6, 8
    s_cbranch_scc1 parallel_sum__grouped_kv_mqa__mixer_token_mlp__prompt_kernel_w8
    s_cmp_ge_u32 s6, 4
    s_cbranch_scc1 parallel_sum__grouped_kv_mqa__mixer_token_mlp__prompt_kernel_stg
    s_setprio 2
    v_bfe_u32 v8, v0, 3, 3
    v_and_b32 v9, 7, v0
    v_mul_u32_u24 v8, 1280, v8
    v_lshl_add_u32 v8, v9, 4, v8
    s_lshl_b32 s7, s49, 2
    s_add_u32 s7, s7, s6
    s_mul_i32 s20, s7, 10240
    s_waitcnt lgkmcnt(0)
    s_mov_b32 s12, s56
    s_and_b32 s13, s57, 0xffff
    s_mov_b32 s14, 2621440
    s_mov_b32 s15, 0x20000
    buffer_load_dwordx4 v[64:67], v8, s[12:15], s20 offen offset:0
    buffer_load_dwordx4 v[68:71], v8, s[12:15], s20 offen offset:128
    buffer_load_dwordx4 v[72:75], v8, s[12:15], s20 offen offset:256
    buffer_load_dwordx4 v[76:79], v8, s[12:15], s20 offen offset:384
    buffer_load_dwordx4 v[80:83], v8, s[12:15], s20 offen offset:512
    buffer_load_dwordx4 v[84:87], v8, s[12:15], s20 offen offset:640
    buffer_load_dwordx4 v[88:91], v8, s[12:15], s20 offen offset:768
    buffer_load_dwordx4 v[92:95], v8, s[12:15], s20 offen offset:896
    buffer_load_dwordx4 v[96:99], v8, s[12:15], s20 offen offset:1024
    buffer_load_dwordx4 v[100:103], v8, s[12:15], s20 offen offset:1152
    s_barrier
    s_branch parallel_sum__grouped_kv_mqa__mixer_token_mlp__prompt_kernel_lnr
parallel_sum__grouped_kv_mqa__mixer_token_mlp__prompt_kernel_w8:
    s_setprio 3
    v_and_b32 v1, 63, v0
    v_lshlrev_b32 v2, 2, v1
    v_add_u32 v2, 162816, v2
    v_mov_b32 v4, 0
    v_mov_b32 v5, 0
    v_mov_b32 v6, 0
    v_mov_b32 v7, 0
    ds_write_b32 v2, v4
    v_lshlrev_b32 v1, 4, v1
    s_waitcnt lgkmcnt(0)
    s_barrier
    s_branch parallel_sum__grouped_kv_mqa__mixer_token_mlp__prompt_kernel_w8r
parallel_sum__grouped_kv_mqa__mixer_token_mlp__prompt_kernel_stg:
    s_sub_u32 s6, s6, 4
    v_and_b32 v1, 63, v0
    v_add_u32 v2, 0, v1
    v_mul_u32_u24 v3, 3277, v2
    v_lshrrev_b32 v3, 16, v3
    v_mul_u32_u24 v3, 960, v3
    v_lshl_add_u32 v8, v2, 4, v3
    v_add_u32 v2, 64, v1
    v_mul_u32_u24 v3, 3277, v2
    v_lshrrev_b32 v3, 16, v3
    v_mul_u32_u24 v3, 960, v3
    v_lshl_add_u32 v9, v2, 4, v3
    v_subrev_u32 v9, 1024, v9
    v_add_u32 v2, 128, v1
    v_mul_u32_u24 v3, 3277, v2
    v_lshrrev_b32 v3, 16, v3
    v_mul_u32_u24 v3, 960, v3
    v_lshl_add_u32 v10, v2, 4, v3
    v_subrev_u32 v10, 2048, v10
    v_add_u32 v2, 192, v1
    v_mul_u32_u24 v3, 3277, v2
    v_lshrrev_b32 v3, 16, v3
    v_mul_u32_u24 v3, 960, v3
    v_lshl_add_u32 v11, v2, 4, v3
    v_subrev_u32 v11, 3072, v11
    v_add_u32 v2, 256, v1
    v_mul_u32_u24 v3, 3277, v2
    v_lshrrev_b32 v3, 16, v3
    v_mul_u32_u24 v3, 960, v3
    v_lshl_add_u32 v12, v2, 4, v3
    s_mul_i32 s20, s6, 20480
    s_mul_i32 s7, s47, 320
    s_add_u32 s20, s20, s7
    s_mul_i32 s21, s6, 5120
    s_add_u32 s21, s21, 80384
    v_mov_b32 v1, 162816
    v_mov_b32 v2, 1
    s_waitcnt lgkmcnt(0)
    s_mov_b32 s12, s58
    s_and_b32 s13, s59, 0xffff
    s_mov_b32 s14, 819200
    s_mov_b32 s15, 0x20000
    s_add_u32 s6, s6, 3
    s_and_b32 s6, s6, 3
    s_mul_i32 s20, s6, 81920
    s_mul_i32 s7, s47, 320
    s_add_u32 s20, s20, s7
    s_mul_i32 s21, s6, 20480
    s_add_u32 s21, s21, 80384
    s_lshl_b32 s7, s6, 2
    v_add_u32 v1, s7, v1
    s_barrier
    s_add_u32 m0, s21, 0
    s_nop 0
    buffer_load_dwordx4 v8, s[12:15], s20 offen offset:0 lds
    buffer_load_dwordx4 v9, s[12:15], s20 offen offset:1024 lds
    buffer_load_dwordx4 v10, s[12:15], s20 offen offset:2048 lds
    buffer_load_dwordx4 v11, s[12:15], s20 offen offset:3072 lds
    s_add_u32 m0, s21, 4096
    s_nop 0
    buffer_load_dwordx4 v12, s[12:15], s20 offen lds
    s_add_u32 s20, s20, 20480
    s_add_u32 m0, s21, 5120
    s_nop 0
    buffer_load_dwordx4 v8, s[12:15], s20 offen offset:0 lds
    buffer_load_dwordx4 v9, s[12:15], s20 offen offset:1024 lds
    buffer_load_dwordx4 v10, s[12:15], s20 offen offset:2048 lds
    buffer_load_dwordx4 v11, s[12:15], s20 offen offset:3072 lds
    s_add_u32 m0, s21, 9216
    s_nop 0
    buffer_load_dwordx4 v12, s[12:15], s20 offen lds
    s_add_u32 s20, s20, 20480
    s_add_u32 m0, s21, 10240
    s_nop 0
    buffer_load_dwordx4 v8, s[12:15], s20 offen offset:0 lds
    buffer_load_dwordx4 v9, s[12:15], s20 offen offset:1024 lds
    buffer_load_dwordx4 v10, s[12:15], s20 offen offset:2048 lds
    buffer_load_dwordx4 v11, s[12:15], s20 offen offset:3072 lds
    s_add_u32 m0, s21, 14336
    s_nop 0
    buffer_load_dwordx4 v12, s[12:15], s20 offen lds
    s_add_u32 s20, s20, 20480
    s_add_u32 m0, s21, 15360
    s_nop 0
    buffer_load_dwordx4 v8, s[12:15], s20 offen offset:0 lds
    buffer_load_dwordx4 v9, s[12:15], s20 offen offset:1024 lds
    buffer_load_dwordx4 v10, s[12:15], s20 offen offset:2048 lds
    buffer_load_dwordx4 v11, s[12:15], s20 offen offset:3072 lds
    s_add_u32 m0, s21, 19456
    s_nop 0
    buffer_load_dwordx4 v12, s[12:15], s20 offen lds
    s_add_u32 s20, s20, 20480
    s_add_u32 s20, s20, 245760
    s_waitcnt vmcnt(0)
    s_mov_b64 exec, 1
    ds_add_u32 v1, v2 offset:40
    s_mov_b64 exec, -1
parallel_sum__grouped_kv_mqa__mixer_token_mlp__prompt_kernel_lw12:
    ds_read_b32 v3, v1 offset:80
    s_waitcnt lgkmcnt(0)
    v_cmp_gt_u32 s[84:85], 4, v3
    s_nop 1
    s_cmp_eq_u64 s[84:85], 0
    s_cbranch_scc0 parallel_sum__grouped_kv_mqa__mixer_token_mlp__prompt_kernel_lx12
    s_add_u32 m0, s21, 0
    s_nop 0
    buffer_load_dwordx4 v8, s[12:15], s20 offen offset:0 lds
    buffer_load_dwordx4 v9, s[12:15], s20 offen offset:1024 lds
    buffer_load_dwordx4 v10, s[12:15], s20 offen offset:2048 lds
    buffer_load_dwordx4 v11, s[12:15], s20 offen offset:3072 lds
    s_add_u32 m0, s21, 4096
    s_nop 0
    buffer_load_dwordx4 v12, s[12:15], s20 offen lds
    s_add_u32 s20, s20, 20480
    s_add_u32 m0, s21, 5120
    s_nop 0
    buffer_load_dwordx4 v8, s[12:15], s20 offen offset:0 lds
    buffer_load_dwordx4 v9, s[12:15], s20 offen offset:1024 lds
    buffer_load_dwordx4 v10, s[12:15], s20 offen offset:2048 lds
    buffer_load_dwordx4 v11, s[12:15], s20 offen offset:3072 lds
    s_add_u32 m0, s21, 9216
    s_nop 0
    buffer_load_dwordx4 v12, s[12:15], s20 offen lds
    s_add_u32 s20, s20, 20480
    s_add_u32 m0, s21, 10240
    s_nop 0
    buffer_load_dwordx4 v8, s[12:15], s20 offen offset:0 lds
    buffer_load_dwordx4 v9, s[12:15], s20 offen offset:1024 lds
    buffer_load_dwordx4 v10, s[12:15], s20 offen offset:2048 lds
    buffer_load_dwordx4 v11, s[12:15], s20 offen offset:3072 lds
    s_add_u32 m0, s21, 14336
    s_nop 0
    buffer_load_dwordx4 v12, s[12:15], s20 offen lds
    s_add_u32 s20, s20, 20480
    s_add_u32 m0, s21, 15360
    s_nop 0
    buffer_load_dwordx4 v8, s[12:15], s20 offen offset:0 lds
    buffer_load_dwordx4 v9, s[12:15], s20 offen offset:1024 lds
    buffer_load_dwordx4 v10, s[12:15], s20 offen offset:2048 lds
    buffer_load_dwordx4 v11, s[12:15], s20 offen offset:3072 lds
    s_add_u32 m0, s21, 19456
    s_nop 0
    buffer_load_dwordx4 v12, s[12:15], s20 offen lds
    s_add_u32 s20, s20, 20480
    s_add_u32 s20, s20, 245760
    s_waitcnt vmcnt(0)
    s_mov_b64 exec, 1
    ds_add_u32 v1, v2 offset:56
    s_mov_b64 exec, -1
    s_cmp_ge_u32 s6, 2
    s_cbranch_scc1 parallel_sum__grouped_kv_mqa__mixer_token_mlp__prompt_kernel_g
parallel_sum__grouped_kv_mqa__mixer_token_mlp__prompt_kernel_lw13:
    ds_read_b32 v3, v1 offset:96
    s_waitcnt lgkmcnt(0)
    v_cmp_gt_u32 s[84:85], 4, v3
    s_nop 1
    s_cmp_eq_u64 s[84:85], 0
    s_cbranch_scc0 parallel_sum__grouped_kv_mqa__mixer_token_mlp__prompt_kernel_lx13
    s_add_u32 m0, s21, 0
    s_nop 0
    buffer_load_dwordx4 v8, s[12:15], s20 offen offset:0 lds
    buffer_load_dwordx4 v9, s[12:15], s20 offen offset:1024 lds
    buffer_load_dwordx4 v10, s[12:15], s20 offen offset:2048 lds
    buffer_load_dwordx4 v11, s[12:15], s20 offen offset:3072 lds
    s_add_u32 m0, s21, 4096
    s_nop 0
    buffer_load_dwordx4 v12, s[12:15], s20 offen lds
    s_add_u32 s20, s20, 20480
    s_add_u32 m0, s21, 5120
    s_nop 0
    buffer_load_dwordx4 v8, s[12:15], s20 offen offset:0 lds
    buffer_load_dwordx4 v9, s[12:15], s20 offen offset:1024 lds
    buffer_load_dwordx4 v10, s[12:15], s20 offen offset:2048 lds
    buffer_load_dwordx4 v11, s[12:15], s20 offen offset:3072 lds
    s_add_u32 m0, s21, 9216
    s_nop 0
    buffer_load_dwordx4 v12, s[12:15], s20 offen lds
    s_add_u32 s20, s20, 20480
    s_add_u32 m0, s21, 10240
    s_nop 0
    buffer_load_dwordx4 v8, s[12:15], s20 offen offset:0 lds
    buffer_load_dwordx4 v9, s[12:15], s20 offen offset:1024 lds
    buffer_load_dwordx4 v10, s[12:15], s20 offen offset:2048 lds
    buffer_load_dwordx4 v11, s[12:15], s20 offen offset:3072 lds
    s_add_u32 m0, s21, 14336
    s_nop 0
    buffer_load_dwordx4 v12, s[12:15], s20 offen lds
    s_add_u32 s20, s20, 20480
    s_add_u32 m0, s21, 15360
    s_nop 0
    buffer_load_dwordx4 v8, s[12:15], s20 offen offset:0 lds
    buffer_load_dwordx4 v9, s[12:15], s20 offen offset:1024 lds
    buffer_load_dwordx4 v10, s[12:15], s20 offen offset:2048 lds
    buffer_load_dwordx4 v11, s[12:15], s20 offen offset:3072 lds
    s_add_u32 m0, s21, 19456
    s_nop 0
    buffer_load_dwordx4 v12, s[12:15], s20 offen lds
    s_add_u32 s20, s20, 20480
    s_add_u32 s20, s20, 245760
    s_waitcnt vmcnt(0)
    s_mov_b64 exec, 1
    ds_add_u32 v1, v2 offset:72
    s_mov_b64 exec, -1
    s_branch parallel_sum__grouped_kv_mqa__mixer_token_mlp__prompt_kernel_g
parallel_sum__grouped_kv_mqa__mixer_token_mlp__prompt_kernel_lnr:
    v_and_b32 v4, 63, v0
    v_mov_b32 v147, 162816
    v_mov_b32 v145, 1
    v_lshlrev_b32 v1, 4, v4
    s_mov_b32 s8, s4
    s_and_b32 s9, s5, 0xffff
    s_mov_b32 s10, 16617472
    s_mov_b32 s11, 0x20000
    v_and_b32 v5, 31, v0
    v_bfe_u32 v6, v0, 5, 1
    s_bfe_u32 s12, s2, 0x20003
    s_lshl_b32 s12, s12, 2
    s_add_u32 s12, s12, s6
    s_and_b32 s13, s2, 7
    s_lshl_b32 s13, s13, 3
    s_lshr_b32 s14, s2, 5
    s_add_u32 s13, s13, s14
    s_mul_i32 s18, s12, 163840
    s_lshl_b32 s13, s13, 9
    s_add_u32 s18, s18, s13
    s_add_u32 s18, s18, 7671808
    v_min_u32 v2, 27, v5
    v_lshlrev_b32 v2, 4, v2
    v_mul_u32_u24 v133, 448, v6
    v_add_u32 v2, v2, v133
    v_add_u32 v2, 1280, v2
    v_lshlrev_b32 v3, 3, v5
    v_add_u32 v3, 1024, v3
    v_cmp_eq_u32 s[22:23], 1, v6
    v_mov_b32 v133, 1696
    v_lshlrev_b32 v7, 4, v5
    v_cndmask_b32_e64 v3, v3, v133, s[22:23]
    v_lshl_add_u32 v7, v6, 15, v7
    v_bfe_u32 v8, v0, 3, 3
    s_lshl_b32 s7, s6, 3
    v_add_u32 v8, s7, v8
    v_and_b32 v9, 7, v0
    v_and_b32 v22, 15, v8
    v_xor_b32 v9, v9, v22
    v_mul_u32_u24 v8, 1280, v8
    v_add_u32 v8, 39424, v8
    v_lshl_add_u32 v22, v9, 4, v8
    v_xor_b32 v9, 8, v9
    v_lshl_add_u32 v23, v9, 4, v8
    v_and_b32 v8, 31, v0
    v_bfe_u32 v9, v0, 5, 1
    v_and_b32 v10, 15, v0
    v_xor_b32 v9, v9, v10
    v_mul_u32_u24 v8, 1280, v8
    v_add_u32 v8, 39424, v8
    v_xor_b32 v24, 0, v9
    v_lshl_add_u32 v24, v24, 4, v8
    v_xor_b32 v25, 2, v9
    v_lshl_add_u32 v25, v25, 4, v8
    v_xor_b32 v26, 4, v9
    v_lshl_add_u32 v26, v26, 4, v8
    v_xor_b32 v27, 6, v9
    v_lshl_add_u32 v27, v27, 4, v8
    v_xor_b32 v28, 8, v9
    v_lshl_add_u32 v28, v28, 4, v8
    v_xor_b32 v29, 10, v9
    v_lshl_add_u32 v29, v29, 4, v8
    v_xor_b32 v30, 12, v9
    v_lshl_add_u32 v30, v30, 4, v8
    v_xor_b32 v31, 14, v9
    v_lshl_add_u32 v31, v31, 4, v8
    v_bfe_u32 v8, v0, 2, 2
    v_bfe_u32 v9, v0, 5, 1
    v_lshl_add_u32 v8, v9, 3, v8
    v_mul_u32_u24 v20, 320, v8
    v_bfe_u32 v8, v0, 4, 1
    v_lshl_add_u32 v20, v8, 5, v20
    v_and_b32 v8, 3, v0
    v_lshl_add_u32 v20, v8, 3, v20
    s_mul_i32 s7, s6, 80
    s_add_u32 s7, s7, 80384
    v_add_u32 v20, s7, v20
    v_add_u32 v21, 61440, v20
    v_mov_b32 v136, 0
    v_mov_b32 v137, 0
    v_mov_b32 v138, 0
    v_mov_b32 v139, 0
    s_waitcnt vmcnt(9)
    v_dot2_f32_bf16 v136, v64, s60, v136
    v_dot2_f32_bf16 v138, v64, v64, v138
    v_dot2_f32_bf16 v137, v65, s60, v137
    v_dot2_f32_bf16 v139, v65, v65, v139
    v_dot2_f32_bf16 v136, v66, s60, v136
    v_dot2_f32_bf16 v138, v66, v66, v138
    v_dot2_f32_bf16 v137, v67, s60, v137
    v_dot2_f32_bf16 v139, v67, v67, v139
    s_waitcnt vmcnt(8)
    v_dot2_f32_bf16 v136, v68, s60, v136
    v_dot2_f32_bf16 v138, v68, v68, v138
    v_dot2_f32_bf16 v137, v69, s60, v137
    v_dot2_f32_bf16 v139, v69, v69, v139
    v_dot2_f32_bf16 v136, v70, s60, v136
    v_dot2_f32_bf16 v138, v70, v70, v138
    v_dot2_f32_bf16 v137, v71, s60, v137
    v_dot2_f32_bf16 v139, v71, v71, v139
    s_waitcnt vmcnt(7)
    v_dot2_f32_bf16 v136, v72, s60, v136
    v_dot2_f32_bf16 v138, v72, v72, v138
    v_dot2_f32_bf16 v137, v73, s60, v137
    v_dot2_f32_bf16 v139, v73, v73, v139
    v_dot2_f32_bf16 v136, v74, s60, v136
    v_dot2_f32_bf16 v138, v74, v74, v138
    v_dot2_f32_bf16 v137, v75, s60, v137
    v_dot2_f32_bf16 v139, v75, v75, v139
    s_waitcnt vmcnt(6)
    v_dot2_f32_bf16 v136, v76, s60, v136
    v_dot2_f32_bf16 v138, v76, v76, v138
    v_dot2_f32_bf16 v137, v77, s60, v137
    v_dot2_f32_bf16 v139, v77, v77, v139
    v_dot2_f32_bf16 v136, v78, s60, v136
    v_dot2_f32_bf16 v138, v78, v78, v138
    v_dot2_f32_bf16 v137, v79, s60, v137
    v_dot2_f32_bf16 v139, v79, v79, v139
    s_waitcnt vmcnt(5)
    v_dot2_f32_bf16 v136, v80, s60, v136
    v_dot2_f32_bf16 v138, v80, v80, v138
    v_dot2_f32_bf16 v137, v81, s60, v137
    v_dot2_f32_bf16 v139, v81, v81, v139
    v_dot2_f32_bf16 v136, v82, s60, v136
    v_dot2_f32_bf16 v138, v82, v82, v138
    v_dot2_f32_bf16 v137, v83, s60, v137
    v_dot2_f32_bf16 v139, v83, v83, v139
    s_waitcnt vmcnt(4)
    v_dot2_f32_bf16 v136, v84, s60, v136
    v_dot2_f32_bf16 v138, v84, v84, v138
    v_dot2_f32_bf16 v137, v85, s60, v137
    v_dot2_f32_bf16 v139, v85, v85, v139
    v_dot2_f32_bf16 v136, v86, s60, v136
    v_dot2_f32_bf16 v138, v86, v86, v138
    v_dot2_f32_bf16 v137, v87, s60, v137
    v_dot2_f32_bf16 v139, v87, v87, v139
    s_waitcnt vmcnt(3)
    v_dot2_f32_bf16 v136, v88, s60, v136
    v_dot2_f32_bf16 v138, v88, v88, v138
    v_dot2_f32_bf16 v137, v89, s60, v137
    v_dot2_f32_bf16 v139, v89, v89, v139
    v_dot2_f32_bf16 v136, v90, s60, v136
    v_dot2_f32_bf16 v138, v90, v90, v138
    v_dot2_f32_bf16 v137, v91, s60, v137
    v_dot2_f32_bf16 v139, v91, v91, v139
    s_waitcnt vmcnt(2)
    v_dot2_f32_bf16 v136, v92, s60, v136
    v_dot2_f32_bf16 v138, v92, v92, v138
    v_dot2_f32_bf16 v137, v93, s60, v137
    v_dot2_f32_bf16 v139, v93, v93, v139
    v_dot2_f32_bf16 v136, v94, s60, v136
    v_dot2_f32_bf16 v138, v94, v94, v138
    v_dot2_f32_bf16 v137, v95, s60, v137
    v_dot2_f32_bf16 v139, v95, v95, v139
    s_waitcnt vmcnt(1)
    v_dot2_f32_bf16 v136, v96, s60, v136
    v_dot2_f32_bf16 v138, v96, v96, v138
    v_dot2_f32_bf16 v137, v97, s60, v137
    v_dot2_f32_bf16 v139, v97, v97, v139
    v_dot2_f32_bf16 v136, v98, s60, v136
    v_dot2_f32_bf16 v138, v98, v98, v138
    v_dot2_f32_bf16 v137, v99, s60, v137
    v_dot2_f32_bf16 v139, v99, v99, v139
    s_waitcnt vmcnt(0)
    v_dot2_f32_bf16 v136, v100, s60, v136
    v_dot2_f32_bf16 v138, v100, v100, v138
    v_dot2_f32_bf16 v137, v101, s60, v137
    v_dot2_f32_bf16 v139, v101, v101, v139
    v_dot2_f32_bf16 v136, v102, s60, v136
    v_dot2_f32_bf16 v138, v102, v102, v138
    v_dot2_f32_bf16 v137, v103, s60, v137
    v_dot2_f32_bf16 v139, v103, v103, v139
    s_nop 2
    v_add_f32 v136, v136, v137
    v_add_f32 v138, v138, v139
    s_nop 0
    v_add_f32_dpp v136, v136, v136 quad_perm:[1,0,3,2] row_mask:0xf bank_mask:0xf
    v_add_f32_dpp v138, v138, v138 quad_perm:[1,0,3,2] row_mask:0xf bank_mask:0xf
    s_nop 0
    v_add_f32_dpp v136, v136, v136 quad_perm:[2,3,0,1] row_mask:0xf bank_mask:0xf
    v_add_f32_dpp v138, v138, v138 quad_perm:[2,3,0,1] row_mask:0xf bank_mask:0xf
    s_nop 0
    v_add_f32_dpp v136, v136, v136 row_half_mirror row_mask:0xf bank_mask:0xf
    v_add_f32_dpp v138, v138, v138 row_half_mirror row_mask:0xf bank_mask:0xf
    v_mul_f32 v136, s61, v136
    v_mul_f32 v137, v136, v136
    v_fma_f32 v138, v138, s61, -v137
    v_max_f32 v138, 0, v138
    v_cvt_pk_bf16_f32 v136, v136, v136
    v_lshlrev_b32 v136, 16, v136
    v_cvt_pk_bf16_f32 v138, v138, v138
    v_lshlrev_b32 v138, 16, v138
    v_add_f32 v138, s62, v138
    v_cvt_pk_bf16_f32 v138, v138, v138
    v_lshlrev_b32 v138, 16, v138
    v_sqrt_f32 v138, v138
    s_nop 0
    v_cvt_pk_bf16_f32 v138, v138, v138
    v_lshlrev_b32 v138, 16, v138
    v_rcp_f32 v138, v138
    s_nop 0
    v_mul_f32 v136, -v136, v138
    v_mov_b32 v139, v138
    v_mov_b32 v137, v136
    v_lshlrev_b32 v10, 16, v64
    v_and_b32 v11, 0xffff0000, v64
    v_pk_fma_f32 v[10:11], v[10:11], v[138:139], v[136:137]
    v_cvt_pk_bf16_f32 v64, v10, v11
    v_lshlrev_b32 v12, 16, v65
    v_and_b32 v13, 0xffff0000, v65
    v_pk_fma_f32 v[12:13], v[12:13], v[138:139], v[136:137]
    v_cvt_pk_bf16_f32 v65, v12, v13
    v_lshlrev_b32 v14, 16, v66
    v_and_b32 v15, 0xffff0000, v66
    v_pk_fma_f32 v[14:15], v[14:15], v[138:139], v[136:137]
    v_cvt_pk_bf16_f32 v66, v14, v15
    v_lshlrev_b32 v16, 16, v67
    v_and_b32 v17, 0xffff0000, v67
    v_pk_fma_f32 v[16:17], v[16:17], v[138:139], v[136:137]
    v_cvt_pk_bf16_f32 v67, v16, v17
    v_lshlrev_b32 v10, 16, v68
    v_and_b32 v11, 0xffff0000, v68
    v_pk_fma_f32 v[10:11], v[10:11], v[138:139], v[136:137]
    v_cvt_pk_bf16_f32 v68, v10, v11
    v_lshlrev_b32 v12, 16, v69
    v_and_b32 v13, 0xffff0000, v69
    v_pk_fma_f32 v[12:13], v[12:13], v[138:139], v[136:137]
    v_cvt_pk_bf16_f32 v69, v12, v13
    v_lshlrev_b32 v14, 16, v70
    v_and_b32 v15, 0xffff0000, v70
    v_pk_fma_f32 v[14:15], v[14:15], v[138:139], v[136:137]
    v_cvt_pk_bf16_f32 v70, v14, v15
    v_lshlrev_b32 v16, 16, v71
    v_and_b32 v17, 0xffff0000, v71
    v_pk_fma_f32 v[16:17], v[16:17], v[138:139], v[136:137]
    v_cvt_pk_bf16_f32 v71, v16, v17
    v_lshlrev_b32 v10, 16, v72
    v_and_b32 v11, 0xffff0000, v72
    v_pk_fma_f32 v[10:11], v[10:11], v[138:139], v[136:137]
    v_cvt_pk_bf16_f32 v72, v10, v11
    v_lshlrev_b32 v12, 16, v73
    v_and_b32 v13, 0xffff0000, v73
    v_pk_fma_f32 v[12:13], v[12:13], v[138:139], v[136:137]
    v_cvt_pk_bf16_f32 v73, v12, v13
    v_lshlrev_b32 v14, 16, v74
    v_and_b32 v15, 0xffff0000, v74
    v_pk_fma_f32 v[14:15], v[14:15], v[138:139], v[136:137]
    v_cvt_pk_bf16_f32 v74, v14, v15
    v_lshlrev_b32 v16, 16, v75
    v_and_b32 v17, 0xffff0000, v75
    v_pk_fma_f32 v[16:17], v[16:17], v[138:139], v[136:137]
    v_cvt_pk_bf16_f32 v75, v16, v17
    v_lshlrev_b32 v10, 16, v76
    v_and_b32 v11, 0xffff0000, v76
    v_pk_fma_f32 v[10:11], v[10:11], v[138:139], v[136:137]
    v_cvt_pk_bf16_f32 v76, v10, v11
    v_lshlrev_b32 v12, 16, v77
    v_and_b32 v13, 0xffff0000, v77
    v_pk_fma_f32 v[12:13], v[12:13], v[138:139], v[136:137]
    v_cvt_pk_bf16_f32 v77, v12, v13
    v_lshlrev_b32 v14, 16, v78
    v_and_b32 v15, 0xffff0000, v78
    v_pk_fma_f32 v[14:15], v[14:15], v[138:139], v[136:137]
    v_cvt_pk_bf16_f32 v78, v14, v15
    v_lshlrev_b32 v16, 16, v79
    v_and_b32 v17, 0xffff0000, v79
    v_pk_fma_f32 v[16:17], v[16:17], v[138:139], v[136:137]
    v_cvt_pk_bf16_f32 v79, v16, v17
    v_lshlrev_b32 v10, 16, v80
    v_and_b32 v11, 0xffff0000, v80
    v_pk_fma_f32 v[10:11], v[10:11], v[138:139], v[136:137]
    v_cvt_pk_bf16_f32 v80, v10, v11
    v_lshlrev_b32 v12, 16, v81
    v_and_b32 v13, 0xffff0000, v81
    v_pk_fma_f32 v[12:13], v[12:13], v[138:139], v[136:137]
    v_cvt_pk_bf16_f32 v81, v12, v13
    v_lshlrev_b32 v14, 16, v82
    v_and_b32 v15, 0xffff0000, v82
    v_pk_fma_f32 v[14:15], v[14:15], v[138:139], v[136:137]
    v_cvt_pk_bf16_f32 v82, v14, v15
    v_lshlrev_b32 v16, 16, v83
    v_and_b32 v17, 0xffff0000, v83
    v_pk_fma_f32 v[16:17], v[16:17], v[138:139], v[136:137]
    v_cvt_pk_bf16_f32 v83, v16, v17
    v_lshlrev_b32 v10, 16, v84
    v_and_b32 v11, 0xffff0000, v84
    v_pk_fma_f32 v[10:11], v[10:11], v[138:139], v[136:137]
    v_cvt_pk_bf16_f32 v84, v10, v11
    v_lshlrev_b32 v12, 16, v85
    v_and_b32 v13, 0xffff0000, v85
    v_pk_fma_f32 v[12:13], v[12:13], v[138:139], v[136:137]
    v_cvt_pk_bf16_f32 v85, v12, v13
    v_lshlrev_b32 v14, 16, v86
    v_and_b32 v15, 0xffff0000, v86
    v_pk_fma_f32 v[14:15], v[14:15], v[138:139], v[136:137]
    v_cvt_pk_bf16_f32 v86, v14, v15
    v_lshlrev_b32 v16, 16, v87
    v_and_b32 v17, 0xffff0000, v87
    v_pk_fma_f32 v[16:17], v[16:17], v[138:139], v[136:137]
    v_cvt_pk_bf16_f32 v87, v16, v17
    v_lshlrev_b32 v10, 16, v88
    v_and_b32 v11, 0xffff0000, v88
    v_pk_fma_f32 v[10:11], v[10:11], v[138:139], v[136:137]
    v_cvt_pk_bf16_f32 v88, v10, v11
    v_lshlrev_b32 v12, 16, v89
    v_and_b32 v13, 0xffff0000, v89
    v_pk_fma_f32 v[12:13], v[12:13], v[138:139], v[136:137]
    v_cvt_pk_bf16_f32 v89, v12, v13
    v_lshlrev_b32 v14, 16, v90
    v_and_b32 v15, 0xffff0000, v90
    v_pk_fma_f32 v[14:15], v[14:15], v[138:139], v[136:137]
    v_cvt_pk_bf16_f32 v90, v14, v15
    v_lshlrev_b32 v16, 16, v91
    v_and_b32 v17, 0xffff0000, v91
    v_pk_fma_f32 v[16:17], v[16:17], v[138:139], v[136:137]
    v_cvt_pk_bf16_f32 v91, v16, v17
    v_lshlrev_b32 v10, 16, v92
    v_and_b32 v11, 0xffff0000, v92
    v_pk_fma_f32 v[10:11], v[10:11], v[138:139], v[136:137]
    v_cvt_pk_bf16_f32 v92, v10, v11
    v_lshlrev_b32 v12, 16, v93
    v_and_b32 v13, 0xffff0000, v93
    v_pk_fma_f32 v[12:13], v[12:13], v[138:139], v[136:137]
    v_cvt_pk_bf16_f32 v93, v12, v13
    v_lshlrev_b32 v14, 16, v94
    v_and_b32 v15, 0xffff0000, v94
    v_pk_fma_f32 v[14:15], v[14:15], v[138:139], v[136:137]
    v_cvt_pk_bf16_f32 v94, v14, v15
    v_lshlrev_b32 v16, 16, v95
    v_and_b32 v17, 0xffff0000, v95
    v_pk_fma_f32 v[16:17], v[16:17], v[138:139], v[136:137]
    v_cvt_pk_bf16_f32 v95, v16, v17
    v_lshlrev_b32 v10, 16, v96
    v_and_b32 v11, 0xffff0000, v96
    v_pk_fma_f32 v[10:11], v[10:11], v[138:139], v[136:137]
    v_cvt_pk_bf16_f32 v96, v10, v11
    v_lshlrev_b32 v12, 16, v97
    v_and_b32 v13, 0xffff0000, v97
    v_pk_fma_f32 v[12:13], v[12:13], v[138:139], v[136:137]
    v_cvt_pk_bf16_f32 v97, v12, v13
    v_lshlrev_b32 v14, 16, v98
    v_and_b32 v15, 0xffff0000, v98
    v_pk_fma_f32 v[14:15], v[14:15], v[138:139], v[136:137]
    v_cvt_pk_bf16_f32 v98, v14, v15
    v_lshlrev_b32 v16, 16, v99
    v_and_b32 v17, 0xffff0000, v99
    v_pk_fma_f32 v[16:17], v[16:17], v[138:139], v[136:137]
    v_cvt_pk_bf16_f32 v99, v16, v17
    v_lshlrev_b32 v10, 16, v100
    v_and_b32 v11, 0xffff0000, v100
    v_pk_fma_f32 v[10:11], v[10:11], v[138:139], v[136:137]
    v_cvt_pk_bf16_f32 v100, v10, v11
    v_lshlrev_b32 v12, 16, v101
    v_and_b32 v13, 0xffff0000, v101
    v_pk_fma_f32 v[12:13], v[12:13], v[138:139], v[136:137]
    v_cvt_pk_bf16_f32 v101, v12, v13
    v_lshlrev_b32 v14, 16, v102
    v_and_b32 v15, 0xffff0000, v102
    v_pk_fma_f32 v[14:15], v[14:15], v[138:139], v[136:137]
    v_cvt_pk_bf16_f32 v102, v14, v15
    v_lshlrev_b32 v16, 16, v103
    v_and_b32 v17, 0xffff0000, v103
    v_pk_fma_f32 v[16:17], v[16:17], v[138:139], v[136:137]
    v_cvt_pk_bf16_f32 v103, v16, v17
    ds_write_b128 v22, v[64:67] offset:0
    ds_write_b128 v23, v[68:71] offset:0
    ds_write_b128 v22, v[72:75] offset:256
    ds_write_b128 v23, v[76:79] offset:256
    ds_write_b128 v22, v[80:83] offset:512
    ds_write_b128 v23, v[84:87] offset:512
    ds_write_b128 v22, v[88:91] offset:768
    ds_write_b128 v23, v[92:95] offset:768
    ds_write_b128 v22, v[96:99] offset:1024
    ds_write_b128 v23, v[100:103] offset:1024
    s_waitcnt lgkmcnt(0)
    s_mov_b64 exec, 1
    ds_add_u32 v147, v145 offset:28
    s_mov_b64 exec, -1
    s_lshl_b32 s7, s49, 2
    s_add_u32 s7, s7, s6
    s_mul_i32 s24, s7, 10240
    s_add_u32 s24, s24, 2838528
    v_mov_b32 v136, 0
    v_mov_b32 v137, 0
    v_mov_b32 v138, 0
    v_mov_b32 v139, 0
    v_dot2_f32_bf16 v136, v64, s60, v136
    v_dot2_f32_bf16 v138, v64, v64, v138
    v_dot2_f32_bf16 v137, v65, s60, v137
    v_dot2_f32_bf16 v139, v65, v65, v139
    v_dot2_f32_bf16 v136, v66, s60, v136
    v_dot2_f32_bf16 v138, v66, v66, v138
    v_dot2_f32_bf16 v137, v67, s60, v137
    v_dot2_f32_bf16 v139, v67, v67, v139
    v_dot2_f32_bf16 v136, v68, s60, v136
    v_dot2_f32_bf16 v138, v68, v68, v138
    v_dot2_f32_bf16 v137, v69, s60, v137
    v_dot2_f32_bf16 v139, v69, v69, v139
    v_dot2_f32_bf16 v136, v70, s60, v136
    v_dot2_f32_bf16 v138, v70, v70, v138
    v_dot2_f32_bf16 v137, v71, s60, v137
    v_dot2_f32_bf16 v139, v71, v71, v139
    v_dot2_f32_bf16 v136, v72, s60, v136
    v_dot2_f32_bf16 v138, v72, v72, v138
    v_dot2_f32_bf16 v137, v73, s60, v137
    v_dot2_f32_bf16 v139, v73, v73, v139
    v_dot2_f32_bf16 v136, v74, s60, v136
    v_dot2_f32_bf16 v138, v74, v74, v138
    v_dot2_f32_bf16 v137, v75, s60, v137
    v_dot2_f32_bf16 v139, v75, v75, v139
    v_dot2_f32_bf16 v136, v76, s60, v136
    v_dot2_f32_bf16 v138, v76, v76, v138
    v_dot2_f32_bf16 v137, v77, s60, v137
    v_dot2_f32_bf16 v139, v77, v77, v139
    v_dot2_f32_bf16 v136, v78, s60, v136
    v_dot2_f32_bf16 v138, v78, v78, v138
    v_dot2_f32_bf16 v137, v79, s60, v137
    v_dot2_f32_bf16 v139, v79, v79, v139
    v_dot2_f32_bf16 v136, v80, s60, v136
    v_dot2_f32_bf16 v138, v80, v80, v138
    v_dot2_f32_bf16 v137, v81, s60, v137
    v_dot2_f32_bf16 v139, v81, v81, v139
    v_dot2_f32_bf16 v136, v82, s60, v136
    v_dot2_f32_bf16 v138, v82, v82, v138
    v_dot2_f32_bf16 v137, v83, s60, v137
    v_dot2_f32_bf16 v139, v83, v83, v139
    v_dot2_f32_bf16 v136, v84, s60, v136
    v_dot2_f32_bf16 v138, v84, v84, v138
    v_dot2_f32_bf16 v137, v85, s60, v137
    v_dot2_f32_bf16 v139, v85, v85, v139
    v_dot2_f32_bf16 v136, v86, s60, v136
    v_dot2_f32_bf16 v138, v86, v86, v138
    v_dot2_f32_bf16 v137, v87, s60, v137
    v_dot2_f32_bf16 v139, v87, v87, v139
    v_dot2_f32_bf16 v136, v88, s60, v136
    v_dot2_f32_bf16 v138, v88, v88, v138
    v_dot2_f32_bf16 v137, v89, s60, v137
    v_dot2_f32_bf16 v139, v89, v89, v139
    v_dot2_f32_bf16 v136, v90, s60, v136
    v_dot2_f32_bf16 v138, v90, v90, v138
    v_dot2_f32_bf16 v137, v91, s60, v137
    v_dot2_f32_bf16 v139, v91, v91, v139
    v_dot2_f32_bf16 v136, v92, s60, v136
    v_dot2_f32_bf16 v138, v92, v92, v138
    v_dot2_f32_bf16 v137, v93, s60, v137
    v_dot2_f32_bf16 v139, v93, v93, v139
    v_dot2_f32_bf16 v136, v94, s60, v136
    v_dot2_f32_bf16 v138, v94, v94, v138
    v_dot2_f32_bf16 v137, v95, s60, v137
    v_dot2_f32_bf16 v139, v95, v95, v139
    v_dot2_f32_bf16 v136, v96, s60, v136
    v_dot2_f32_bf16 v138, v96, v96, v138
    v_dot2_f32_bf16 v137, v97, s60, v137
    v_dot2_f32_bf16 v139, v97, v97, v139
    v_dot2_f32_bf16 v136, v98, s60, v136
    v_dot2_f32_bf16 v138, v98, v98, v138
    v_dot2_f32_bf16 v137, v99, s60, v137
    v_dot2_f32_bf16 v139, v99, v99, v139
    v_dot2_f32_bf16 v136, v100, s60, v136
    v_dot2_f32_bf16 v138, v100, v100, v138
    v_dot2_f32_bf16 v137, v101, s60, v137
    v_dot2_f32_bf16 v139, v101, v101, v139
    v_dot2_f32_bf16 v136, v102, s60, v136
    v_dot2_f32_bf16 v138, v102, v102, v138
    v_dot2_f32_bf16 v137, v103, s60, v137
    v_dot2_f32_bf16 v139, v103, v103, v139
    s_nop 2
    v_add_f32 v136, v136, v137
    v_add_f32 v138, v138, v139
    s_nop 0
    v_add_f32_dpp v136, v136, v136 quad_perm:[1,0,3,2] row_mask:0xf bank_mask:0xf
    v_add_f32_dpp v138, v138, v138 quad_perm:[1,0,3,2] row_mask:0xf bank_mask:0xf
    s_nop 0
    v_add_f32_dpp v136, v136, v136 quad_perm:[2,3,0,1] row_mask:0xf bank_mask:0xf
    v_add_f32_dpp v138, v138, v138 quad_perm:[2,3,0,1] row_mask:0xf bank_mask:0xf
    s_nop 0
    v_add_f32_dpp v136, v136, v136 row_half_mirror row_mask:0xf bank_mask:0xf
    v_add_f32_dpp v138, v138, v138 row_half_mirror row_mask:0xf bank_mask:0xf
    v_mul_f32 v136, s61, v136
    v_mul_f32 v137, v136, v136
    v_fma_f32 v138, v138, s61, -v137
    v_max_f32 v138, 0, v138
    v_cvt_pk_bf16_f32 v136, v136, v136
    v_lshlrev_b32 v136, 16, v136
    v_cvt_pk_bf16_f32 v138, v138, v138
    v_lshlrev_b32 v138, 16, v138
    v_add_f32 v138, s62, v138
    v_cvt_pk_bf16_f32 v138, v138, v138
    v_lshlrev_b32 v138, 16, v138
    v_sqrt_f32 v138, v138
    s_nop 0
    v_cvt_pk_bf16_f32 v138, v138, v138
    v_lshlrev_b32 v138, 16, v138
    v_rcp_f32 v138, v138
    s_nop 0
    v_mul_f32 v136, -v136, v138
    v_mov_b32 v139, v138
    v_mov_b32 v137, v136
    s_cmp_lg_u32 s47, 0
    s_cbranch_scc1 parallel_sum__grouped_kv_mqa__mixer_token_mlp__prompt_kernel_hv1
    s_mul_i32 s7, s6, 2560
    s_add_u32 s7, s7, 26624
    v_bfe_u32 v140, v0, 3, 3
    v_and_b32 v141, 7, v0
    v_mul_u32_u24 v140, 320, v140
    v_lshl_add_u32 v140, v141, 4, v140
    v_add_u32 v140, s7, v140
    v_bfe_u32 v141, v0, 2, 2
    v_mul_u32_u24 v141, 320, v141
    v_bfe_u32 v142, v0, 4, 2
    v_lshl_add_u32 v141, v142, 5, v141
    v_and_b32 v142, 3, v0
    v_lshl_add_u32 v141, v142, 3, v141
    v_add_u32 v141, s7, v141
    s_add_u32 s24, s24, 0
    v_lshlrev_b32 v10, 16, v64
    v_and_b32 v11, 0xffff0000, v64
    v_pk_fma_f32 v[10:11], v[10:11], v[138:139], v[136:137]
    v_cvt_pk_bf16_f32 v64, v10, v11
    v_lshlrev_b32 v12, 16, v65
    v_and_b32 v13, 0xffff0000, v65
    v_pk_fma_f32 v[12:13], v[12:13], v[138:139], v[136:137]
    v_cvt_pk_bf16_f32 v65, v12, v13
    v_lshlrev_b32 v14, 16, v66
    v_and_b32 v15, 0xffff0000, v66
    v_pk_fma_f32 v[14:15], v[14:15], v[138:139], v[136:137]
    v_cvt_pk_bf16_f32 v66, v14, v15
    v_lshlrev_b32 v16, 16, v67
    v_and_b32 v17, 0xffff0000, v67
    v_pk_fma_f32 v[16:17], v[16:17], v[138:139], v[136:137]
    v_cvt_pk_bf16_f32 v67, v16, v17
    ds_write_b128 v140, v[64:67] offset:0
    v_lshlrev_b32 v10, 16, v68
    v_and_b32 v11, 0xffff0000, v68
    v_pk_fma_f32 v[10:11], v[10:11], v[138:139], v[136:137]
    v_cvt_pk_bf16_f32 v68, v10, v11
    v_lshlrev_b32 v12, 16, v69
    v_and_b32 v13, 0xffff0000, v69
    v_pk_fma_f32 v[12:13], v[12:13], v[138:139], v[136:137]
    v_cvt_pk_bf16_f32 v69, v12, v13
    v_lshlrev_b32 v14, 16, v70
    v_and_b32 v15, 0xffff0000, v70
    v_pk_fma_f32 v[14:15], v[14:15], v[138:139], v[136:137]
    v_cvt_pk_bf16_f32 v70, v14, v15
    v_lshlrev_b32 v16, 16, v71
    v_and_b32 v17, 0xffff0000, v71
    v_pk_fma_f32 v[16:17], v[16:17], v[138:139], v[136:137]
    v_cvt_pk_bf16_f32 v71, v16, v17
    ds_write_b128 v140, v[68:71] offset:128
    s_waitcnt lgkmcnt(0)
    ds_read_b64_tr_b16 v[64:65], v141 offset:0
    ds_read_b64_tr_b16 v[66:67], v141 offset:1280
    ds_read_b64_tr_b16 v[68:69], v141 offset:128
    ds_read_b64_tr_b16 v[70:71], v141 offset:1408
    s_waitcnt lgkmcnt(2)
    buffer_store_dwordx4 v[64:67], v1, s[8:11], s24 offen offset:0 sc1
    s_waitcnt lgkmcnt(0)
    buffer_store_dwordx4 v[68:71], v1, s[8:11], s24 offen offset:1024 sc1
    s_branch parallel_sum__grouped_kv_mqa__mixer_token_mlp__prompt_kernel_hz
parallel_sum__grouped_kv_mqa__mixer_token_mlp__prompt_kernel_hv1:
    s_cmp_lg_u32 s47, 1
    s_cbranch_scc1 parallel_sum__grouped_kv_mqa__mixer_token_mlp__prompt_kernel_hv2
    s_mul_i32 s7, s6, 2560
    s_add_u32 s7, s7, 26624
    v_bfe_u32 v140, v0, 3, 3
    v_and_b32 v141, 7, v0
    v_mul_u32_u24 v140, 320, v140
    v_lshl_add_u32 v140, v141, 4, v140
    v_add_u32 v140, s7, v140
    v_bfe_u32 v141, v0, 2, 2
    v_mul_u32_u24 v141, 320, v141
    v_bfe_u32 v142, v0, 4, 2
    v_lshl_add_u32 v141, v142, 5, v141
    v_and_b32 v142, 3, v0
    v_lshl_add_u32 v141, v142, 3, v141
    v_add_u32 v141, s7, v141
    s_add_u32 s24, s24, 2048
    v_lshlrev_b32 v10, 16, v72
    v_and_b32 v11, 0xffff0000, v72
    v_pk_fma_f32 v[10:11], v[10:11], v[138:139], v[136:137]
    v_cvt_pk_bf16_f32 v72, v10, v11
    v_lshlrev_b32 v12, 16, v73
    v_and_b32 v13, 0xffff0000, v73
    v_pk_fma_f32 v[12:13], v[12:13], v[138:139], v[136:137]
    v_cvt_pk_bf16_f32 v73, v12, v13
    v_lshlrev_b32 v14, 16, v74
    v_and_b32 v15, 0xffff0000, v74
    v_pk_fma_f32 v[14:15], v[14:15], v[138:139], v[136:137]
    v_cvt_pk_bf16_f32 v74, v14, v15
    v_lshlrev_b32 v16, 16, v75
    v_and_b32 v17, 0xffff0000, v75
    v_pk_fma_f32 v[16:17], v[16:17], v[138:139], v[136:137]
    v_cvt_pk_bf16_f32 v75, v16, v17
    ds_write_b128 v140, v[72:75] offset:0
    v_lshlrev_b32 v10, 16, v76
    v_and_b32 v11, 0xffff0000, v76
    v_pk_fma_f32 v[10:11], v[10:11], v[138:139], v[136:137]
    v_cvt_pk_bf16_f32 v76, v10, v11
    v_lshlrev_b32 v12, 16, v77
    v_and_b32 v13, 0xffff0000, v77
    v_pk_fma_f32 v[12:13], v[12:13], v[138:139], v[136:137]
    v_cvt_pk_bf16_f32 v77, v12, v13
    v_lshlrev_b32 v14, 16, v78
    v_and_b32 v15, 0xffff0000, v78
    v_pk_fma_f32 v[14:15], v[14:15], v[138:139], v[136:137]
    v_cvt_pk_bf16_f32 v78, v14, v15
    v_lshlrev_b32 v16, 16, v79
    v_and_b32 v17, 0xffff0000, v79
    v_pk_fma_f32 v[16:17], v[16:17], v[138:139], v[136:137]
    v_cvt_pk_bf16_f32 v79, v16, v17
    ds_write_b128 v140, v[76:79] offset:128
    s_waitcnt lgkmcnt(0)
    ds_read_b64_tr_b16 v[72:73], v141 offset:0
    ds_read_b64_tr_b16 v[74:75], v141 offset:1280
    ds_read_b64_tr_b16 v[76:77], v141 offset:128
    ds_read_b64_tr_b16 v[78:79], v141 offset:1408
    s_waitcnt lgkmcnt(2)
    buffer_store_dwordx4 v[72:75], v1, s[8:11], s24 offen offset:0 sc1
    s_waitcnt lgkmcnt(0)
    buffer_store_dwordx4 v[76:79], v1, s[8:11], s24 offen offset:1024 sc1
    s_branch parallel_sum__grouped_kv_mqa__mixer_token_mlp__prompt_kernel_hz
parallel_sum__grouped_kv_mqa__mixer_token_mlp__prompt_kernel_hv2:
    s_cmp_lg_u32 s47, 2
    s_cbranch_scc1 parallel_sum__grouped_kv_mqa__mixer_token_mlp__prompt_kernel_hv3
    s_mul_i32 s7, s6, 3584
    s_add_u32 s7, s7, 0
    v_bfe_u32 v140, v0, 3, 3
    v_and_b32 v141, 7, v0
    v_mul_u32_u24 v140, 448, v140
    v_lshl_add_u32 v140, v141, 4, v140
    v_add_u32 v140, s7, v140
    v_bfe_u32 v141, v0, 2, 2
    v_mul_u32_u24 v141, 448, v141
    v_bfe_u32 v142, v0, 4, 2
    v_lshl_add_u32 v141, v142, 5, v141
    v_and_b32 v142, 3, v0
    v_lshl_add_u32 v141, v142, 3, v141
    v_add_u32 v141, s7, v141
    s_add_u32 s24, s24, 4096
    v_lshlrev_b32 v10, 16, v80
    v_and_b32 v11, 0xffff0000, v80
    v_pk_fma_f32 v[10:11], v[10:11], v[138:139], v[136:137]
    v_cvt_pk_bf16_f32 v80, v10, v11
    v_lshlrev_b32 v12, 16, v81
    v_and_b32 v13, 0xffff0000, v81
    v_pk_fma_f32 v[12:13], v[12:13], v[138:139], v[136:137]
    v_cvt_pk_bf16_f32 v81, v12, v13
    v_lshlrev_b32 v14, 16, v82
    v_and_b32 v15, 0xffff0000, v82
    v_pk_fma_f32 v[14:15], v[14:15], v[138:139], v[136:137]
    v_cvt_pk_bf16_f32 v82, v14, v15
    v_lshlrev_b32 v16, 16, v83
    v_and_b32 v17, 0xffff0000, v83
    v_pk_fma_f32 v[16:17], v[16:17], v[138:139], v[136:137]
    v_cvt_pk_bf16_f32 v83, v16, v17
    ds_write_b128 v140, v[80:83] offset:0
    v_lshlrev_b32 v10, 16, v84
    v_and_b32 v11, 0xffff0000, v84
    v_pk_fma_f32 v[10:11], v[10:11], v[138:139], v[136:137]
    v_cvt_pk_bf16_f32 v84, v10, v11
    v_lshlrev_b32 v12, 16, v85
    v_and_b32 v13, 0xffff0000, v85
    v_pk_fma_f32 v[12:13], v[12:13], v[138:139], v[136:137]
    v_cvt_pk_bf16_f32 v85, v12, v13
    v_lshlrev_b32 v14, 16, v86
    v_and_b32 v15, 0xffff0000, v86
    v_pk_fma_f32 v[14:15], v[14:15], v[138:139], v[136:137]
    v_cvt_pk_bf16_f32 v86, v14, v15
    v_lshlrev_b32 v16, 16, v87
    v_and_b32 v17, 0xffff0000, v87
    v_pk_fma_f32 v[16:17], v[16:17], v[138:139], v[136:137]
    v_cvt_pk_bf16_f32 v87, v16, v17
    ds_write_b128 v140, v[84:87] offset:128
    v_lshlrev_b32 v10, 16, v88
    v_and_b32 v11, 0xffff0000, v88
    v_pk_fma_f32 v[10:11], v[10:11], v[138:139], v[136:137]
    v_cvt_pk_bf16_f32 v88, v10, v11
    v_lshlrev_b32 v12, 16, v89
    v_and_b32 v13, 0xffff0000, v89
    v_pk_fma_f32 v[12:13], v[12:13], v[138:139], v[136:137]
    v_cvt_pk_bf16_f32 v89, v12, v13
    v_lshlrev_b32 v14, 16, v90
    v_and_b32 v15, 0xffff0000, v90
    v_pk_fma_f32 v[14:15], v[14:15], v[138:139], v[136:137]
    v_cvt_pk_bf16_f32 v90, v14, v15
    v_lshlrev_b32 v16, 16, v91
    v_and_b32 v17, 0xffff0000, v91
    v_pk_fma_f32 v[16:17], v[16:17], v[138:139], v[136:137]
    v_cvt_pk_bf16_f32 v91, v16, v17
    ds_write_b128 v140, v[88:91] offset:256
    s_waitcnt lgkmcnt(0)
    ds_read_b64_tr_b16 v[80:81], v141 offset:0
    ds_read_b64_tr_b16 v[82:83], v141 offset:1792
    ds_read_b64_tr_b16 v[84:85], v141 offset:128
    ds_read_b64_tr_b16 v[86:87], v141 offset:1920
    ds_read_b64_tr_b16 v[88:89], v141 offset:256
    ds_read_b64_tr_b16 v[90:91], v141 offset:2048
    s_waitcnt lgkmcnt(4)
    buffer_store_dwordx4 v[80:83], v1, s[8:11], s24 offen offset:0 sc1
    s_waitcnt lgkmcnt(2)
    buffer_store_dwordx4 v[84:87], v1, s[8:11], s24 offen offset:1024 sc1
    s_waitcnt lgkmcnt(0)
    buffer_store_dwordx4 v[88:91], v1, s[8:11], s24 offen offset:2048 sc1
    s_branch parallel_sum__grouped_kv_mqa__mixer_token_mlp__prompt_kernel_hz
parallel_sum__grouped_kv_mqa__mixer_token_mlp__prompt_kernel_hv3:
    s_mul_i32 s7, s6, 3584
    s_add_u32 s7, s7, 0
    v_bfe_u32 v140, v0, 3, 3
    v_and_b32 v141, 7, v0
    v_mul_u32_u24 v140, 448, v140
    v_lshl_add_u32 v140, v141, 4, v140
    v_add_u32 v140, s7, v140
    v_bfe_u32 v141, v0, 2, 2
    v_mul_u32_u24 v141, 448, v141
    v_bfe_u32 v142, v0, 4, 2
    v_lshl_add_u32 v141, v142, 5, v141
    v_and_b32 v142, 3, v0
    v_lshl_add_u32 v141, v142, 3, v141
    v_add_u32 v141, s7, v141
    s_add_u32 s24, s24, 7168
    v_lshlrev_b32 v10, 16, v92
    v_and_b32 v11, 0xffff0000, v92
    v_pk_fma_f32 v[10:11], v[10:11], v[138:139], v[136:137]
    v_cvt_pk_bf16_f32 v92, v10, v11
    v_lshlrev_b32 v12, 16, v93
    v_and_b32 v13, 0xffff0000, v93
    v_pk_fma_f32 v[12:13], v[12:13], v[138:139], v[136:137]
    v_cvt_pk_bf16_f32 v93, v12, v13
    v_lshlrev_b32 v14, 16, v94
    v_and_b32 v15, 0xffff0000, v94
    v_pk_fma_f32 v[14:15], v[14:15], v[138:139], v[136:137]
    v_cvt_pk_bf16_f32 v94, v14, v15
    v_lshlrev_b32 v16, 16, v95
    v_and_b32 v17, 0xffff0000, v95
    v_pk_fma_f32 v[16:17], v[16:17], v[138:139], v[136:137]
    v_cvt_pk_bf16_f32 v95, v16, v17
    ds_write_b128 v140, v[92:95] offset:0
    v_lshlrev_b32 v10, 16, v96
    v_and_b32 v11, 0xffff0000, v96
    v_pk_fma_f32 v[10:11], v[10:11], v[138:139], v[136:137]
    v_cvt_pk_bf16_f32 v96, v10, v11
    v_lshlrev_b32 v12, 16, v97
    v_and_b32 v13, 0xffff0000, v97
    v_pk_fma_f32 v[12:13], v[12:13], v[138:139], v[136:137]
    v_cvt_pk_bf16_f32 v97, v12, v13
    v_lshlrev_b32 v14, 16, v98
    v_and_b32 v15, 0xffff0000, v98
    v_pk_fma_f32 v[14:15], v[14:15], v[138:139], v[136:137]
    v_cvt_pk_bf16_f32 v98, v14, v15
    v_lshlrev_b32 v16, 16, v99
    v_and_b32 v17, 0xffff0000, v99
    v_pk_fma_f32 v[16:17], v[16:17], v[138:139], v[136:137]
    v_cvt_pk_bf16_f32 v99, v16, v17
    ds_write_b128 v140, v[96:99] offset:128
    v_lshlrev_b32 v10, 16, v100
    v_and_b32 v11, 0xffff0000, v100
    v_pk_fma_f32 v[10:11], v[10:11], v[138:139], v[136:137]
    v_cvt_pk_bf16_f32 v100, v10, v11
    v_lshlrev_b32 v12, 16, v101
    v_and_b32 v13, 0xffff0000, v101
    v_pk_fma_f32 v[12:13], v[12:13], v[138:139], v[136:137]
    v_cvt_pk_bf16_f32 v101, v12, v13
    v_lshlrev_b32 v14, 16, v102
    v_and_b32 v15, 0xffff0000, v102
    v_pk_fma_f32 v[14:15], v[14:15], v[138:139], v[136:137]
    v_cvt_pk_bf16_f32 v102, v14, v15
    v_lshlrev_b32 v16, 16, v103
    v_and_b32 v17, 0xffff0000, v103
    v_pk_fma_f32 v[16:17], v[16:17], v[138:139], v[136:137]
    v_cvt_pk_bf16_f32 v103, v16, v17
    ds_write_b128 v140, v[100:103] offset:256
    s_waitcnt lgkmcnt(0)
    ds_read_b64_tr_b16 v[92:93], v141 offset:0
    ds_read_b64_tr_b16 v[94:95], v141 offset:1792
    ds_read_b64_tr_b16 v[96:97], v141 offset:128
    ds_read_b64_tr_b16 v[98:99], v141 offset:1920
    ds_read_b64_tr_b16 v[100:101], v141 offset:256
    ds_read_b64_tr_b16 v[102:103], v141 offset:2048
    s_waitcnt lgkmcnt(4)
    buffer_store_dwordx4 v[92:95], v1, s[8:11], s24 offen offset:0 sc1
    s_waitcnt lgkmcnt(2)
    buffer_store_dwordx4 v[96:99], v1, s[8:11], s24 offen offset:1024 sc1
    s_waitcnt lgkmcnt(0)
    buffer_store_dwordx4 v[100:103], v1, s[8:11], s24 offen offset:2048 sc1
parallel_sum__grouped_kv_mqa__mixer_token_mlp__prompt_kernel_hz:
    v_mov_b32 v10, -1
    v_mov_b32 v11, -1
    v_mov_b32 v12, -1
    v_mov_b32 v13, -1
    buffer_store_dwordx4 v[10:13], v7, s[8:11], s18 offen sc1
    s_add_u32 s7, s18, 65536
    buffer_store_dwordx4 v[10:13], v7, s[8:11], s7 offen sc1
    s_add_u32 s7, s18, 131072
    s_mov_b32 exec_hi, 0
    buffer_store_dwordx4 v[10:13], v7, s[8:11], s7 offen sc1
    s_mov_b32 exec_hi, -1
parallel_sum__grouped_kv_mqa__mixer_token_mlp__prompt_kernel_lw0:
    ds_read_b32 v8, v147 offset:28
    s_waitcnt lgkmcnt(0)
    v_cmp_gt_u32 s[84:85], 4, v8
    s_nop 1
    s_cmp_eq_u64 s[84:85], 0
    s_cbranch_scc0 parallel_sum__grouped_kv_mqa__mixer_token_mlp__prompt_kernel_lx0
parallel_sum__grouped_kv_mqa__mixer_token_mlp__prompt_kernel_lw1:
    ds_read_b32 v8, v147 offset:40
    s_waitcnt lgkmcnt(0)
    v_cmp_gt_u32 s[84:85], 1, v8
    s_nop 1
    s_cmp_eq_u64 s[84:85], 0
    s_cbranch_scc0 parallel_sum__grouped_kv_mqa__mixer_token_mlp__prompt_kernel_lx1
    ds_read_b128 v[32:35], v24 offset:0
    ds_read_b64_tr_b16 v[104:105], v20 offset:0
    ds_read_b64_tr_b16 v[106:107], v20 offset:1280
    ds_read_b64_tr_b16 v[108:109], v20 offset:64
    ds_read_b64_tr_b16 v[110:111], v20 offset:1344
    ds_read_b128 v[36:39], v25 offset:0
    ds_read_b64_tr_b16 v[112:113], v20 offset:5120
    ds_read_b64_tr_b16 v[114:115], v20 offset:6400
    ds_read_b64_tr_b16 v[116:117], v20 offset:5184
    ds_read_b64_tr_b16 v[118:119], v20 offset:6464
    ds_read_b128 v[40:43], v26 offset:0
    ds_read_b64_tr_b16 v[120:121], v20 offset:10240
    ds_read_b64_tr_b16 v[122:123], v20 offset:11520
    ds_read_b64_tr_b16 v[124:125], v20 offset:10304
    ds_read_b64_tr_b16 v[126:127], v20 offset:11584
    s_waitcnt lgkmcnt(10)
    v_mfma_f32_32x32x16_bf16 v[152:167], v[104:107], v[32:35], 0
    ds_read_b32 v8, v147 offset:44
    ds_read_b128 v[44:47], v27 offset:0
    ds_read_b64_tr_b16 v[128:129], v20 offset:15360
    v_mfma_f32_32x32x16_bf16 v[48:63], v[108:111], v[32:35], 0
    ds_read_b64_tr_b16 v[130:131], v20 offset:16640
    ds_read_b64_tr_b16 v[132:133], v20 offset:15424
    ds_read_b64_tr_b16 v[134:135], v20 offset:16704
    s_waitcnt lgkmcnt(5)
    v_cmp_gt_u32 vcc, 1, v8
    v_mfma_f32_32x32x16_bf16 v[152:167], v[112:115], v[36:39], v[152:167]
    s_nop 3
    s_cbranch_vccnz parallel_sum__grouped_kv_mqa__mixer_token_mlp__prompt_kernel_cx2
parallel_sum__grouped_kv_mqa__mixer_token_mlp__prompt_kernel_cb2:
    ds_read_b128 v[32:35], v28 offset:0
    ds_read_b64_tr_b16 v[104:105], v20 offset:20480
    ds_read_b64_tr_b16 v[106:107], v20 offset:21760
    v_mfma_f32_32x32x16_bf16 v[48:63], v[116:119], v[36:39], v[48:63]
    ds_read_b64_tr_b16 v[108:109], v20 offset:20544
    ds_read_b64_tr_b16 v[110:111], v20 offset:21824
    s_waitcnt lgkmcnt(10)
    v_mfma_f32_32x32x16_bf16 v[152:167], v[120:123], v[40:43], v[152:167]
    ds_read_b128 v[36:39], v29 offset:0
    ds_read_b64_tr_b16 v[112:113], v20 offset:25600
    ds_read_b64_tr_b16 v[114:115], v20 offset:26880
    v_mfma_f32_32x32x16_bf16 v[48:63], v[124:127], v[40:43], v[48:63]
    ds_read_b64_tr_b16 v[116:117], v20 offset:25664
    ds_read_b64_tr_b16 v[118:119], v20 offset:26944
    s_waitcnt lgkmcnt(10)
    v_mfma_f32_32x32x16_bf16 v[152:167], v[128:131], v[44:47], v[152:167]
    ds_read_b128 v[40:43], v30 offset:0
    ds_read_b64_tr_b16 v[120:121], v20 offset:30720
    ds_read_b64_tr_b16 v[122:123], v20 offset:32000
    v_mfma_f32_32x32x16_bf16 v[48:63], v[132:135], v[44:47], v[48:63]
    ds_read_b64_tr_b16 v[124:125], v20 offset:30784
    ds_read_b64_tr_b16 v[126:127], v20 offset:32064
    s_waitcnt lgkmcnt(10)
    s_mov_b64 exec, 1
    ds_add_u32 v147, v145 offset:80
    s_mov_b64 exec, -1
    v_mfma_f32_32x32x16_bf16 v[152:167], v[104:107], v[32:35], v[152:167]
    ds_read_b32 v8, v147 offset:48
    ds_read_b128 v[44:47], v31 offset:0
    ds_read_b64_tr_b16 v[128:129], v20 offset:35840
    v_mfma_f32_32x32x16_bf16 v[48:63], v[108:111], v[32:35], v[48:63]
    ds_read_b64_tr_b16 v[130:131], v20 offset:37120
    ds_read_b64_tr_b16 v[132:133], v20 offset:35904
    ds_read_b64_tr_b16 v[134:135], v20 offset:37184
    s_waitcnt lgkmcnt(5)
    v_cmp_gt_u32 vcc, 1, v8
    v_mfma_f32_32x32x16_bf16 v[152:167], v[112:115], v[36:39], v[152:167]
    s_nop 3
    s_cbranch_vccnz parallel_sum__grouped_kv_mqa__mixer_token_mlp__prompt_kernel_cx3
parallel_sum__grouped_kv_mqa__mixer_token_mlp__prompt_kernel_cb3:
    ds_read_b128 v[32:35], v24 offset:256
    ds_read_b64_tr_b16 v[104:105], v20 offset:40960
    ds_read_b64_tr_b16 v[106:107], v20 offset:42240
    v_mfma_f32_32x32x16_bf16 v[48:63], v[116:119], v[36:39], v[48:63]
    ds_read_b64_tr_b16 v[108:109], v20 offset:41024
    ds_read_b64_tr_b16 v[110:111], v20 offset:42304
    s_waitcnt lgkmcnt(10)
    v_mfma_f32_32x32x16_bf16 v[152:167], v[120:123], v[40:43], v[152:167]
    ds_read_b128 v[36:39], v25 offset:256
    ds_read_b64_tr_b16 v[112:113], v20 offset:46080
    ds_read_b64_tr_b16 v[114:115], v20 offset:47360
    v_mfma_f32_32x32x16_bf16 v[48:63], v[124:127], v[40:43], v[48:63]
    ds_read_b64_tr_b16 v[116:117], v20 offset:46144
    ds_read_b64_tr_b16 v[118:119], v20 offset:47424
    s_waitcnt lgkmcnt(10)
    v_mfma_f32_32x32x16_bf16 v[152:167], v[128:131], v[44:47], v[152:167]
    ds_read_b128 v[40:43], v26 offset:256
    ds_read_b64_tr_b16 v[120:121], v20 offset:51200
    ds_read_b64_tr_b16 v[122:123], v20 offset:52480
    v_mfma_f32_32x32x16_bf16 v[48:63], v[132:135], v[44:47], v[48:63]
    ds_read_b64_tr_b16 v[124:125], v20 offset:51264
    ds_read_b64_tr_b16 v[126:127], v20 offset:52544
    s_waitcnt lgkmcnt(10)
    s_mov_b64 exec, 1
    ds_add_u32 v147, v145 offset:84
    s_mov_b64 exec, -1
    s_waitcnt vmcnt(0)
    s_mov_b64 exec, 1
    ds_add_u32 v147, v145 offset:36
    s_mov_b64 exec, -1
    v_mfma_f32_32x32x16_bf16 v[152:167], v[104:107], v[32:35], v[152:167]
    ds_read_b32 v8, v147 offset:52
    ds_read_b128 v[44:47], v27 offset:256
    ds_read_b64_tr_b16 v[128:129], v20 offset:56320
    v_mfma_f32_32x32x16_bf16 v[48:63], v[108:111], v[32:35], v[48:63]
    ds_read_b64_tr_b16 v[130:131], v20 offset:57600
    ds_read_b64_tr_b16 v[132:133], v20 offset:56384
    ds_read_b64_tr_b16 v[134:135], v20 offset:57664
    s_waitcnt lgkmcnt(5)
    v_cmp_gt_u32 vcc, 1, v8
    v_mfma_f32_32x32x16_bf16 v[152:167], v[112:115], v[36:39], v[152:167]
    s_nop 3
    s_cbranch_vccnz parallel_sum__grouped_kv_mqa__mixer_token_mlp__prompt_kernel_cx4
parallel_sum__grouped_kv_mqa__mixer_token_mlp__prompt_kernel_cb4:
    ds_read_b128 v[32:35], v28 offset:256
    ds_read_b64_tr_b16 v[104:105], v21 offset:0
    ds_read_b64_tr_b16 v[106:107], v21 offset:1280
    v_mfma_f32_32x32x16_bf16 v[48:63], v[116:119], v[36:39], v[48:63]
    ds_read_b64_tr_b16 v[108:109], v21 offset:64
    ds_read_b64_tr_b16 v[110:111], v21 offset:1344
    s_waitcnt lgkmcnt(10)
    v_mfma_f32_32x32x16_bf16 v[152:167], v[120:123], v[40:43], v[152:167]
    ds_read_b128 v[36:39], v29 offset:256
    ds_read_b64_tr_b16 v[112:113], v21 offset:5120
    ds_read_b64_tr_b16 v[114:115], v21 offset:6400
    v_mfma_f32_32x32x16_bf16 v[48:63], v[124:127], v[40:43], v[48:63]
    ds_read_b64_tr_b16 v[116:117], v21 offset:5184
    ds_read_b64_tr_b16 v[118:119], v21 offset:6464
    s_waitcnt lgkmcnt(10)
    v_mfma_f32_32x32x16_bf16 v[152:167], v[128:131], v[44:47], v[152:167]
    ds_read_b128 v[40:43], v30 offset:256
    ds_read_b64_tr_b16 v[120:121], v21 offset:10240
    ds_read_b64_tr_b16 v[122:123], v21 offset:11520
    v_mfma_f32_32x32x16_bf16 v[48:63], v[132:135], v[44:47], v[48:63]
    ds_read_b64_tr_b16 v[124:125], v21 offset:10304
    ds_read_b64_tr_b16 v[126:127], v21 offset:11584
    s_waitcnt lgkmcnt(10)
    s_mov_b64 exec, 1
    ds_add_u32 v147, v145 offset:88
    s_mov_b64 exec, -1
    v_mfma_f32_32x32x16_bf16 v[152:167], v[104:107], v[32:35], v[152:167]
    ds_read_b32 v8, v147 offset:56
    ds_read_b128 v[44:47], v31 offset:256
    ds_read_b64_tr_b16 v[128:129], v21 offset:15360
    v_mfma_f32_32x32x16_bf16 v[48:63], v[108:111], v[32:35], v[48:63]
    ds_read_b64_tr_b16 v[130:131], v21 offset:16640
    ds_read_b64_tr_b16 v[132:133], v21 offset:15424
    ds_read_b64_tr_b16 v[134:135], v21 offset:16704
    s_waitcnt lgkmcnt(5)
    v_cmp_gt_u32 vcc, 1, v8
    v_mfma_f32_32x32x16_bf16 v[152:167], v[112:115], v[36:39], v[152:167]
    s_nop 3
    s_cbranch_vccnz parallel_sum__grouped_kv_mqa__mixer_token_mlp__prompt_kernel_cx5
parallel_sum__grouped_kv_mqa__mixer_token_mlp__prompt_kernel_cb5:
    ds_read_b128 v[32:35], v24 offset:512
    ds_read_b64_tr_b16 v[104:105], v20 offset:0
    ds_read_b64_tr_b16 v[106:107], v20 offset:1280
    v_mfma_f32_32x32x16_bf16 v[48:63], v[116:119], v[36:39], v[48:63]
    ds_read_b64_tr_b16 v[108:109], v20 offset:64
    ds_read_b64_tr_b16 v[110:111], v20 offset:1344
    s_waitcnt lgkmcnt(10)
    v_mfma_f32_32x32x16_bf16 v[152:167], v[120:123], v[40:43], v[152:167]
    ds_read_b128 v[36:39], v25 offset:512
    ds_read_b64_tr_b16 v[112:113], v20 offset:5120
    ds_read_b64_tr_b16 v[114:115], v20 offset:6400
    v_mfma_f32_32x32x16_bf16 v[48:63], v[124:127], v[40:43], v[48:63]
    ds_read_b64_tr_b16 v[116:117], v20 offset:5184
    ds_read_b64_tr_b16 v[118:119], v20 offset:6464
    s_waitcnt lgkmcnt(10)
    v_mfma_f32_32x32x16_bf16 v[152:167], v[128:131], v[44:47], v[152:167]
    ds_read_b128 v[40:43], v26 offset:512
    ds_read_b64_tr_b16 v[120:121], v20 offset:10240
    ds_read_b64_tr_b16 v[122:123], v20 offset:11520
    v_mfma_f32_32x32x16_bf16 v[48:63], v[132:135], v[44:47], v[48:63]
    ds_read_b64_tr_b16 v[124:125], v20 offset:10304
    ds_read_b64_tr_b16 v[126:127], v20 offset:11584
    s_waitcnt lgkmcnt(10)
    s_mov_b64 exec, 1
    ds_add_u32 v147, v145 offset:92
    s_mov_b64 exec, -1
    v_mfma_f32_32x32x16_bf16 v[152:167], v[104:107], v[32:35], v[152:167]
    ds_read_b32 v8, v147 offset:60
    ds_read_b128 v[44:47], v27 offset:512
    ds_read_b64_tr_b16 v[128:129], v20 offset:15360
    v_mfma_f32_32x32x16_bf16 v[48:63], v[108:111], v[32:35], v[48:63]
    ds_read_b64_tr_b16 v[130:131], v20 offset:16640
    ds_read_b64_tr_b16 v[132:133], v20 offset:15424
    ds_read_b64_tr_b16 v[134:135], v20 offset:16704
    s_waitcnt lgkmcnt(5)
    v_cmp_gt_u32 vcc, 1, v8
    v_mfma_f32_32x32x16_bf16 v[152:167], v[112:115], v[36:39], v[152:167]
    s_nop 3
    s_cbranch_vccnz parallel_sum__grouped_kv_mqa__mixer_token_mlp__prompt_kernel_cx6
parallel_sum__grouped_kv_mqa__mixer_token_mlp__prompt_kernel_cb6:
    ds_read_b128 v[32:35], v28 offset:512
    ds_read_b64_tr_b16 v[104:105], v20 offset:20480
    ds_read_b64_tr_b16 v[106:107], v20 offset:21760
    v_mfma_f32_32x32x16_bf16 v[48:63], v[116:119], v[36:39], v[48:63]
    ds_read_b64_tr_b16 v[108:109], v20 offset:20544
    ds_read_b64_tr_b16 v[110:111], v20 offset:21824
    s_waitcnt lgkmcnt(10)
    v_mfma_f32_32x32x16_bf16 v[152:167], v[120:123], v[40:43], v[152:167]
    ds_read_b128 v[36:39], v29 offset:512
    ds_read_b64_tr_b16 v[112:113], v20 offset:25600
    ds_read_b64_tr_b16 v[114:115], v20 offset:26880
    v_mfma_f32_32x32x16_bf16 v[48:63], v[124:127], v[40:43], v[48:63]
    ds_read_b64_tr_b16 v[116:117], v20 offset:25664
    ds_read_b64_tr_b16 v[118:119], v20 offset:26944
    s_waitcnt lgkmcnt(10)
    v_mfma_f32_32x32x16_bf16 v[152:167], v[128:131], v[44:47], v[152:167]
    ds_read_b128 v[40:43], v30 offset:512
    ds_read_b64_tr_b16 v[120:121], v20 offset:30720
    ds_read_b64_tr_b16 v[122:123], v20 offset:32000
    v_mfma_f32_32x32x16_bf16 v[48:63], v[132:135], v[44:47], v[48:63]
    ds_read_b64_tr_b16 v[124:125], v20 offset:30784
    ds_read_b64_tr_b16 v[126:127], v20 offset:32064
    s_waitcnt lgkmcnt(10)
    s_mov_b64 exec, 1
    ds_add_u32 v147, v145 offset:96
    s_mov_b64 exec, -1
    v_mfma_f32_32x32x16_bf16 v[152:167], v[104:107], v[32:35], v[152:167]
    ds_read_b32 v8, v147 offset:64
    ds_read_b128 v[44:47], v31 offset:512
    ds_read_b64_tr_b16 v[128:129], v20 offset:35840
    v_mfma_f32_32x32x16_bf16 v[48:63], v[108:111], v[32:35], v[48:63]
    ds_read_b64_tr_b16 v[130:131], v20 offset:37120
    ds_read_b64_tr_b16 v[132:133], v20 offset:35904
    ds_read_b64_tr_b16 v[134:135], v20 offset:37184
    s_waitcnt lgkmcnt(5)
    v_cmp_gt_u32 vcc, 1, v8
    v_mfma_f32_32x32x16_bf16 v[152:167], v[112:115], v[36:39], v[152:167]
    s_nop 3
    s_cbranch_vccnz parallel_sum__grouped_kv_mqa__mixer_token_mlp__prompt_kernel_cx7
parallel_sum__grouped_kv_mqa__mixer_token_mlp__prompt_kernel_cb7:
    ds_read_b128 v[32:35], v24 offset:768
    ds_read_b64_tr_b16 v[104:105], v20 offset:40960
    ds_read_b64_tr_b16 v[106:107], v20 offset:42240
    v_mfma_f32_32x32x16_bf16 v[48:63], v[116:119], v[36:39], v[48:63]
    ds_read_b64_tr_b16 v[108:109], v20 offset:41024
    ds_read_b64_tr_b16 v[110:111], v20 offset:42304
    s_waitcnt lgkmcnt(10)
    v_mfma_f32_32x32x16_bf16 v[152:167], v[120:123], v[40:43], v[152:167]
    ds_read_b128 v[36:39], v25 offset:768
    ds_read_b64_tr_b16 v[112:113], v20 offset:46080
    ds_read_b64_tr_b16 v[114:115], v20 offset:47360
    v_mfma_f32_32x32x16_bf16 v[48:63], v[124:127], v[40:43], v[48:63]
    ds_read_b64_tr_b16 v[116:117], v20 offset:46144
    ds_read_b64_tr_b16 v[118:119], v20 offset:47424
    s_waitcnt lgkmcnt(10)
    v_mfma_f32_32x32x16_bf16 v[152:167], v[128:131], v[44:47], v[152:167]
    ds_read_b128 v[40:43], v26 offset:768
    ds_read_b64_tr_b16 v[120:121], v20 offset:51200
    ds_read_b64_tr_b16 v[122:123], v20 offset:52480
    v_mfma_f32_32x32x16_bf16 v[48:63], v[132:135], v[44:47], v[48:63]
    ds_read_b64_tr_b16 v[124:125], v20 offset:51264
    ds_read_b64_tr_b16 v[126:127], v20 offset:52544
    s_waitcnt lgkmcnt(10)
    s_mov_b64 exec, 1
    ds_add_u32 v147, v145 offset:100
    s_mov_b64 exec, -1
    v_mfma_f32_32x32x16_bf16 v[152:167], v[104:107], v[32:35], v[152:167]
    ds_read_b32 v8, v147 offset:68
    ds_read_b128 v[44:47], v27 offset:768
    ds_read_b64_tr_b16 v[128:129], v20 offset:56320
    v_mfma_f32_32x32x16_bf16 v[48:63], v[108:111], v[32:35], v[48:63]
    ds_read_b64_tr_b16 v[130:131], v20 offset:57600
    ds_read_b64_tr_b16 v[132:133], v20 offset:56384
    ds_read_b64_tr_b16 v[134:135], v20 offset:57664
    s_waitcnt lgkmcnt(5)
    v_cmp_gt_u32 vcc, 1, v8
    v_mfma_f32_32x32x16_bf16 v[152:167], v[112:115], v[36:39], v[152:167]
    s_nop 3
    s_cbranch_vccnz parallel_sum__grouped_kv_mqa__mixer_token_mlp__prompt_kernel_cx8
parallel_sum__grouped_kv_mqa__mixer_token_mlp__prompt_kernel_cb8:
    ds_read_b128 v[32:35], v28 offset:768
    ds_read_b64_tr_b16 v[104:105], v21 offset:0
    ds_read_b64_tr_b16 v[106:107], v21 offset:1280
    v_mfma_f32_32x32x16_bf16 v[48:63], v[116:119], v[36:39], v[48:63]
    ds_read_b64_tr_b16 v[108:109], v21 offset:64
    ds_read_b64_tr_b16 v[110:111], v21 offset:1344
    s_waitcnt lgkmcnt(10)
    v_mfma_f32_32x32x16_bf16 v[152:167], v[120:123], v[40:43], v[152:167]
    ds_read_b128 v[36:39], v29 offset:768
    ds_read_b64_tr_b16 v[112:113], v21 offset:5120
    ds_read_b64_tr_b16 v[114:115], v21 offset:6400
    v_mfma_f32_32x32x16_bf16 v[48:63], v[124:127], v[40:43], v[48:63]
    ds_read_b64_tr_b16 v[116:117], v21 offset:5184
    ds_read_b64_tr_b16 v[118:119], v21 offset:6464
    s_waitcnt lgkmcnt(10)
    v_mfma_f32_32x32x16_bf16 v[152:167], v[128:131], v[44:47], v[152:167]
    ds_read_b128 v[40:43], v30 offset:768
    ds_read_b64_tr_b16 v[120:121], v21 offset:10240
    ds_read_b64_tr_b16 v[122:123], v21 offset:11520
    v_mfma_f32_32x32x16_bf16 v[48:63], v[132:135], v[44:47], v[48:63]
    ds_read_b64_tr_b16 v[124:125], v21 offset:10304
    ds_read_b64_tr_b16 v[126:127], v21 offset:11584
    s_waitcnt lgkmcnt(10)
    v_mfma_f32_32x32x16_bf16 v[152:167], v[104:107], v[32:35], v[152:167]
    ds_read_b32 v8, v147 offset:72
    ds_read_b128 v[44:47], v31 offset:768
    ds_read_b64_tr_b16 v[128:129], v21 offset:15360
    v_mfma_f32_32x32x16_bf16 v[48:63], v[108:111], v[32:35], v[48:63]
    ds_read_b64_tr_b16 v[130:131], v21 offset:16640
    ds_read_b64_tr_b16 v[132:133], v21 offset:15424
    ds_read_b64_tr_b16 v[134:135], v21 offset:16704
    s_waitcnt lgkmcnt(5)
    v_cmp_gt_u32 vcc, 1, v8
    v_mfma_f32_32x32x16_bf16 v[152:167], v[112:115], v[36:39], v[152:167]
    s_nop 3
    s_cbranch_vccnz parallel_sum__grouped_kv_mqa__mixer_token_mlp__prompt_kernel_cx9
parallel_sum__grouped_kv_mqa__mixer_token_mlp__prompt_kernel_cb9:
    ds_read_b128 v[32:35], v24 offset:1024
    ds_read_b64_tr_b16 v[104:105], v20 offset:0
    ds_read_b64_tr_b16 v[106:107], v20 offset:1280
    v_mfma_f32_32x32x16_bf16 v[48:63], v[116:119], v[36:39], v[48:63]
    ds_read_b64_tr_b16 v[108:109], v20 offset:64
    ds_read_b64_tr_b16 v[110:111], v20 offset:1344
    s_waitcnt lgkmcnt(10)
    v_mfma_f32_32x32x16_bf16 v[152:167], v[120:123], v[40:43], v[152:167]
    ds_read_b128 v[36:39], v25 offset:1024
    ds_read_b64_tr_b16 v[112:113], v20 offset:5120
    ds_read_b64_tr_b16 v[114:115], v20 offset:6400
    v_mfma_f32_32x32x16_bf16 v[48:63], v[124:127], v[40:43], v[48:63]
    ds_read_b64_tr_b16 v[116:117], v20 offset:5184
    ds_read_b64_tr_b16 v[118:119], v20 offset:6464
    s_waitcnt lgkmcnt(10)
    v_mfma_f32_32x32x16_bf16 v[152:167], v[128:131], v[44:47], v[152:167]
    ds_read_b128 v[40:43], v26 offset:1024
    ds_read_b64_tr_b16 v[120:121], v20 offset:10240
    ds_read_b64_tr_b16 v[122:123], v20 offset:11520
    v_mfma_f32_32x32x16_bf16 v[48:63], v[132:135], v[44:47], v[48:63]
    ds_read_b64_tr_b16 v[124:125], v20 offset:10304
    ds_read_b64_tr_b16 v[126:127], v20 offset:11584
    s_waitcnt lgkmcnt(10)
    v_mfma_f32_32x32x16_bf16 v[152:167], v[104:107], v[32:35], v[152:167]
    ds_read_b32 v8, v147 offset:76
    ds_read_b128 v[44:47], v27 offset:1024
    ds_read_b64_tr_b16 v[128:129], v20 offset:15360
    v_mfma_f32_32x32x16_bf16 v[48:63], v[108:111], v[32:35], v[48:63]
    ds_read_b64_tr_b16 v[130:131], v20 offset:16640
    ds_read_b64_tr_b16 v[132:133], v20 offset:15424
    ds_read_b64_tr_b16 v[134:135], v20 offset:16704
    s_waitcnt lgkmcnt(5)
    v_cmp_gt_u32 vcc, 1, v8
    v_mfma_f32_32x32x16_bf16 v[152:167], v[112:115], v[36:39], v[152:167]
    s_nop 3
    s_cbranch_vccnz parallel_sum__grouped_kv_mqa__mixer_token_mlp__prompt_kernel_cx10
parallel_sum__grouped_kv_mqa__mixer_token_mlp__prompt_kernel_cb10:
    ds_read_b128 v[32:35], v28 offset:1024
    ds_read_b64_tr_b16 v[104:105], v20 offset:20480
    ds_read_b64_tr_b16 v[106:107], v20 offset:21760
    v_mfma_f32_32x32x16_bf16 v[48:63], v[116:119], v[36:39], v[48:63]
    ds_read_b64_tr_b16 v[108:109], v20 offset:20544
    ds_read_b64_tr_b16 v[110:111], v20 offset:21824
    s_waitcnt lgkmcnt(10)
    v_mfma_f32_32x32x16_bf16 v[152:167], v[120:123], v[40:43], v[152:167]
    ds_read_b128 v[36:39], v29 offset:1024
    ds_read_b64_tr_b16 v[112:113], v20 offset:25600
    ds_read_b64_tr_b16 v[114:115], v20 offset:26880
    v_mfma_f32_32x32x16_bf16 v[48:63], v[124:127], v[40:43], v[48:63]
    ds_read_b64_tr_b16 v[116:117], v20 offset:25664
    ds_read_b64_tr_b16 v[118:119], v20 offset:26944
    s_waitcnt lgkmcnt(10)
    v_mfma_f32_32x32x16_bf16 v[152:167], v[128:131], v[44:47], v[152:167]
    ds_read_b128 v[40:43], v30 offset:1024
    ds_read_b64_tr_b16 v[120:121], v20 offset:30720
    ds_read_b64_tr_b16 v[122:123], v20 offset:32000
    v_mfma_f32_32x32x16_bf16 v[48:63], v[132:135], v[44:47], v[48:63]
    ds_read_b64_tr_b16 v[124:125], v20 offset:30784
    ds_read_b64_tr_b16 v[126:127], v20 offset:32064
    s_waitcnt lgkmcnt(10)
    v_mfma_f32_32x32x16_bf16 v[152:167], v[104:107], v[32:35], v[152:167]
    ds_read_b128 v[44:47], v31 offset:1024
    ds_read_b64_tr_b16 v[128:129], v20 offset:35840
    ds_read_b64_tr_b16 v[130:131], v20 offset:37120
    v_mfma_f32_32x32x16_bf16 v[48:63], v[108:111], v[32:35], v[48:63]
    ds_read_b64_tr_b16 v[132:133], v20 offset:35904
    ds_read_b64_tr_b16 v[134:135], v20 offset:37184
    s_waitcnt lgkmcnt(10)
    v_mfma_f32_32x32x16_bf16 v[152:167], v[112:115], v[36:39], v[152:167]
    v_mfma_f32_32x32x16_bf16 v[48:63], v[116:119], v[36:39], v[48:63]
    s_waitcnt lgkmcnt(5)
    v_mfma_f32_32x32x16_bf16 v[152:167], v[120:123], v[40:43], v[152:167]
    v_mfma_f32_32x32x16_bf16 v[48:63], v[124:127], v[40:43], v[48:63]
    s_waitcnt lgkmcnt(0)
    v_mfma_f32_32x32x16_bf16 v[152:167], v[128:131], v[44:47], v[152:167]
    v_mfma_f32_32x32x16_bf16 v[48:63], v[132:135], v[44:47], v[48:63]
    s_mov_b64 exec, 1
    ds_add_u32 v147, v145 offset:24
    s_mov_b64 exec, -1
    v_mov_b32 v22, 0x3ea52b5c
    v_mov_b32 v23, 0x3ea52b5c
    s_nop 7
    v_pk_mul_f32 v[152:153], v[152:153], v[22:23]
    v_pk_mul_f32 v[154:155], v[154:155], v[22:23]
    v_cvt_pk_bf16_f32 v8, v152, v153
    v_cvt_pk_bf16_f32 v9, v154, v155
    v_pk_mul_f32 v[156:157], v[156:157], v[22:23]
    v_pk_mul_f32 v[158:159], v[158:159], v[22:23]
    v_cvt_pk_bf16_f32 v10, v156, v157
    v_cvt_pk_bf16_f32 v11, v158, v159
    v_pk_mul_f32 v[160:161], v[160:161], v[22:23]
    v_pk_mul_f32 v[162:163], v[162:163], v[22:23]
    v_cvt_pk_bf16_f32 v16, v160, v161
    v_cvt_pk_bf16_f32 v17, v162, v163
    v_pk_mul_f32 v[164:165], v[164:165], v[22:23]
    v_pk_mul_f32 v[166:167], v[166:167], v[22:23]
    v_cvt_pk_bf16_f32 v32, v164, v165
    v_cvt_pk_bf16_f32 v33, v166, v167
    v_pk_mul_f32 v[48:49], v[48:49], v[22:23]
    v_pk_mul_f32 v[50:51], v[50:51], v[22:23]
    v_cvt_pk_bf16_f32 v34, v48, v49
    v_cvt_pk_bf16_f32 v35, v50, v51
    s_nop 1
    v_permlane32_swap_b32 v12, v32
    v_permlane32_swap_b32 v14, v34
    v_permlane32_swap_b32 v13, v33
    v_permlane32_swap_b32 v15, v35
    s_nop 1
    v_permlane32_swap_b32 v16, v12
    v_permlane32_swap_b32 v32, v14
    v_permlane32_swap_b32 v34, v18
    v_permlane32_swap_b32 v17, v13
    v_permlane32_swap_b32 v33, v15
    v_permlane32_swap_b32 v35, v19
    s_nop 0
    v_cndmask_b32_e64 v16, v16, 0, s[22:23]
    v_cndmask_b32_e64 v17, v17, 0, s[22:23]
    v_cndmask_b32_e64 v18, v18, 0, s[22:23]
    v_cndmask_b32_e64 v19, v19, 0, s[22:23]
    v_dot2_f32_bf16 v134, v8, v8, 0
    v_dot2_f32_bf16 v134, v9, v9, v134
    v_dot2_f32_bf16 v134, v10, v10, v134
    v_dot2_f32_bf16 v134, v11, v11, v134
    v_dot2_f32_bf16 v134, v16, v16, v134
    v_dot2_f32_bf16 v134, v17, v17, v134
    v_dot2_f32_bf16 v136, v12, v12, 0
    v_dot2_f32_bf16 v136, v13, v13, v136
    v_dot2_f32_bf16 v136, v14, v14, v136
    v_dot2_f32_bf16 v136, v15, v15, v136
    v_dot2_f32_bf16 v136, v18, v18, v136
    v_dot2_f32_bf16 v136, v19, v19, v136
    v_mov_b32 v96, 0
    v_mov_b32 v97, 0
    v_mov_b32 v98, 0
    v_mov_b32 v135, v134
    v_mov_b32 v99, 0
    v_mov_b32 v137, v136
    v_mov_b32 v100, 0
    v_mov_b32 v101, 0
    v_mov_b32 v102, 0
    v_permlane32_swap_b32 v134, v135
    v_mov_b32 v103, 0
    v_permlane32_swap_b32 v136, v137
    v_mov_b32 v104, 0
    v_mov_b32 v105, 0
    v_mov_b32 v106, 0
    v_add_f32 v134, v134, v135
    v_mov_b32 v107, 0
    v_add_f32 v136, v136, v137
    v_mov_b32 v108, 0
    v_mov_b32 v109, 0
    v_mov_b32 v110, 0
    v_mov_b32 v111, 0
    v_mov_b32 v112, 0
    v_mov_b32 v113, 0
    v_mov_b32 v114, 0
    v_mov_b32 v115, 0
    v_mov_b32 v116, 0
    v_mov_b32 v117, 0
    v_mov_b32 v118, 0
    v_mov_b32 v119, 0
    v_mov_b32 v120, 0
    v_mov_b32 v121, 0
    v_mov_b32 v122, 0
    v_mov_b32 v123, 0
    v_mov_b32 v124, 0
    v_mov_b32 v125, 0
    v_mov_b32 v126, 0
    v_mov_b32 v127, 0
    v_mov_b32 v56, 0
    v_mov_b32 v40, 0
    v_mov_b32 v57, 0
    v_mov_b32 v41, 0
    v_mov_b32 v58, 0
    v_mov_b32 v42, 0
    v_mov_b32 v59, 0
    v_mov_b32 v43, 0
    v_mov_b32 v60, 0
    v_mov_b32 v44, 0
    v_mov_b32 v61, 0
    v_mov_b32 v45, 0
    v_mov_b32 v62, 0
    v_mov_b32 v46, 0
    v_mov_b32 v63, 0
    v_mov_b32 v47, 0
parallel_sum__grouped_kv_mqa__mixer_token_mlp__prompt_kernel_lw11:
    ds_read_b32 v146, v147 offset:0
    s_waitcnt lgkmcnt(0)
    v_cmp_gt_u32 s[84:85], 1, v146
    s_nop 1
    s_cmp_eq_u64 s[84:85], 0
    s_cbranch_scc0 parallel_sum__grouped_kv_mqa__mixer_token_mlp__prompt_kernel_lx11
    ds_read_b32 v132, v147 offset:20
    ds_read_b128 v[20:23], v1 offset:0
    ds_read_b64 v[28:29], v3 offset:0
    s_waitcnt lgkmcnt(2)
    v_mul_f32 v134, v134, v132
    v_mul_f32 v136, v136, v132
    v_sqrt_f32 v134, v134
    v_sqrt_f32 v136, v136
    s_nop 0
    v_max_f32 v132, v134, v136
    v_cvt_pk_bf16_f32 v135, -v134, 0
    v_cvt_pk_bf16_f32 v137, -v136, 0
    v_mov_b32 v133, 0x42400000
    v_cmp_nle_f32 s[20:21], v132, v133
    v_cndmask_b32_e64 v16, v16, v135, s[22:23]
    v_cndmask_b32_e64 v18, v18, v137, s[22:23]
    s_setprio 0
    s_mov_b32 s19, 1
    s_cmp_lg_u64 s[20:21], 0
    s_cbranch_scc1 parallel_sum__grouped_kv_mqa__mixer_token_mlp__prompt_kernel_slow
    s_waitcnt lgkmcnt(0)
    v_mfma_f32_32x32x16_bf16 v[64:79], v[20:23], v[8:11], 0
    v_mfma_f32_32x32x8_bf16 v[64:79], v[28:29], v[16:17], v[64:79]
    ds_read_b128 v[24:27], v1 offset:3072
    ds_read_b64 v[30:31], v3 offset:3072
    ds_read_b128 v[32:35], v2 offset:0
    ds_read_b128 v[36:39], v2 offset:896
    s_nop 7
.p2align 6
parallel_sum__grouped_kv_mqa__mixer_token_mlp__prompt_kernel_loop:
    v_mfma_f32_32x32x16_bf16 v[80:95], v[20:23], v[12:15], 0
    s_mov_b64 exec, 1
    ds_add_u32 v147, v145 offset:120
    s_mov_b64 exec, -1
    v_exp_f32 v64, v64
    v_exp_f32 v65, v65
    v_exp_f32 v66, v66
    v_exp_f32 v67, v67
    v_cvt_pk_bf16_f32 v48, v64, v65
    v_cvt_pk_bf16_f32 v49, v66, v67
    v_mfma_f32_32x32x8_bf16 v[80:95], v[28:29], v[18:19], v[80:95]
    v_exp_f32 v68, v68
    v_exp_f32 v69, v69
    v_exp_f32 v70, v70
    v_exp_f32 v71, v71
    v_cvt_pk_bf16_f32 v50, v68, v69
    v_cvt_pk_bf16_f32 v51, v70, v71
    v_mfma_f32_32x32x16_bf16 v[112:127], v[40:43], v[56:59], v[112:127]
    ds_read_b64 v[28:29], v3 offset:6144
    v_exp_f32 v72, v72
    v_exp_f32 v73, v73
    v_exp_f32 v74, v74
    v_exp_f32 v75, v75
    v_cvt_pk_bf16_f32 v52, v72, v73
    v_cvt_pk_bf16_f32 v53, v74, v75
    v_mfma_f32_32x32x16_bf16 v[112:127], v[44:47], v[60:63], v[112:127]
    s_waitcnt lgkmcnt(0)
    v_exp_f32_e64 v76, v76
    v_exp_f32 v77, v77
    v_exp_f32 v78, v78
    v_exp_f32 v79, v79
    v_cvt_pk_bf16_f32 v54, v76, v77
    v_cvt_pk_bf16_f32 v55, v78, v79
    v_mfma_f32_32x32x16_bf16 v[64:79], v[24:27], v[8:11], 0
    ds_read_b128 v[20:23], v1 offset:6144
    v_exp_f32 v80, v80
    v_exp_f32 v81, v81
    v_exp_f32 v82, v82
    v_exp_f32 v83, v83
    v_cvt_pk_bf16_f32 v56, v80, v81
    v_cvt_pk_bf16_f32 v57, v82, v83
    v_mfma_f32_32x32x8_bf16 v[64:79], v[30:31], v[16:17], v[64:79]
    v_exp_f32 v84, v84
    v_exp_f32 v85, v85
    v_exp_f32 v86, v86
    v_exp_f32 v87, v87
    v_cvt_pk_bf16_f32 v58, v84, v85
    v_cvt_pk_bf16_f32 v59, v86, v87
    v_mfma_f32_32x32x16_bf16 v[96:111], v[32:35], v[48:51], v[96:111]
    ds_read_b128 v[40:43], v2 offset:3072
    v_exp_f32 v88, v88
    v_exp_f32 v89, v89
    v_exp_f32 v90, v90
    v_exp_f32 v91, v91
    v_cvt_pk_bf16_f32 v60, v88, v89
    v_cvt_pk_bf16_f32 v61, v90, v91
    v_mfma_f32_32x32x16_bf16 v[96:111], v[36:39], v[52:55], v[96:111]
    ds_read_b128 v[44:47], v2 offset:3968
    v_exp_f32 v92, v92
    v_exp_f32 v93, v93
    v_exp_f32 v94, v94
    v_exp_f32 v95, v95
    v_cvt_pk_bf16_f32 v62, v92, v93
    v_cvt_pk_bf16_f32 v63, v94, v95
    v_mfma_f32_32x32x16_bf16 v[80:95], v[24:27], v[12:15], 0
    ds_read_b32 v146, v147 offset:4
    v_exp_f32 v64, v64
    v_exp_f32 v65, v65
    v_exp_f32 v66, v66
    v_exp_f32 v67, v67
    v_cvt_pk_bf16_f32 v48, v64, v65
    v_cvt_pk_bf16_f32 v49, v66, v67
    v_mfma_f32_32x32x8_bf16 v[80:95], v[30:31], v[18:19], v[80:95]
    v_exp_f32 v68, v68
    v_exp_f32 v69, v69
    v_exp_f32 v70, v70
    v_exp_f32 v71, v71
    v_cvt_pk_bf16_f32 v50, v68, v69
    v_cvt_pk_bf16_f32 v51, v70, v71
    v_mfma_f32_32x32x16_bf16 v[112:127], v[32:35], v[56:59], v[112:127]
    ds_read_b64 v[30:31], v3 offset:9216
    v_exp_f32 v72, v72
    v_exp_f32 v73, v73
    v_exp_f32 v74, v74
    v_exp_f32 v75, v75
    v_cvt_pk_bf16_f32 v52, v72, v73
    v_cvt_pk_bf16_f32 v53, v74, v75
    v_mfma_f32_32x32x16_bf16 v[112:127], v[36:39], v[60:63], v[112:127]
    s_waitcnt lgkmcnt(0)
    v_exp_f32_e64 v76, v76
    v_exp_f32 v77, v77
    v_exp_f32 v78, v78
    v_exp_f32 v79, v79
    v_cvt_pk_bf16_f32 v54, v76, v77
    v_cvt_pk_bf16_f32 v55, v78, v79
    v_mfma_f32_32x32x16_bf16 v[64:79], v[20:23], v[8:11], 0
    ds_read_b128 v[24:27], v1 offset:9216
    v_exp_f32 v80, v80
    v_exp_f32 v81, v81
    v_exp_f32 v82, v82
    v_exp_f32 v83, v83
    v_cvt_pk_bf16_f32 v56, v80, v81
    v_cvt_pk_bf16_f32 v57, v82, v83
    v_mfma_f32_32x32x8_bf16 v[64:79], v[28:29], v[16:17], v[64:79]
    v_cmp_gt_u32 vcc, s19, v146
    v_exp_f32_e64 v84, v84
    v_exp_f32 v85, v85
    v_exp_f32 v86, v86
    v_exp_f32 v87, v87
    v_cvt_pk_bf16_f32 v58, v84, v85
    v_cvt_pk_bf16_f32 v59, v86, v87
    v_mfma_f32_32x32x16_bf16 v[96:111], v[40:43], v[48:51], v[96:111]
    ds_read_b128 v[32:35], v2 offset:6144
    v_exp_f32 v88, v88
    v_exp_f32 v89, v89
    v_exp_f32 v90, v90
    v_exp_f32 v91, v91
    v_cvt_pk_bf16_f32 v60, v88, v89
    v_cvt_pk_bf16_f32 v61, v90, v91
    v_mfma_f32_32x32x16_bf16 v[96:111], v[44:47], v[52:55], v[96:111]
    ds_read_b128 v[36:39], v2 offset:7040
    v_exp_f32 v92, v92
    v_exp_f32 v93, v93
    v_exp_f32 v94, v94
    v_exp_f32 v95, v95
    v_cvt_pk_bf16_f32 v62, v92, v93
    v_cvt_pk_bf16_f32 v63, v94, v95
    v_mfma_f32_32x32x16_bf16 v[80:95], v[20:23], v[12:15], 0
    s_cbranch_vccnz parallel_sum__grouped_kv_mqa__mixer_token_mlp__prompt_kernel_spin0
parallel_sum__grouped_kv_mqa__mixer_token_mlp__prompt_kernel_back0:
    v_exp_f32_e64 v64, v64
    v_exp_f32 v65, v65
    v_exp_f32 v66, v66
    v_exp_f32 v67, v67
    v_cvt_pk_bf16_f32 v48, v64, v65
    v_cvt_pk_bf16_f32 v49, v66, v67
    v_mfma_f32_32x32x8_bf16 v[80:95], v[28:29], v[18:19], v[80:95]
    v_exp_f32 v68, v68
    v_exp_f32 v69, v69
    v_exp_f32 v70, v70
    v_exp_f32 v71, v71
    v_cvt_pk_bf16_f32 v50, v68, v69
    v_cvt_pk_bf16_f32 v51, v70, v71
    v_mfma_f32_32x32x16_bf16 v[112:127], v[40:43], v[56:59], v[112:127]
    ds_read_b64 v[28:29], v3 offset:12288
    v_exp_f32 v72, v72
    v_exp_f32 v73, v73
    v_exp_f32 v74, v74
    v_exp_f32 v75, v75
    v_cvt_pk_bf16_f32 v52, v72, v73
    v_cvt_pk_bf16_f32 v53, v74, v75
    v_mfma_f32_32x32x16_bf16 v[112:127], v[44:47], v[60:63], v[112:127]
    s_waitcnt lgkmcnt(0)
    v_exp_f32_e64 v76, v76
    v_exp_f32 v77, v77
    v_exp_f32 v78, v78
    v_exp_f32 v79, v79
    v_cvt_pk_bf16_f32 v54, v76, v77
    v_cvt_pk_bf16_f32 v55, v78, v79
    v_mfma_f32_32x32x16_bf16 v[64:79], v[24:27], v[8:11], 0
    ds_read_b128 v[20:23], v1 offset:12288
    v_exp_f32 v80, v80
    v_exp_f32 v81, v81
    v_exp_f32 v82, v82
    v_exp_f32 v83, v83
    v_cvt_pk_bf16_f32 v56, v80, v81
    v_cvt_pk_bf16_f32 v57, v82, v83
    v_mfma_f32_32x32x8_bf16 v[64:79], v[30:31], v[16:17], v[64:79]
    v_exp_f32 v84, v84
    v_exp_f32 v85, v85
    v_exp_f32 v86, v86
    v_exp_f32 v87, v87
    v_cvt_pk_bf16_f32 v58, v84, v85
    v_cvt_pk_bf16_f32 v59, v86, v87
    v_mfma_f32_32x32x16_bf16 v[96:111], v[32:35], v[48:51], v[96:111]
    ds_read_b128 v[40:43], v2 offset:9216
    v_exp_f32 v88, v88
    v_exp_f32 v89, v89
    v_exp_f32 v90, v90
    v_exp_f32 v91, v91
    v_cvt_pk_bf16_f32 v60, v88, v89
    v_cvt_pk_bf16_f32 v61, v90, v91
    v_mfma_f32_32x32x16_bf16 v[96:111], v[36:39], v[52:55], v[96:111]
    ds_read_b128 v[44:47], v2 offset:10112
    v_exp_f32 v92, v92
    v_exp_f32 v93, v93
    v_exp_f32 v94, v94
    v_exp_f32 v95, v95
    v_cvt_pk_bf16_f32 v62, v92, v93
    v_cvt_pk_bf16_f32 v63, v94, v95
    v_mfma_f32_32x32x16_bf16 v[80:95], v[24:27], v[12:15], 0
    v_exp_f32 v64, v64
    v_exp_f32 v65, v65
    v_exp_f32 v66, v66
    v_exp_f32 v67, v67
    v_cvt_pk_bf16_f32 v48, v64, v65
    v_cvt_pk_bf16_f32 v49, v66, v67
    v_mfma_f32_32x32x8_bf16 v[80:95], v[30:31], v[18:19], v[80:95]
    v_exp_f32 v68, v68
    v_exp_f32 v69, v69
    v_exp_f32 v70, v70
    v_exp_f32 v71, v71
    v_cvt_pk_bf16_f32 v50, v68, v69
    v_cvt_pk_bf16_f32 v51, v70, v71
    v_mfma_f32_32x32x16_bf16 v[112:127], v[32:35], v[56:59], v[112:127]
    ds_read_b64 v[30:31], v3 offset:15360
    v_exp_f32 v72, v72
    v_exp_f32 v73, v73
    v_exp_f32 v74, v74
    v_exp_f32 v75, v75
    v_cvt_pk_bf16_f32 v52, v72, v73
    v_cvt_pk_bf16_f32 v53, v74, v75
    v_mfma_f32_32x32x16_bf16 v[112:127], v[36:39], v[60:63], v[112:127]
    s_waitcnt lgkmcnt(0)
    v_exp_f32_e64 v76, v76
    v_exp_f32 v77, v77
    v_exp_f32 v78, v78
    v_exp_f32 v79, v79
    v_cvt_pk_bf16_f32 v54, v76, v77
    v_cvt_pk_bf16_f32 v55, v78, v79
    v_mfma_f32_32x32x16_bf16 v[64:79], v[20:23], v[8:11], 0
    ds_read_b128 v[24:27], v1 offset:15360
    v_exp_f32 v80, v80
    v_exp_f32 v81, v81
    v_exp_f32 v82, v82
    v_exp_f32 v83, v83
    v_cvt_pk_bf16_f32 v56, v80, v81
    v_cvt_pk_bf16_f32 v57, v82, v83
    v_mfma_f32_32x32x8_bf16 v[64:79], v[28:29], v[16:17], v[64:79]
    v_exp_f32 v84, v84
    v_exp_f32 v85, v85
    v_exp_f32 v86, v86
    v_exp_f32 v87, v87
    v_cvt_pk_bf16_f32 v58, v84, v85
    v_cvt_pk_bf16_f32 v59, v86, v87
    v_mfma_f32_32x32x16_bf16 v[96:111], v[40:43], v[48:51], v[96:111]
    ds_read_b128 v[32:35], v2 offset:12288
    v_exp_f32 v88, v88
    v_exp_f32 v89, v89
    v_exp_f32 v90, v90
    v_exp_f32 v91, v91
    v_cvt_pk_bf16_f32 v60, v88, v89
    v_cvt_pk_bf16_f32 v61, v90, v91
    v_mfma_f32_32x32x16_bf16 v[96:111], v[44:47], v[52:55], v[96:111]
    ds_read_b128 v[36:39], v2 offset:13184
    v_exp_f32 v92, v92
    v_exp_f32 v93, v93
    v_exp_f32 v94, v94
    v_exp_f32 v95, v95
    v_cvt_pk_bf16_f32 v62, v92, v93
    v_cvt_pk_bf16_f32 v63, v94, v95
    v_mfma_f32_32x32x16_bf16 v[80:95], v[20:23], v[12:15], 0
    s_mov_b64 exec, 1
    ds_add_u32 v147, v145 offset:124
    s_mov_b64 exec, -1
    v_exp_f32 v64, v64
    v_exp_f32 v65, v65
    v_exp_f32 v66, v66
    v_exp_f32 v67, v67
    v_cvt_pk_bf16_f32 v48, v64, v65
    v_cvt_pk_bf16_f32 v49, v66, v67
    v_mfma_f32_32x32x8_bf16 v[80:95], v[28:29], v[18:19], v[80:95]
    v_exp_f32 v68, v68
    v_exp_f32 v69, v69
    v_exp_f32 v70, v70
    v_exp_f32 v71, v71
    v_cvt_pk_bf16_f32 v50, v68, v69
    v_cvt_pk_bf16_f32 v51, v70, v71
    v_mfma_f32_32x32x16_bf16 v[112:127], v[40:43], v[56:59], v[112:127]
    ds_read_b64 v[28:29], v3 offset:18432
    v_exp_f32 v72, v72
    v_exp_f32 v73, v73
    v_exp_f32 v74, v74
    v_exp_f32 v75, v75
    v_cvt_pk_bf16_f32 v52, v72, v73
    v_cvt_pk_bf16_f32 v53, v74, v75
    v_mfma_f32_32x32x16_bf16 v[112:127], v[44:47], v[60:63], v[112:127]
    s_waitcnt lgkmcnt(0)
    v_exp_f32_e64 v76, v76
    v_exp_f32 v77, v77
    v_exp_f32 v78, v78
    v_exp_f32 v79, v79
    v_cvt_pk_bf16_f32 v54, v76, v77
    v_cvt_pk_bf16_f32 v55, v78, v79
    v_mfma_f32_32x32x16_bf16 v[64:79], v[24:27], v[8:11], 0
    ds_read_b128 v[20:23], v1 offset:18432
    v_exp_f32 v80, v80
    v_exp_f32 v81, v81
    v_exp_f32 v82, v82
    v_exp_f32 v83, v83
    v_cvt_pk_bf16_f32 v56, v80, v81
    v_cvt_pk_bf16_f32 v57, v82, v83
    v_mfma_f32_32x32x8_bf16 v[64:79], v[30:31], v[16:17], v[64:79]
    v_exp_f32 v84, v84
    v_exp_f32 v85, v85
    v_exp_f32 v86, v86
    v_exp_f32 v87, v87
    v_cvt_pk_bf16_f32 v58, v84, v85
    v_cvt_pk_bf16_f32 v59, v86, v87
    v_mfma_f32_32x32x16_bf16 v[96:111], v[32:35], v[48:51], v[96:111]
    ds_read_b128 v[40:43], v2 offset:15360
    v_exp_f32 v88, v88
    v_exp_f32 v89, v89
    v_exp_f32 v90, v90
    v_exp_f32 v91, v91
    v_cvt_pk_bf16_f32 v60, v88, v89
    v_cvt_pk_bf16_f32 v61, v90, v91
    v_mfma_f32_32x32x16_bf16 v[96:111], v[36:39], v[52:55], v[96:111]
    ds_read_b128 v[44:47], v2 offset:16256
    v_exp_f32 v92, v92
    v_exp_f32 v93, v93
    v_exp_f32 v94, v94
    v_exp_f32 v95, v95
    v_cvt_pk_bf16_f32 v62, v92, v93
    v_cvt_pk_bf16_f32 v63, v94, v95
    v_mfma_f32_32x32x16_bf16 v[80:95], v[24:27], v[12:15], 0
    ds_read_b32 v146, v147 offset:8
    v_exp_f32 v64, v64
    v_exp_f32 v65, v65
    v_exp_f32 v66, v66
    v_exp_f32 v67, v67
    v_cvt_pk_bf16_f32 v48, v64, v65
    v_cvt_pk_bf16_f32 v49, v66, v67
    v_mfma_f32_32x32x8_bf16 v[80:95], v[30:31], v[18:19], v[80:95]
    v_exp_f32 v68, v68
    v_exp_f32 v69, v69
    v_exp_f32 v70, v70
    v_exp_f32 v71, v71
    v_cvt_pk_bf16_f32 v50, v68, v69
    v_cvt_pk_bf16_f32 v51, v70, v71
    v_mfma_f32_32x32x16_bf16 v[112:127], v[32:35], v[56:59], v[112:127]
    ds_read_b64 v[30:31], v3 offset:21504
    v_exp_f32 v72, v72
    v_exp_f32 v73, v73
    v_exp_f32 v74, v74
    v_exp_f32 v75, v75
    v_cvt_pk_bf16_f32 v52, v72, v73
    v_cvt_pk_bf16_f32 v53, v74, v75
    v_mfma_f32_32x32x16_bf16 v[112:127], v[36:39], v[60:63], v[112:127]
    s_waitcnt lgkmcnt(0)
    v_exp_f32_e64 v76, v76
    v_exp_f32 v77, v77
    v_exp_f32 v78, v78
    v_exp_f32 v79, v79
    v_cvt_pk_bf16_f32 v54, v76, v77
    v_cvt_pk_bf16_f32 v55, v78, v79
    v_mfma_f32_32x32x16_bf16 v[64:79], v[20:23], v[8:11], 0
    ds_read_b128 v[24:27], v1 offset:21504
    v_exp_f32 v80, v80
    v_exp_f32 v81, v81
    v_exp_f32 v82, v82
    v_exp_f32 v83, v83
    v_cvt_pk_bf16_f32 v56, v80, v81
    v_cvt_pk_bf16_f32 v57, v82, v83
    v_mfma_f32_32x32x8_bf16 v[64:79], v[28:29], v[16:17], v[64:79]
    v_cmp_gt_u32 vcc, s19, v146
    v_exp_f32_e64 v84, v84
    v_exp_f32 v85, v85
    v_exp_f32 v86, v86
    v_exp_f32 v87, v87
    v_cvt_pk_bf16_f32 v58, v84, v85
    v_cvt_pk_bf16_f32 v59, v86, v87
    v_mfma_f32_32x32x16_bf16 v[96:111], v[40:43], v[48:51], v[96:111]
    ds_read_b128 v[32:35], v2 offset:18432
    v_exp_f32 v88, v88
    v_exp_f32 v89, v89
    v_exp_f32 v90, v90
    v_exp_f32 v91, v91
    v_cvt_pk_bf16_f32 v60, v88, v89
    v_cvt_pk_bf16_f32 v61, v90, v91
    v_mfma_f32_32x32x16_bf16 v[96:111], v[44:47], v[52:55], v[96:111]
    ds_read_b128 v[36:39], v2 offset:19328
    v_exp_f32 v92, v92
    v_exp_f32 v93, v93
    v_exp_f32 v94, v94
    v_exp_f32 v95, v95
    v_cvt_pk_bf16_f32 v62, v92, v93
    v_cvt_pk_bf16_f32 v63, v94, v95
    v_mfma_f32_32x32x16_bf16 v[80:95], v[20:23], v[12:15], 0
    s_cbranch_vccnz parallel_sum__grouped_kv_mqa__mixer_token_mlp__prompt_kernel_spin1
parallel_sum__grouped_kv_mqa__mixer_token_mlp__prompt_kernel_back1:
    v_exp_f32_e64 v64, v64
    v_exp_f32 v65, v65
    v_exp_f32 v66, v66
    v_exp_f32 v67, v67
    v_cvt_pk_bf16_f32 v48, v64, v65
    v_cvt_pk_bf16_f32 v49, v66, v67
    v_mfma_f32_32x32x8_bf16 v[80:95], v[28:29], v[18:19], v[80:95]
    v_exp_f32 v68, v68
    v_exp_f32 v69, v69
    v_exp_f32 v70, v70
    v_exp_f32 v71, v71
    v_cvt_pk_bf16_f32 v50, v68, v69
    v_cvt_pk_bf16_f32 v51, v70, v71
    v_mfma_f32_32x32x16_bf16 v[112:127], v[40:43], v[56:59], v[112:127]
    ds_read_b64 v[28:29], v3 offset:24576
    v_exp_f32 v72, v72
    v_exp_f32 v73, v73
    v_exp_f32 v74, v74
    v_exp_f32 v75, v75
    v_cvt_pk_bf16_f32 v52, v72, v73
    v_cvt_pk_bf16_f32 v53, v74, v75
    v_mfma_f32_32x32x16_bf16 v[112:127], v[44:47], v[60:63], v[112:127]
    s_waitcnt lgkmcnt(0)
    v_exp_f32_e64 v76, v76
    v_exp_f32 v77, v77
    v_exp_f32 v78, v78
    v_exp_f32 v79, v79
    v_cvt_pk_bf16_f32 v54, v76, v77
    v_cvt_pk_bf16_f32 v55, v78, v79
    v_mfma_f32_32x32x16_bf16 v[64:79], v[24:27], v[8:11], 0
    ds_read_b128 v[20:23], v1 offset:24576
    v_exp_f32 v80, v80
    v_exp_f32 v81, v81
    v_exp_f32 v82, v82
    v_exp_f32 v83, v83
    v_cvt_pk_bf16_f32 v56, v80, v81
    v_cvt_pk_bf16_f32 v57, v82, v83
    v_mfma_f32_32x32x8_bf16 v[64:79], v[30:31], v[16:17], v[64:79]
    v_exp_f32 v84, v84
    v_exp_f32 v85, v85
    v_exp_f32 v86, v86
    v_exp_f32 v87, v87
    v_cvt_pk_bf16_f32 v58, v84, v85
    v_cvt_pk_bf16_f32 v59, v86, v87
    v_mfma_f32_32x32x16_bf16 v[96:111], v[32:35], v[48:51], v[96:111]
    ds_read_b128 v[40:43], v2 offset:21504
    v_exp_f32 v88, v88
    v_exp_f32 v89, v89
    v_exp_f32 v90, v90
    v_exp_f32 v91, v91
    v_cvt_pk_bf16_f32 v60, v88, v89
    v_cvt_pk_bf16_f32 v61, v90, v91
    v_mfma_f32_32x32x16_bf16 v[96:111], v[36:39], v[52:55], v[96:111]
    ds_read_b128 v[44:47], v2 offset:22400
    v_exp_f32 v92, v92
    v_exp_f32 v93, v93
    v_exp_f32 v94, v94
    v_exp_f32 v95, v95
    v_cvt_pk_bf16_f32 v62, v92, v93
    v_cvt_pk_bf16_f32 v63, v94, v95
    v_mfma_f32_32x32x16_bf16 v[80:95], v[24:27], v[12:15], 0
    v_exp_f32 v64, v64
    v_exp_f32 v65, v65
    v_exp_f32 v66, v66
    v_exp_f32 v67, v67
    v_cvt_pk_bf16_f32 v48, v64, v65
    v_cvt_pk_bf16_f32 v49, v66, v67
    v_mfma_f32_32x32x8_bf16 v[80:95], v[30:31], v[18:19], v[80:95]
    v_exp_f32 v68, v68
    v_exp_f32 v69, v69
    v_exp_f32 v70, v70
    v_exp_f32 v71, v71
    v_cvt_pk_bf16_f32 v50, v68, v69
    v_cvt_pk_bf16_f32 v51, v70, v71
    v_mfma_f32_32x32x16_bf16 v[112:127], v[32:35], v[56:59], v[112:127]
    ds_read_b64 v[30:31], v3 offset:27648
    v_exp_f32 v72, v72
    v_exp_f32 v73, v73
    v_exp_f32 v74, v74
    v_exp_f32 v75, v75
    v_cvt_pk_bf16_f32 v52, v72, v73
    v_cvt_pk_bf16_f32 v53, v74, v75
    v_mfma_f32_32x32x16_bf16 v[112:127], v[36:39], v[60:63], v[112:127]
    s_waitcnt lgkmcnt(0)
    v_exp_f32_e64 v76, v76
    v_exp_f32 v77, v77
    v_exp_f32 v78, v78
    v_exp_f32 v79, v79
    v_cvt_pk_bf16_f32 v54, v76, v77
    v_cvt_pk_bf16_f32 v55, v78, v79
    v_mfma_f32_32x32x16_bf16 v[64:79], v[20:23], v[8:11], 0
    ds_read_b128 v[24:27], v1 offset:27648
    v_exp_f32 v80, v80
    v_exp_f32 v81, v81
    v_exp_f32 v82, v82
    v_exp_f32 v83, v83
    v_cvt_pk_bf16_f32 v56, v80, v81
    v_cvt_pk_bf16_f32 v57, v82, v83
    v_mfma_f32_32x32x8_bf16 v[64:79], v[28:29], v[16:17], v[64:79]
    v_exp_f32 v84, v84
    v_exp_f32 v85, v85
    v_exp_f32 v86, v86
    v_exp_f32 v87, v87
    v_cvt_pk_bf16_f32 v58, v84, v85
    v_cvt_pk_bf16_f32 v59, v86, v87
    v_mfma_f32_32x32x16_bf16 v[96:111], v[40:43], v[48:51], v[96:111]
    ds_read_b128 v[32:35], v2 offset:24576
    v_exp_f32 v88, v88
    v_exp_f32 v89, v89
    v_exp_f32 v90, v90
    v_exp_f32 v91, v91
    v_cvt_pk_bf16_f32 v60, v88, v89
    v_cvt_pk_bf16_f32 v61, v90, v91
    v_mfma_f32_32x32x16_bf16 v[96:111], v[44:47], v[52:55], v[96:111]
    ds_read_b128 v[36:39], v2 offset:25472
    v_exp_f32 v92, v92
    v_exp_f32 v93, v93
    v_exp_f32 v94, v94
    v_exp_f32 v95, v95
    v_cvt_pk_bf16_f32 v62, v92, v93
    v_cvt_pk_bf16_f32 v63, v94, v95
    v_mfma_f32_32x32x16_bf16 v[80:95], v[20:23], v[12:15], 0
    s_mov_b64 exec, 1
    ds_add_u32 v147, v145 offset:128
    s_mov_b64 exec, -1
    v_exp_f32 v64, v64
    v_exp_f32 v65, v65
    v_exp_f32 v66, v66
    v_exp_f32 v67, v67
    v_cvt_pk_bf16_f32 v48, v64, v65
    v_cvt_pk_bf16_f32 v49, v66, v67
    v_mfma_f32_32x32x8_bf16 v[80:95], v[28:29], v[18:19], v[80:95]
    v_exp_f32 v68, v68
    v_exp_f32 v69, v69
    v_exp_f32 v70, v70
    v_exp_f32 v71, v71
    v_cvt_pk_bf16_f32 v50, v68, v69
    v_cvt_pk_bf16_f32 v51, v70, v71
    v_mfma_f32_32x32x16_bf16 v[112:127], v[40:43], v[56:59], v[112:127]
    ds_read_b64 v[28:29], v3 offset:30720
    v_exp_f32 v72, v72
    v_exp_f32 v73, v73
    v_exp_f32 v74, v74
    v_exp_f32 v75, v75
    v_cvt_pk_bf16_f32 v52, v72, v73
    v_cvt_pk_bf16_f32 v53, v74, v75
    v_mfma_f32_32x32x16_bf16 v[112:127], v[44:47], v[60:63], v[112:127]
    s_waitcnt lgkmcnt(0)
    v_exp_f32_e64 v76, v76
    v_exp_f32 v77, v77
    v_exp_f32 v78, v78
    v_exp_f32 v79, v79
    v_cvt_pk_bf16_f32 v54, v76, v77
    v_cvt_pk_bf16_f32 v55, v78, v79
    v_mfma_f32_32x32x16_bf16 v[64:79], v[24:27], v[8:11], 0
    ds_read_b128 v[20:23], v1 offset:30720
    v_exp_f32 v80, v80
    v_exp_f32 v81, v81
    v_exp_f32 v82, v82
    v_exp_f32 v83, v83
    v_cvt_pk_bf16_f32 v56, v80, v81
    v_cvt_pk_bf16_f32 v57, v82, v83
    v_mfma_f32_32x32x8_bf16 v[64:79], v[30:31], v[16:17], v[64:79]
    v_exp_f32 v84, v84
    v_exp_f32 v85, v85
    v_exp_f32 v86, v86
    v_exp_f32 v87, v87
    v_cvt_pk_bf16_f32 v58, v84, v85
    v_cvt_pk_bf16_f32 v59, v86, v87
    v_mfma_f32_32x32x16_bf16 v[96:111], v[32:35], v[48:51], v[96:111]
    ds_read_b128 v[40:43], v2 offset:27648
    v_exp_f32 v88, v88
    v_exp_f32 v89, v89
    v_exp_f32 v90, v90
    v_exp_f32 v91, v91
    v_cvt_pk_bf16_f32 v60, v88, v89
    v_cvt_pk_bf16_f32 v61, v90, v91
    v_mfma_f32_32x32x16_bf16 v[96:111], v[36:39], v[52:55], v[96:111]
    ds_read_b128 v[44:47], v2 offset:28544
    v_exp_f32 v92, v92
    v_exp_f32 v93, v93
    v_exp_f32 v94, v94
    v_exp_f32 v95, v95
    v_cvt_pk_bf16_f32 v62, v92, v93
    v_cvt_pk_bf16_f32 v63, v94, v95
    v_mfma_f32_32x32x16_bf16 v[80:95], v[24:27], v[12:15], 0
    ds_read_b32 v146, v147 offset:12
    v_exp_f32 v64, v64
    v_exp_f32 v65, v65
    v_exp_f32 v66, v66
    v_exp_f32 v67, v67
    v_cvt_pk_bf16_f32 v48, v64, v65
    v_cvt_pk_bf16_f32 v49, v66, v67
    v_mfma_f32_32x32x8_bf16 v[80:95], v[30:31], v[18:19], v[80:95]
    v_exp_f32 v68, v68
    v_exp_f32 v69, v69
    v_exp_f32 v70, v70
    v_exp_f32 v71, v71
    v_cvt_pk_bf16_f32 v50, v68, v69
    v_cvt_pk_bf16_f32 v51, v70, v71
    v_mfma_f32_32x32x16_bf16 v[112:127], v[32:35], v[56:59], v[112:127]
    ds_read_b64 v[30:31], v3 offset:33792
    v_exp_f32 v72, v72
    v_exp_f32 v73, v73
    v_exp_f32 v74, v74
    v_exp_f32 v75, v75
    v_cvt_pk_bf16_f32 v52, v72, v73
    v_cvt_pk_bf16_f32 v53, v74, v75
    v_mfma_f32_32x32x16_bf16 v[112:127], v[36:39], v[60:63], v[112:127]
    s_waitcnt lgkmcnt(0)
    v_exp_f32_e64 v76, v76
    v_exp_f32 v77, v77
    v_exp_f32 v78, v78
    v_exp_f32 v79, v79
    v_cvt_pk_bf16_f32 v54, v76, v77
    v_cvt_pk_bf16_f32 v55, v78, v79
    v_mfma_f32_32x32x16_bf16 v[64:79], v[20:23], v[8:11], 0
    ds_read_b128 v[24:27], v1 offset:33792
    v_exp_f32 v80, v80
    v_exp_f32 v81, v81
    v_exp_f32 v82, v82
    v_exp_f32 v83, v83
    v_cvt_pk_bf16_f32 v56, v80, v81
    v_cvt_pk_bf16_f32 v57, v82, v83
    v_mfma_f32_32x32x8_bf16 v[64:79], v[28:29], v[16:17], v[64:79]
    v_cmp_gt_u32 vcc, s19, v146
    v_exp_f32_e64 v84, v84
    v_exp_f32 v85, v85
    v_exp_f32 v86, v86
    v_exp_f32 v87, v87
    v_cvt_pk_bf16_f32 v58, v84, v85
    v_cvt_pk_bf16_f32 v59, v86, v87
    v_mfma_f32_32x32x16_bf16 v[96:111], v[40:43], v[48:51], v[96:111]
    ds_read_b128 v[32:35], v2 offset:30720
    v_exp_f32 v88, v88
    v_exp_f32 v89, v89
    v_exp_f32 v90, v90
    v_exp_f32 v91, v91
    v_cvt_pk_bf16_f32 v60, v88, v89
    v_cvt_pk_bf16_f32 v61, v90, v91
    v_mfma_f32_32x32x16_bf16 v[96:111], v[44:47], v[52:55], v[96:111]
    ds_read_b128 v[36:39], v2 offset:31616
    v_exp_f32 v92, v92
    v_exp_f32 v93, v93
    v_exp_f32 v94, v94
    v_exp_f32 v95, v95
    v_cvt_pk_bf16_f32 v62, v92, v93
    v_cvt_pk_bf16_f32 v63, v94, v95
    v_mfma_f32_32x32x16_bf16 v[80:95], v[20:23], v[12:15], 0
    s_cbranch_vccnz parallel_sum__grouped_kv_mqa__mixer_token_mlp__prompt_kernel_spin2
parallel_sum__grouped_kv_mqa__mixer_token_mlp__prompt_kernel_back2:
    v_exp_f32_e64 v64, v64
    v_exp_f32 v65, v65
    v_exp_f32 v66, v66
    v_exp_f32 v67, v67
    v_cvt_pk_bf16_f32 v48, v64, v65
    v_cvt_pk_bf16_f32 v49, v66, v67
    v_mfma_f32_32x32x8_bf16 v[80:95], v[28:29], v[18:19], v[80:95]
    v_exp_f32 v68, v68
    v_exp_f32 v69, v69
    v_exp_f32 v70, v70
    v_exp_f32 v71, v71
    v_cvt_pk_bf16_f32 v50, v68, v69
    v_cvt_pk_bf16_f32 v51, v70, v71
    v_mfma_f32_32x32x16_bf16 v[112:127], v[40:43], v[56:59], v[112:127]
    ds_read_b64 v[28:29], v3 offset:36864
    v_exp_f32 v72, v72
    v_exp_f32 v73, v73
    v_exp_f32 v74, v74
    v_exp_f32 v75, v75
    v_cvt_pk_bf16_f32 v52, v72, v73
    v_cvt_pk_bf16_f32 v53, v74, v75
    v_mfma_f32_32x32x16_bf16 v[112:127], v[44:47], v[60:63], v[112:127]
    s_waitcnt lgkmcnt(0)
    v_exp_f32_e64 v76, v76
    v_exp_f32 v77, v77
    v_exp_f32 v78, v78
    v_exp_f32 v79, v79
    v_cvt_pk_bf16_f32 v54, v76, v77
    v_cvt_pk_bf16_f32 v55, v78, v79
    v_mfma_f32_32x32x16_bf16 v[64:79], v[24:27], v[8:11], 0
    ds_read_b128 v[20:23], v1 offset:36864
    v_exp_f32 v80, v80
    v_exp_f32 v81, v81
    v_exp_f32 v82, v82
    v_exp_f32 v83, v83
    v_cvt_pk_bf16_f32 v56, v80, v81
    v_cvt_pk_bf16_f32 v57, v82, v83
    v_mfma_f32_32x32x8_bf16 v[64:79], v[30:31], v[16:17], v[64:79]
    v_exp_f32 v84, v84
    v_exp_f32 v85, v85
    v_exp_f32 v86, v86
    v_exp_f32 v87, v87
    v_cvt_pk_bf16_f32 v58, v84, v85
    v_cvt_pk_bf16_f32 v59, v86, v87
    v_mfma_f32_32x32x16_bf16 v[96:111], v[32:35], v[48:51], v[96:111]
    ds_read_b128 v[40:43], v2 offset:33792
    v_exp_f32 v88, v88
    v_exp_f32 v89, v89
    v_exp_f32 v90, v90
    v_exp_f32 v91, v91
    v_cvt_pk_bf16_f32 v60, v88, v89
    v_cvt_pk_bf16_f32 v61, v90, v91
    v_mfma_f32_32x32x16_bf16 v[96:111], v[36:39], v[52:55], v[96:111]
    ds_read_b128 v[44:47], v2 offset:34688
    v_exp_f32 v92, v92
    v_exp_f32 v93, v93
    v_exp_f32 v94, v94
    v_exp_f32 v95, v95
    v_cvt_pk_bf16_f32 v62, v92, v93
    v_cvt_pk_bf16_f32 v63, v94, v95
    v_mfma_f32_32x32x16_bf16 v[80:95], v[24:27], v[12:15], 0
    v_exp_f32 v64, v64
    v_exp_f32 v65, v65
    v_exp_f32 v66, v66
    v_exp_f32 v67, v67
    v_cvt_pk_bf16_f32 v48, v64, v65
    v_cvt_pk_bf16_f32 v49, v66, v67
    v_mfma_f32_32x32x8_bf16 v[80:95], v[30:31], v[18:19], v[80:95]
    v_exp_f32 v68, v68
    v_exp_f32 v69, v69
    v_exp_f32 v70, v70
    v_exp_f32 v71, v71
    v_cvt_pk_bf16_f32 v50, v68, v69
    v_cvt_pk_bf16_f32 v51, v70, v71
    v_mfma_f32_32x32x16_bf16 v[112:127], v[32:35], v[56:59], v[112:127]
    ds_read_b64 v[30:31], v3 offset:39936
    v_exp_f32 v72, v72
    v_exp_f32 v73, v73
    v_exp_f32 v74, v74
    v_exp_f32 v75, v75
    v_cvt_pk_bf16_f32 v52, v72, v73
    v_cvt_pk_bf16_f32 v53, v74, v75
    v_mfma_f32_32x32x16_bf16 v[112:127], v[36:39], v[60:63], v[112:127]
    s_waitcnt lgkmcnt(0)
    v_exp_f32_e64 v76, v76
    v_exp_f32 v77, v77
    v_exp_f32 v78, v78
    v_exp_f32 v79, v79
    v_cvt_pk_bf16_f32 v54, v76, v77
    v_cvt_pk_bf16_f32 v55, v78, v79
    v_mfma_f32_32x32x16_bf16 v[64:79], v[20:23], v[8:11], 0
    ds_read_b128 v[24:27], v1 offset:39936
    v_exp_f32 v80, v80
    v_exp_f32 v81, v81
    v_exp_f32 v82, v82
    v_exp_f32 v83, v83
    v_cvt_pk_bf16_f32 v56, v80, v81
    v_cvt_pk_bf16_f32 v57, v82, v83
    v_mfma_f32_32x32x8_bf16 v[64:79], v[28:29], v[16:17], v[64:79]
    v_exp_f32 v84, v84
    v_exp_f32 v85, v85
    v_exp_f32 v86, v86
    v_exp_f32 v87, v87
    v_cvt_pk_bf16_f32 v58, v84, v85
    v_cvt_pk_bf16_f32 v59, v86, v87
    v_mfma_f32_32x32x16_bf16 v[96:111], v[40:43], v[48:51], v[96:111]
    ds_read_b128 v[32:35], v2 offset:36864
    v_exp_f32 v88, v88
    v_exp_f32 v89, v89
    v_exp_f32 v90, v90
    v_exp_f32 v91, v91
    v_cvt_pk_bf16_f32 v60, v88, v89
    v_cvt_pk_bf16_f32 v61, v90, v91
    v_mfma_f32_32x32x16_bf16 v[96:111], v[44:47], v[52:55], v[96:111]
    ds_read_b128 v[36:39], v2 offset:37760
    v_exp_f32 v92, v92
    v_exp_f32 v93, v93
    v_exp_f32 v94, v94
    v_exp_f32 v95, v95
    v_cvt_pk_bf16_f32 v62, v92, v93
    v_cvt_pk_bf16_f32 v63, v94, v95
    v_mfma_f32_32x32x16_bf16 v[80:95], v[20:23], v[12:15], 0
    s_mov_b64 exec, 1
    ds_add_u32 v147, v145 offset:132
    s_mov_b64 exec, -1
    v_exp_f32 v64, v64
    v_exp_f32 v65, v65
    v_exp_f32 v66, v66
    v_exp_f32 v67, v67
    v_cvt_pk_bf16_f32 v48, v64, v65
    v_cvt_pk_bf16_f32 v49, v66, v67
    v_mfma_f32_32x32x8_bf16 v[80:95], v[28:29], v[18:19], v[80:95]
    v_exp_f32 v68, v68
    v_exp_f32 v69, v69
    v_exp_f32 v70, v70
    v_exp_f32 v71, v71
    v_cvt_pk_bf16_f32 v50, v68, v69
    v_cvt_pk_bf16_f32 v51, v70, v71
    v_mfma_f32_32x32x16_bf16 v[112:127], v[40:43], v[56:59], v[112:127]
    ds_read_b64 v[28:29], v3 offset:43008
    v_exp_f32 v72, v72
    v_exp_f32 v73, v73
    v_exp_f32 v74, v74
    v_exp_f32 v75, v75
    v_cvt_pk_bf16_f32 v52, v72, v73
    v_cvt_pk_bf16_f32 v53, v74, v75
    v_mfma_f32_32x32x16_bf16 v[112:127], v[44:47], v[60:63], v[112:127]
    s_waitcnt lgkmcnt(0)
    v_exp_f32_e64 v76, v76
    v_exp_f32 v77, v77
    v_exp_f32 v78, v78
    v_exp_f32 v79, v79
    v_cvt_pk_bf16_f32 v54, v76, v77
    v_cvt_pk_bf16_f32 v55, v78, v79
    v_mfma_f32_32x32x16_bf16 v[64:79], v[24:27], v[8:11], 0
    ds_read_b128 v[20:23], v1 offset:43008
    v_exp_f32 v80, v80
    v_exp_f32 v81, v81
    v_exp_f32 v82, v82
    v_exp_f32 v83, v83
    v_cvt_pk_bf16_f32 v56, v80, v81
    v_cvt_pk_bf16_f32 v57, v82, v83
    v_mfma_f32_32x32x8_bf16 v[64:79], v[30:31], v[16:17], v[64:79]
    v_exp_f32 v84, v84
    v_exp_f32 v85, v85
    v_exp_f32 v86, v86
    v_exp_f32 v87, v87
    v_cvt_pk_bf16_f32 v58, v84, v85
    v_cvt_pk_bf16_f32 v59, v86, v87
    v_mfma_f32_32x32x16_bf16 v[96:111], v[32:35], v[48:51], v[96:111]
    ds_read_b128 v[40:43], v2 offset:39936
    v_exp_f32 v88, v88
    v_exp_f32 v89, v89
    v_exp_f32 v90, v90
    v_exp_f32 v91, v91
    v_cvt_pk_bf16_f32 v60, v88, v89
    v_cvt_pk_bf16_f32 v61, v90, v91
    v_mfma_f32_32x32x16_bf16 v[96:111], v[36:39], v[52:55], v[96:111]
    ds_read_b128 v[44:47], v2 offset:40832
    v_exp_f32 v92, v92
    v_exp_f32 v93, v93
    v_exp_f32 v94, v94
    v_exp_f32 v95, v95
    v_cvt_pk_bf16_f32 v62, v92, v93
    v_cvt_pk_bf16_f32 v63, v94, v95
    v_mfma_f32_32x32x16_bf16 v[80:95], v[24:27], v[12:15], 0
    ds_read_b32 v146, v147 offset:0
    v_exp_f32 v64, v64
    v_exp_f32 v65, v65
    v_exp_f32 v66, v66
    v_exp_f32 v67, v67
    v_cvt_pk_bf16_f32 v48, v64, v65
    v_cvt_pk_bf16_f32 v49, v66, v67
    v_mfma_f32_32x32x8_bf16 v[80:95], v[30:31], v[18:19], v[80:95]
    v_exp_f32 v68, v68
    v_exp_f32 v69, v69
    v_exp_f32 v70, v70
    v_exp_f32 v71, v71
    v_cvt_pk_bf16_f32 v50, v68, v69
    v_cvt_pk_bf16_f32 v51, v70, v71
    v_mfma_f32_32x32x16_bf16 v[112:127], v[32:35], v[56:59], v[112:127]
    ds_read_b64 v[30:31], v3 offset:46080
    v_exp_f32 v72, v72
    v_exp_f32 v73, v73
    v_exp_f32 v74, v74
    v_exp_f32 v75, v75
    v_cvt_pk_bf16_f32 v52, v72, v73
    v_cvt_pk_bf16_f32 v53, v74, v75
    v_mfma_f32_32x32x16_bf16 v[112:127], v[36:39], v[60:63], v[112:127]
    s_waitcnt lgkmcnt(0)
    v_exp_f32_e64 v76, v76
    v_exp_f32 v77, v77
    v_exp_f32 v78, v78
    v_exp_f32 v79, v79
    v_cvt_pk_bf16_f32 v54, v76, v77
    v_cvt_pk_bf16_f32 v55, v78, v79
    v_mfma_f32_32x32x16_bf16 v[64:79], v[20:23], v[8:11], 0
    ds_read_b128 v[24:27], v1 offset:46080
    v_exp_f32 v80, v80
    v_exp_f32 v81, v81
    v_exp_f32 v82, v82
    v_exp_f32 v83, v83
    v_cvt_pk_bf16_f32 v56, v80, v81
    v_cvt_pk_bf16_f32 v57, v82, v83
    v_mfma_f32_32x32x8_bf16 v[64:79], v[28:29], v[16:17], v[64:79]
    v_cmp_ge_u32 vcc, s19, v146
    v_exp_f32_e64 v84, v84
    v_exp_f32 v85, v85
    v_exp_f32 v86, v86
    v_exp_f32 v87, v87
    v_cvt_pk_bf16_f32 v58, v84, v85
    v_cvt_pk_bf16_f32 v59, v86, v87
    v_mfma_f32_32x32x16_bf16 v[96:111], v[40:43], v[48:51], v[96:111]
    ds_read_b128 v[32:35], v2 offset:43008
    v_exp_f32 v88, v88
    v_exp_f32 v89, v89
    v_exp_f32 v90, v90
    v_exp_f32 v91, v91
    v_cvt_pk_bf16_f32 v60, v88, v89
    v_cvt_pk_bf16_f32 v61, v90, v91
    v_mfma_f32_32x32x16_bf16 v[96:111], v[44:47], v[52:55], v[96:111]
    ds_read_b128 v[36:39], v2 offset:43904
    v_exp_f32 v92, v92
    v_exp_f32 v93, v93
    v_exp_f32 v94, v94
    v_exp_f32 v95, v95
    v_cvt_pk_bf16_f32 v62, v92, v93
    v_cvt_pk_bf16_f32 v63, v94, v95
    v_mfma_f32_32x32x16_bf16 v[80:95], v[20:23], v[12:15], 0
    s_cbranch_vccnz parallel_sum__grouped_kv_mqa__mixer_token_mlp__prompt_kernel_spin3
parallel_sum__grouped_kv_mqa__mixer_token_mlp__prompt_kernel_back3:
    v_exp_f32_e64 v64, v64
    v_exp_f32 v65, v65
    v_exp_f32 v66, v66
    v_exp_f32 v67, v67
    v_cvt_pk_bf16_f32 v48, v64, v65
    v_cvt_pk_bf16_f32 v49, v66, v67
    v_mfma_f32_32x32x8_bf16 v[80:95], v[28:29], v[18:19], v[80:95]
    v_exp_f32 v68, v68
    v_exp_f32 v69, v69
    v_exp_f32 v70, v70
    v_exp_f32 v71, v71
    v_cvt_pk_bf16_f32 v50, v68, v69
    v_cvt_pk_bf16_f32 v51, v70, v71
    v_mfma_f32_32x32x16_bf16 v[112:127], v[40:43], v[56:59], v[112:127]
    ds_read_b64 v[28:29], v3 offset:0
    v_exp_f32 v72, v72
    v_exp_f32 v73, v73
    v_exp_f32 v74, v74
    v_exp_f32 v75, v75
    v_cvt_pk_bf16_f32 v52, v72, v73
    v_cvt_pk_bf16_f32 v53, v74, v75
    v_mfma_f32_32x32x16_bf16 v[112:127], v[44:47], v[60:63], v[112:127]
    s_waitcnt lgkmcnt(0)
    v_exp_f32_e64 v76, v76
    v_exp_f32 v77, v77
    v_exp_f32 v78, v78
    v_exp_f32 v79, v79
    v_cvt_pk_bf16_f32 v54, v76, v77
    v_cvt_pk_bf16_f32 v55, v78, v79
    v_mfma_f32_32x32x16_bf16 v[64:79], v[24:27], v[8:11], 0
    ds_read_b128 v[20:23], v1 offset:0
    v_exp_f32 v80, v80
    v_exp_f32 v81, v81
    v_exp_f32 v82, v82
    v_exp_f32 v83, v83
    v_cvt_pk_bf16_f32 v56, v80, v81
    v_cvt_pk_bf16_f32 v57, v82, v83
    v_mfma_f32_32x32x8_bf16 v[64:79], v[30:31], v[16:17], v[64:79]
    v_exp_f32 v84, v84
    v_exp_f32 v85, v85
    v_exp_f32 v86, v86
    v_exp_f32 v87, v87
    v_cvt_pk_bf16_f32 v58, v84, v85
    v_cvt_pk_bf16_f32 v59, v86, v87
    v_mfma_f32_32x32x16_bf16 v[96:111], v[32:35], v[48:51], v[96:111]
    ds_read_b128 v[40:43], v2 offset:46080
    v_exp_f32 v88, v88
    v_exp_f32 v89, v89
    v_exp_f32 v90, v90
    v_exp_f32 v91, v91
    v_cvt_pk_bf16_f32 v60, v88, v89
    v_cvt_pk_bf16_f32 v61, v90, v91
    v_mfma_f32_32x32x16_bf16 v[96:111], v[36:39], v[52:55], v[96:111]
    ds_read_b128 v[44:47], v2 offset:46976
    v_exp_f32 v92, v92
    v_exp_f32 v93, v93
    v_exp_f32 v94, v94
    v_exp_f32 v95, v95
    v_cvt_pk_bf16_f32 v62, v92, v93
    v_cvt_pk_bf16_f32 v63, v94, v95
    v_mfma_f32_32x32x16_bf16 v[80:95], v[24:27], v[12:15], 0
    s_add_u32 s19, s19, 1
    v_exp_f32_e64 v64, v64
    v_exp_f32 v65, v65
    v_exp_f32 v66, v66
    v_exp_f32 v67, v67
    v_cvt_pk_bf16_f32 v48, v64, v65
    v_cvt_pk_bf16_f32 v49, v66, v67
    v_mfma_f32_32x32x8_bf16 v[80:95], v[30:31], v[18:19], v[80:95]
    v_exp_f32 v68, v68
    v_exp_f32 v69, v69
    v_exp_f32 v70, v70
    v_exp_f32 v71, v71
    v_cvt_pk_bf16_f32 v50, v68, v69
    v_cvt_pk_bf16_f32 v51, v70, v71
    v_mfma_f32_32x32x16_bf16 v[112:127], v[32:35], v[56:59], v[112:127]
    ds_read_b64 v[30:31], v3 offset:3072
    v_exp_f32 v72, v72
    v_exp_f32 v73, v73
    v_exp_f32 v74, v74
    v_exp_f32 v75, v75
    v_cvt_pk_bf16_f32 v52, v72, v73
    v_cvt_pk_bf16_f32 v53, v74, v75
    v_mfma_f32_32x32x16_bf16 v[112:127], v[36:39], v[60:63], v[112:127]
    s_waitcnt lgkmcnt(0)
    v_exp_f32_e64 v76, v76
    v_exp_f32 v77, v77
    v_exp_f32 v78, v78
    v_exp_f32 v79, v79
    v_cvt_pk_bf16_f32 v54, v76, v77
    v_cvt_pk_bf16_f32 v55, v78, v79
    v_mfma_f32_32x32x16_bf16 v[64:79], v[20:23], v[8:11], 0
    ds_read_b128 v[24:27], v1 offset:3072
    v_exp_f32 v80, v80
    v_exp_f32 v81, v81
    v_exp_f32 v82, v82
    v_exp_f32 v83, v83
    v_cvt_pk_bf16_f32 v56, v80, v81
    v_cvt_pk_bf16_f32 v57, v82, v83
    v_mfma_f32_32x32x8_bf16 v[64:79], v[28:29], v[16:17], v[64:79]
    s_cmp_lg_u32 s19, 5
    v_exp_f32_e64 v84, v84
    v_exp_f32 v85, v85
    v_exp_f32 v86, v86
    v_exp_f32 v87, v87
    v_cvt_pk_bf16_f32 v58, v84, v85
    v_cvt_pk_bf16_f32 v59, v86, v87
    v_mfma_f32_32x32x16_bf16 v[96:111], v[40:43], v[48:51], v[96:111]
    ds_read_b128 v[32:35], v2 offset:0
    v_exp_f32 v88, v88
    v_exp_f32 v89, v89
    v_exp_f32 v90, v90
    v_exp_f32 v91, v91
    v_cvt_pk_bf16_f32 v60, v88, v89
    v_cvt_pk_bf16_f32 v61, v90, v91
    v_mfma_f32_32x32x16_bf16 v[96:111], v[44:47], v[52:55], v[96:111]
    ds_read_b128 v[36:39], v2 offset:896
    v_exp_f32 v92, v92
    v_exp_f32 v93, v93
    v_exp_f32 v94, v94
    v_exp_f32 v95, v95
    v_cvt_pk_bf16_f32 v62, v92, v93
    v_cvt_pk_bf16_f32 v63, v94, v95
    s_cbranch_scc1 parallel_sum__grouped_kv_mqa__mixer_token_mlp__prompt_kernel_loop
    s_nop 1
    v_mfma_f32_32x32x16_bf16 v[112:127], v[40:43], v[56:59], v[112:127]
    v_mfma_f32_32x32x16_bf16 v[112:127], v[44:47], v[60:63], v[112:127]
parallel_sum__grouped_kv_mqa__mixer_token_mlp__prompt_kernel_fin:
    s_nop 7
    s_nop 1
    v_mov_b32 v142, v104
    v_mov_b32 v143, v104
    s_nop 1
    v_permlane32_swap_b32 v142, v143
    s_nop 1
    v_rcp_f32 v142, v143
    v_rcp_f32 v143, v143
    s_nop 0
    v_pk_mul_f32 v[96:97], v[96:97], v[142:143]
    v_pk_mul_f32 v[98:99], v[98:99], v[142:143]
    v_pk_mul_f32 v[100:101], v[100:101], v[142:143]
    v_pk_mul_f32 v[102:103], v[102:103], v[142:143]
    v_pk_mul_f32 v[104:105], v[104:105], v[142:143]
    v_pk_mul_f32 v[106:107], v[106:107], v[142:143]
    v_cvt_pk_bf16_f32 v128, v96, v97
    v_cvt_pk_bf16_f32 v129, v98, v99
    v_cvt_pk_bf16_f32 v130, v100, v101
    v_cvt_pk_bf16_f32 v131, v102, v103
    v_cvt_pk_bf16_f32 v132, v104, v105
    v_cvt_pk_bf16_f32 v133, v106, v107
    s_nop 1
    v_permlane32_swap_b32 v128, v130
    v_permlane32_swap_b32 v129, v131
    v_mov_b32 v142, v120
    v_mov_b32 v143, v120
    s_nop 1
    v_permlane32_swap_b32 v142, v143
    s_nop 1
    v_rcp_f32 v142, v143
    v_rcp_f32 v143, v143
    s_nop 0
    v_pk_mul_f32 v[112:113], v[112:113], v[142:143]
    v_pk_mul_f32 v[114:115], v[114:115], v[142:143]
    v_pk_mul_f32 v[116:117], v[116:117], v[142:143]
    v_pk_mul_f32 v[118:119], v[118:119], v[142:143]
    v_pk_mul_f32 v[120:121], v[120:121], v[142:143]
    v_pk_mul_f32 v[122:123], v[122:123], v[142:143]
    buffer_store_dwordx4 v[128:131], v7, s[8:11], s18 offen sc1
    v_cvt_pk_bf16_f32 v134, v112, v113
    v_cvt_pk_bf16_f32 v135, v114, v115
    v_cvt_pk_bf16_f32 v140, v116, v117
    v_cvt_pk_bf16_f32 v141, v118, v119
    v_cvt_pk_bf16_f32 v138, v120, v121
    v_cvt_pk_bf16_f32 v139, v122, v123
    s_add_u32 s12, s18, 65536
    v_permlane32_swap_b32 v134, v140
    v_permlane32_swap_b32 v135, v141
    s_nop 1
    v_permlane32_swap_b32 v132, v140
    v_permlane32_swap_b32 v133, v141
    s_nop 1
    v_permlane32_swap_b32 v140, v136
    v_permlane32_swap_b32 v141, v137
    buffer_store_dwordx4 v[132:135], v7, s[8:11], s12 offen sc1
    s_add_u32 s12, s18, 131072
    s_mov_b32 exec_hi, 0
    buffer_store_dwordx4 v[136:139], v7, s[8:11], s12 offen sc1
    s_mov_b64 exec, 1
    ds_add_u32 v147, v145 offset:32
    s_endpgm
parallel_sum__grouped_kv_mqa__mixer_token_mlp__prompt_kernel_spin0:
    ds_read_b32 v146, v147 offset:4
    s_waitcnt lgkmcnt(0)
    v_cmp_gt_u32 vcc, s19, v146
    s_nop 4
    s_cbranch_vccnz parallel_sum__grouped_kv_mqa__mixer_token_mlp__prompt_kernel_spin0
    s_branch parallel_sum__grouped_kv_mqa__mixer_token_mlp__prompt_kernel_back0
parallel_sum__grouped_kv_mqa__mixer_token_mlp__prompt_kernel_spin1:
    ds_read_b32 v146, v147 offset:8
    s_waitcnt lgkmcnt(0)
    v_cmp_gt_u32 vcc, s19, v146
    s_nop 4
    s_cbranch_vccnz parallel_sum__grouped_kv_mqa__mixer_token_mlp__prompt_kernel_spin1
    s_branch parallel_sum__grouped_kv_mqa__mixer_token_mlp__prompt_kernel_back1
parallel_sum__grouped_kv_mqa__mixer_token_mlp__prompt_kernel_spin2:
    ds_read_b32 v146, v147 offset:12
    s_waitcnt lgkmcnt(0)
    v_cmp_gt_u32 vcc, s19, v146
    s_nop 4
    s_cbranch_vccnz parallel_sum__grouped_kv_mqa__mixer_token_mlp__prompt_kernel_spin2
    s_branch parallel_sum__grouped_kv_mqa__mixer_token_mlp__prompt_kernel_back2
parallel_sum__grouped_kv_mqa__mixer_token_mlp__prompt_kernel_spin3:
    s_cmp_eq_u32 s19, 4
    s_cbranch_scc1 parallel_sum__grouped_kv_mqa__mixer_token_mlp__prompt_kernel_back3
    ds_read_b32 v146, v147 offset:0
    s_waitcnt lgkmcnt(0)
    v_cmp_ge_u32 vcc, s19, v146
    s_nop 4
    s_cbranch_vccnz parallel_sum__grouped_kv_mqa__mixer_token_mlp__prompt_kernel_spin3
    s_branch parallel_sum__grouped_kv_mqa__mixer_token_mlp__prompt_kernel_back3
parallel_sum__grouped_kv_mqa__mixer_token_mlp__prompt_kernel_slow:
    s_mov_b32 exec_lo, 0
    v_mov_b32 v16, 0
    v_mov_b32 v18, 0
    s_mov_b32 exec_lo, -1
    v_mov_b32 v148, 0xff7fffff
    v_mov_b32 v149, 0xff7fffff
    s_mov_b32 s13, 0
parallel_sum__grouped_kv_mqa__mixer_token_mlp__prompt_kernel_sl_chunk:
    s_and_b32 s14, s13, 3
    s_lshl_b32 s12, s14, 2
    v_add_u32 v129, s12, v147
    s_lshr_b32 s19, s13, 2
    s_waitcnt lgkmcnt(0)
    s_mov_b64 exec, 1
    ds_add_u32 v129, v145 offset:120
    s_mov_b64 exec, -1
parallel_sum__grouped_kv_mqa__mixer_token_mlp__prompt_kernel_sl_w:
    ds_read_b32 v146, v129
    s_waitcnt lgkmcnt(0)
    v_cmp_ge_u32 vcc, s19, v146
    s_nop 4
    s_cbranch_vccnz parallel_sum__grouped_kv_mqa__mixer_token_mlp__prompt_kernel_sl_w
    s_mul_i32 s12, s14, 12288
    s_add_u32 s14, s12, 12288
parallel_sum__grouped_kv_mqa__mixer_token_mlp__prompt_kernel_sl_tile:
    v_add_u32 v128, s12, v1
    v_add_u32 v129, s12, v3
    v_add_u32 v130, s12, v2
    ds_read_b128 v[20:23], v128
    ds_read_b64 v[28:29], v129
    ds_read_b128 v[32:35], v130
    ds_read_b128 v[36:39], v130 offset:896
    s_waitcnt lgkmcnt(0)
    v_mfma_f32_32x32x16_bf16 v[64:79], v[20:23], v[8:11], 0
    v_mfma_f32_32x32x8_bf16 v[64:79], v[28:29], v[16:17], v[64:79]
    v_mfma_f32_32x32x16_bf16 v[80:95], v[20:23], v[12:15], 0
    v_mfma_f32_32x32x8_bf16 v[80:95], v[28:29], v[18:19], v[80:95]
    s_nop 7
    s_nop 7
    v_max3_f32 v128, v64, v65, v148
    v_max3_f32 v128, v66, v67, v128
    v_max3_f32 v128, v68, v69, v128
    v_max3_f32 v128, v70, v71, v128
    v_max3_f32 v128, v72, v73, v128
    v_max3_f32 v128, v74, v75, v128
    v_max3_f32 v128, v76, v77, v128
    v_max3_f32 v128, v78, v79, v128
    v_mov_b32 v129, v128
    s_nop 1
    v_permlane32_swap_b32 v128, v129
    s_nop 1
    v_max_f32 v128, v128, v129
    v_sub_f32 v129, v148, v128
    v_exp_f32 v129, v129
    v_mov_b32 v148, v128
    v_mul_f32 v96, v96, v129
    v_mul_f32 v97, v97, v129
    v_mul_f32 v98, v98, v129
    v_mul_f32 v99, v99, v129
    v_mul_f32 v100, v100, v129
    v_mul_f32 v101, v101, v129
    v_mul_f32 v102, v102, v129
    v_mul_f32 v103, v103, v129
    v_mul_f32 v104, v104, v129
    v_mul_f32 v105, v105, v129
    v_mul_f32 v106, v106, v129
    v_mul_f32 v107, v107, v129
    v_mul_f32 v108, v108, v129
    v_mul_f32 v109, v109, v129
    v_mul_f32 v110, v110, v129
    v_mul_f32 v111, v111, v129
    v_sub_f32 v64, v64, v148
    v_sub_f32 v65, v65, v148
    v_sub_f32 v66, v66, v148
    v_sub_f32 v67, v67, v148
    v_sub_f32 v68, v68, v148
    v_sub_f32 v69, v69, v148
    v_sub_f32 v70, v70, v148
    v_sub_f32 v71, v71, v148
    v_sub_f32 v72, v72, v148
    v_sub_f32 v73, v73, v148
    v_sub_f32 v74, v74, v148
    v_sub_f32 v75, v75, v148
    v_sub_f32 v76, v76, v148
    v_sub_f32 v77, v77, v148
    v_sub_f32 v78, v78, v148
    v_sub_f32 v79, v79, v148
    v_exp_f32 v64, v64
    v_exp_f32 v65, v65
    v_exp_f32 v66, v66
    v_exp_f32 v67, v67
    v_cvt_pk_bf16_f32 v48, v64, v65
    v_cvt_pk_bf16_f32 v49, v66, v67
    v_exp_f32 v68, v68
    v_exp_f32 v69, v69
    v_exp_f32 v70, v70
    v_exp_f32 v71, v71
    v_cvt_pk_bf16_f32 v50, v68, v69
    v_cvt_pk_bf16_f32 v51, v70, v71
    v_exp_f32 v72, v72
    v_exp_f32 v73, v73
    v_exp_f32 v74, v74
    v_exp_f32 v75, v75
    v_cvt_pk_bf16_f32 v52, v72, v73
    v_cvt_pk_bf16_f32 v53, v74, v75
    v_exp_f32 v76, v76
    v_exp_f32 v77, v77
    v_exp_f32 v78, v78
    v_exp_f32 v79, v79
    v_cvt_pk_bf16_f32 v54, v76, v77
    v_cvt_pk_bf16_f32 v55, v78, v79
    s_nop 1
    v_mfma_f32_32x32x16_bf16 v[96:111], v[32:35], v[48:51], v[96:111]
    v_mfma_f32_32x32x16_bf16 v[96:111], v[36:39], v[52:55], v[96:111]
    v_max3_f32 v128, v80, v81, v149
    v_max3_f32 v128, v82, v83, v128
    v_max3_f32 v128, v84, v85, v128
    v_max3_f32 v128, v86, v87, v128
    v_max3_f32 v128, v88, v89, v128
    v_max3_f32 v128, v90, v91, v128
    v_max3_f32 v128, v92, v93, v128
    v_max3_f32 v128, v94, v95, v128
    v_mov_b32 v129, v128
    s_nop 1
    v_permlane32_swap_b32 v128, v129
    s_nop 1
    v_max_f32 v128, v128, v129
    v_sub_f32 v129, v149, v128
    v_exp_f32 v129, v129
    v_mov_b32 v149, v128
    v_mul_f32 v112, v112, v129
    v_mul_f32 v113, v113, v129
    v_mul_f32 v114, v114, v129
    v_mul_f32 v115, v115, v129
    v_mul_f32 v116, v116, v129
    v_mul_f32 v117, v117, v129
    v_mul_f32 v118, v118, v129
    v_mul_f32 v119, v119, v129
    v_mul_f32 v120, v120, v129
    v_mul_f32 v121, v121, v129
    v_mul_f32 v122, v122, v129
    v_mul_f32 v123, v123, v129
    v_mul_f32 v124, v124, v129
    v_mul_f32 v125, v125, v129
    v_mul_f32 v126, v126, v129
    v_mul_f32 v127, v127, v129
    v_sub_f32 v80, v80, v149
    v_sub_f32 v81, v81, v149
    v_sub_f32 v82, v82, v149
    v_sub_f32 v83, v83, v149
    v_sub_f32 v84, v84, v149
    v_sub_f32 v85, v85, v149
    v_sub_f32 v86, v86, v149
    v_sub_f32 v87, v87, v149
    v_sub_f32 v88, v88, v149
    v_sub_f32 v89, v89, v149
    v_sub_f32 v90, v90, v149
    v_sub_f32 v91, v91, v149
    v_sub_f32 v92, v92, v149
    v_sub_f32 v93, v93, v149
    v_sub_f32 v94, v94, v149
    v_sub_f32 v95, v95, v149
    v_exp_f32 v80, v80
    v_exp_f32 v81, v81
    v_exp_f32 v82, v82
    v_exp_f32 v83, v83
    v_cvt_pk_bf16_f32 v56, v80, v81
    v_cvt_pk_bf16_f32 v57, v82, v83
    v_exp_f32 v84, v84
    v_exp_f32 v85, v85
    v_exp_f32 v86, v86
    v_exp_f32 v87, v87
    v_cvt_pk_bf16_f32 v58, v84, v85
    v_cvt_pk_bf16_f32 v59, v86, v87
    v_exp_f32 v88, v88
    v_exp_f32 v89, v89
    v_exp_f32 v90, v90
    v_exp_f32 v91, v91
    v_cvt_pk_bf16_f32 v60, v88, v89
    v_cvt_pk_bf16_f32 v61, v90, v91
    v_exp_f32 v92, v92
    v_exp_f32 v93, v93
    v_exp_f32 v94, v94
    v_exp_f32 v95, v95
    v_cvt_pk_bf16_f32 v62, v92, v93
    v_cvt_pk_bf16_f32 v63, v94, v95
    s_nop 1
    v_mfma_f32_32x32x16_bf16 v[112:127], v[32:35], v[56:59], v[112:127]
    v_mfma_f32_32x32x16_bf16 v[112:127], v[36:39], v[60:63], v[112:127]
    s_add_u32 s12, s12, 3072
    s_cmp_lg_u32 s12, s14
    s_cbranch_scc1 parallel_sum__grouped_kv_mqa__mixer_token_mlp__prompt_kernel_sl_tile
    s_add_u32 s13, s13, 1
    s_cmp_lg_u32 s13, 16
    s_cbranch_scc1 parallel_sum__grouped_kv_mqa__mixer_token_mlp__prompt_kernel_sl_chunk
    s_branch parallel_sum__grouped_kv_mqa__mixer_token_mlp__prompt_kernel_fin
parallel_sum__grouped_kv_mqa__mixer_token_mlp__prompt_kernel_w8r:
    s_cmp_ge_u32 s47, 2
    s_cbranch_scc1 parallel_sum__grouped_kv_mqa__mixer_token_mlp__prompt_kernel_nw
    s_cmp_eq_u32 s47, 0
    s_cselect_b32 s12, s80, s82
    s_cselect_b32 s13, s81, s83
    s_and_b32 s13, s13, 0xffff
    s_mov_b32 s14, 25600
    s_mov_b32 s15, 0x20000
    s_mov_b32 s7, 0
    s_mov_b32 m0, 0
    s_nop 0
    buffer_load_dwordx4 v1, s[12:15], s7 offen offset:0 lds
    buffer_load_dwordx4 v1, s[12:15], s7 offen offset:1024 lds
    buffer_load_dwordx4 v1, s[12:15], s7 offen offset:2048 lds
    buffer_load_dwordx4 v1, s[12:15], s7 offen offset:3072 lds
    s_add_u32 s7, s7, 4096
    s_mov_b32 m0, 4096
    s_nop 0
    buffer_load_dwordx4 v1, s[12:15], s7 offen offset:0 lds
    buffer_load_dwordx4 v1, s[12:15], s7 offen offset:1024 lds
    buffer_load_dwordx4 v1, s[12:15], s7 offen offset:2048 lds
    buffer_load_dwordx4 v1, s[12:15], s7 offen offset:3072 lds
    s_add_u32 s7, s7, 4096
    s_mov_b32 m0, 8192
    s_nop 0
    buffer_load_dwordx4 v1, s[12:15], s7 offen offset:0 lds
    buffer_load_dwordx4 v1, s[12:15], s7 offen offset:1024 lds
    buffer_load_dwordx4 v1, s[12:15], s7 offen offset:2048 lds
    buffer_load_dwordx4 v1, s[12:15], s7 offen offset:3072 lds
    s_add_u32 s7, s7, 4096
    s_mov_b32 m0, 12288
    s_nop 0
    buffer_load_dwordx4 v1, s[12:15], s7 offen offset:0 lds
    buffer_load_dwordx4 v1, s[12:15], s7 offen offset:1024 lds
    buffer_load_dwordx4 v1, s[12:15], s7 offen offset:2048 lds
    buffer_load_dwordx4 v1, s[12:15], s7 offen offset:3072 lds
    s_add_u32 s7, s7, 4096
    s_mov_b32 m0, 16384
    s_nop 0
    buffer_load_dwordx4 v1, s[12:15], s7 offen offset:0 lds
    buffer_load_dwordx4 v1, s[12:15], s7 offen offset:1024 lds
    buffer_load_dwordx4 v1, s[12:15], s7 offen offset:2048 lds
    buffer_load_dwordx4 v1, s[12:15], s7 offen offset:3072 lds
    s_add_u32 s7, s7, 4096
    s_mov_b32 m0, 20480
    s_nop 0
    buffer_load_dwordx4 v1, s[12:15], s7 offen offset:0 lds
    buffer_load_dwordx4 v1, s[12:15], s7 offen offset:1024 lds
    buffer_load_dwordx4 v1, s[12:15], s7 offen offset:2048 lds
    buffer_load_dwordx4 v1, s[12:15], s7 offen offset:3072 lds
    s_add_u32 s7, s7, 4096
    s_mov_b32 m0, 24576
    s_nop 0
    buffer_load_dwordx4 v1, s[12:15], s7 offen offset:0 lds
    s_add_u32 s7, s7, 4096
parallel_sum__grouped_kv_mqa__mixer_token_mlp__prompt_kernel_nw:
    s_mov_b32 s12, s58
    s_and_b32 s13, s59, 0xffff
    s_mov_b32 s14, 819200
    s_mov_b32 s15, 0x20000
    s_lshr_b32 s7, s2, 3
    s_mul_i32 s7, s7, 15360
    s_add_u32 s7, s7, 327680
    v_lshrrev_b32 v2, 4, v1
    v_min_u32 v2, 59, v2
    v_lshlrev_b32 v2, 7, v2
    buffer_load_dword v127, v2, s[12:15], s7 offen
    s_add_u32 s7, s7, 7680
    buffer_load_dword v127, v2, s[12:15], s7 offen
    s_mov_b32 s8, s4
    s_and_b32 s9, s5, 0xffff
    s_mov_b32 s10, 16617472
    s_mov_b32 s11, 0x20000
    s_cmp_lg_u32 s2, 24
    s_cbranch_scc1 parallel_sum__grouped_kv_mqa__mixer_token_mlp__prompt_kernel_nz
    s_mov_b32 s20, 2822144
    buffer_store_dwordx4 v[4:7], v1, s[8:11], s20 offen offset:0 sc1
    buffer_store_dwordx4 v[4:7], v1, s[8:11], s20 offen offset:1024 sc1
    buffer_store_dwordx4 v[4:7], v1, s[8:11], s20 offen offset:2048 sc1
    buffer_store_dwordx4 v[4:7], v1, s[8:11], s20 offen offset:3072 sc1
    s_add_u32 s20, s20, 4096
    buffer_store_dwordx4 v[4:7], v1, s[8:11], s20 offen offset:0 sc1
    buffer_store_dwordx4 v[4:7], v1, s[8:11], s20 offen offset:1024 sc1
    buffer_store_dwordx4 v[4:7], v1, s[8:11], s20 offen offset:2048 sc1
    buffer_store_dwordx4 v[4:7], v1, s[8:11], s20 offen offset:3072 sc1
    s_add_u32 s20, s20, 4096
    buffer_store_dwordx4 v[4:7], v1, s[8:11], s20 offen offset:0 sc1
    buffer_store_dwordx4 v[4:7], v1, s[8:11], s20 offen offset:1024 sc1
    buffer_store_dwordx4 v[4:7], v1, s[8:11], s20 offen offset:2048 sc1
    buffer_store_dwordx4 v[4:7], v1, s[8:11], s20 offen offset:3072 sc1
    s_add_u32 s20, s20, 4096
    buffer_store_dwordx4 v[4:7], v1, s[8:11], s20 offen offset:0 sc1
    buffer_store_dwordx4 v[4:7], v1, s[8:11], s20 offen offset:1024 sc1
    buffer_store_dwordx4 v[4:7], v1, s[8:11], s20 offen offset:2048 sc1
    buffer_store_dwordx4 v[4:7], v1, s[8:11], s20 offen offset:3072 sc1
    s_add_u32 s20, s20, 4096
    v_mov_b32 v2, 1
    s_waitcnt vmcnt(0)
    s_mov_b64 exec, 1
    global_store_dword v4, v2, s[78:79] sc1
    s_mov_b64 exec, -1
parallel_sum__grouped_kv_mqa__mixer_token_mlp__prompt_kernel_nz:
    v_and_b32 v10, 31, v0
    v_bfe_u32 v11, v0, 5, 1
    v_and_b32 v12, 15, v0
    v_xor_b32 v11, v11, v12
    v_mul_u32_u24 v10, 1280, v10
    v_add_u32 v10, 39424, v10
    v_xor_b32 v16, 0, v11
    v_lshl_add_u32 v16, v16, 4, v10
    v_xor_b32 v17, 2, v11
    v_lshl_add_u32 v17, v17, 4, v10
    v_xor_b32 v18, 4, v11
    v_lshl_add_u32 v18, v18, 4, v10
    v_xor_b32 v19, 6, v11
    v_lshl_add_u32 v19, v19, 4, v10
    v_xor_b32 v20, 8, v11
    v_lshl_add_u32 v20, v20, 4, v10
    v_xor_b32 v21, 10, v11
    v_lshl_add_u32 v21, v21, 4, v10
    v_xor_b32 v22, 12, v11
    v_lshl_add_u32 v22, v22, 4, v10
    v_xor_b32 v23, 14, v11
    v_lshl_add_u32 v23, v23, 4, v10
    v_bfe_u32 v10, v0, 2, 2
    v_bfe_u32 v11, v0, 5, 1
    v_lshl_add_u32 v10, v11, 3, v10
    v_mul_u32_u24 v24, 40, v10
    v_bfe_u32 v10, v0, 4, 1
    v_lshl_add_u32 v24, v10, 5, v24
    v_and_b32 v10, 3, v0
    v_lshl_add_u32 v24, v10, 3, v24
    v_bfe_u32 v10, v0, 3, 3
    s_lshl_b32 s7, s47, 3
    v_add_u32 v10, s7, v10
    v_and_b32 v11, 7, v0
    v_and_b32 v26, 15, v10
    v_xor_b32 v11, v11, v26
    v_mul_u32_u24 v10, 1280, v10
    v_add_u32 v10, 39424, v10
    v_lshl_add_u32 v26, v11, 4, v10
    v_xor_b32 v11, 8, v11
    v_lshl_add_u32 v27, v11, 4, v10
    v_mov_b32 v3, 162816
    v_mov_b32 v5, 1
    v_and_b32 v13, 31, v0
    v_bfe_u32 v14, v0, 5, 1
    s_waitcnt vmcnt(2)
parallel_sum__grouped_kv_mqa__mixer_token_mlp__prompt_kernel_lw14:
    ds_read_b32 v4, v3 offset:28
    s_waitcnt lgkmcnt(0)
    v_cmp_gt_u32 s[84:85], 4, v4
    s_nop 1
    s_cmp_eq_u64 s[84:85], 0
    s_cbranch_scc0 parallel_sum__grouped_kv_mqa__mixer_token_mlp__prompt_kernel_lx14
    s_cmp_ge_u32 s47, 2
    s_cbranch_scc1 parallel_sum__grouped_kv_mqa__mixer_token_mlp__prompt_kernel_h
    ds_read_b128 v[28:31], v16 offset:0
    ds_read_b64_tr_b16 v[44:45], v24 offset:0
    ds_read_b64_tr_b16 v[46:47], v24 offset:160
    ds_read_b128 v[32:35], v17 offset:0
    ds_read_b64_tr_b16 v[48:49], v24 offset:640
    ds_read_b64_tr_b16 v[50:51], v24 offset:800
    ds_read_b128 v[36:39], v18 offset:0
    ds_read_b64_tr_b16 v[52:53], v24 offset:1280
    ds_read_b64_tr_b16 v[54:55], v24 offset:1440
    s_waitcnt lgkmcnt(6)
    v_mfma_f32_32x32x16_bf16 v[64:79], v[44:47], v[28:31], 0
    ds_read_b128 v[40:43], v19 offset:0
    ds_read_b64_tr_b16 v[56:57], v24 offset:1920
    ds_read_b64_tr_b16 v[58:59], v24 offset:2080
    s_waitcnt lgkmcnt(6)
    v_mfma_f32_32x32x16_bf16 v[64:79], v[48:51], v[32:35], v[64:79]
    ds_read_b128 v[28:31], v20 offset:0
    ds_read_b64_tr_b16 v[44:45], v24 offset:2560
    ds_read_b64_tr_b16 v[46:47], v24 offset:2720
    s_waitcnt lgkmcnt(6)
    v_mfma_f32_32x32x16_bf16 v[64:79], v[52:55], v[36:39], v[64:79]
    ds_read_b128 v[32:35], v21 offset:0
    ds_read_b64_tr_b16 v[48:49], v24 offset:3200
    ds_read_b64_tr_b16 v[50:51], v24 offset:3360
    s_waitcnt lgkmcnt(6)
    v_mfma_f32_32x32x16_bf16 v[64:79], v[56:59], v[40:43], v[64:79]
    ds_read_b128 v[36:39], v22 offset:0
    ds_read_b64_tr_b16 v[52:53], v24 offset:3840
    ds_read_b64_tr_b16 v[54:55], v24 offset:4000
    s_waitcnt lgkmcnt(6)
    v_mfma_f32_32x32x16_bf16 v[64:79], v[44:47], v[28:31], v[64:79]
    ds_read_b128 v[40:43], v23 offset:0
    ds_read_b64_tr_b16 v[56:57], v24 offset:4480
    ds_read_b64_tr_b16 v[58:59], v24 offset:4640
    s_waitcnt lgkmcnt(6)
    v_mfma_f32_32x32x16_bf16 v[64:79], v[48:51], v[32:35], v[64:79]
    ds_read_b128 v[28:31], v16 offset:256
    ds_read_b64_tr_b16 v[44:45], v24 offset:5120
    ds_read_b64_tr_b16 v[46:47], v24 offset:5280
    s_waitcnt lgkmcnt(6)
    v_mfma_f32_32x32x16_bf16 v[64:79], v[52:55], v[36:39], v[64:79]
    ds_read_b128 v[32:35], v17 offset:256
    ds_read_b64_tr_b16 v[48:49], v24 offset:5760
    ds_read_b64_tr_b16 v[50:51], v24 offset:5920
    s_waitcnt lgkmcnt(6)
    v_mfma_f32_32x32x16_bf16 v[64:79], v[56:59], v[40:43], v[64:79]
    ds_read_b128 v[36:39], v18 offset:256
    ds_read_b64_tr_b16 v[52:53], v24 offset:6400
    ds_read_b64_tr_b16 v[54:55], v24 offset:6560
    s_waitcnt lgkmcnt(6)
    v_mfma_f32_32x32x16_bf16 v[64:79], v[44:47], v[28:31], v[64:79]
    ds_read_b128 v[40:43], v19 offset:256
    ds_read_b64_tr_b16 v[56:57], v24 offset:7040
    ds_read_b64_tr_b16 v[58:59], v24 offset:7200
    s_waitcnt lgkmcnt(6)
    v_mfma_f32_32x32x16_bf16 v[64:79], v[48:51], v[32:35], v[64:79]
    ds_read_b128 v[28:31], v20 offset:256
    ds_read_b64_tr_b16 v[44:45], v24 offset:7680
    ds_read_b64_tr_b16 v[46:47], v24 offset:7840
    s_waitcnt lgkmcnt(6)
    v_mfma_f32_32x32x16_bf16 v[64:79], v[52:55], v[36:39], v[64:79]
    ds_read_b128 v[32:35], v21 offset:256
    ds_read_b64_tr_b16 v[48:49], v24 offset:8320
    ds_read_b64_tr_b16 v[50:51], v24 offset:8480
    s_waitcnt lgkmcnt(6)
    v_mfma_f32_32x32x16_bf16 v[64:79], v[56:59], v[40:43], v[64:79]
    ds_read_b128 v[36:39], v22 offset:256
    ds_read_b64_tr_b16 v[52:53], v24 offset:8960
    ds_read_b64_tr_b16 v[54:55], v24 offset:9120
    s_waitcnt lgkmcnt(6)
    v_mfma_f32_32x32x16_bf16 v[64:79], v[44:47], v[28:31], v[64:79]
    ds_read_b128 v[40:43], v23 offset:256
    ds_read_b64_tr_b16 v[56:57], v24 offset:9600
    ds_read_b64_tr_b16 v[58:59], v24 offset:9760
    s_waitcnt lgkmcnt(6)
    v_mfma_f32_32x32x16_bf16 v[64:79], v[48:51], v[32:35], v[64:79]
    ds_read_b128 v[28:31], v16 offset:512
    ds_read_b64_tr_b16 v[44:45], v24 offset:10240
    ds_read_b64_tr_b16 v[46:47], v24 offset:10400
    s_waitcnt lgkmcnt(6)
    v_mfma_f32_32x32x16_bf16 v[64:79], v[52:55], v[36:39], v[64:79]
    ds_read_b128 v[32:35], v17 offset:512
    ds_read_b64_tr_b16 v[48:49], v24 offset:10880
    ds_read_b64_tr_b16 v[50:51], v24 offset:11040
    s_waitcnt lgkmcnt(6)
    v_mfma_f32_32x32x16_bf16 v[64:79], v[56:59], v[40:43], v[64:79]
    ds_read_b128 v[36:39], v18 offset:512
    ds_read_b64_tr_b16 v[52:53], v24 offset:11520
    ds_read_b64_tr_b16 v[54:55], v24 offset:11680
    s_waitcnt lgkmcnt(6)
    v_mfma_f32_32x32x16_bf16 v[64:79], v[44:47], v[28:31], v[64:79]
    ds_read_b128 v[40:43], v19 offset:512
    ds_read_b64_tr_b16 v[56:57], v24 offset:12160
    ds_read_b64_tr_b16 v[58:59], v24 offset:12320
    s_waitcnt lgkmcnt(6)
    v_mfma_f32_32x32x16_bf16 v[64:79], v[48:51], v[32:35], v[64:79]
    ds_read_b128 v[28:31], v20 offset:512
    ds_read_b64_tr_b16 v[44:45], v24 offset:12800
    ds_read_b64_tr_b16 v[46:47], v24 offset:12960
    s_waitcnt lgkmcnt(6)
    v_mfma_f32_32x32x16_bf16 v[64:79], v[52:55], v[36:39], v[64:79]
    ds_read_b128 v[32:35], v21 offset:512
    ds_read_b64_tr_b16 v[48:49], v24 offset:13440
    ds_read_b64_tr_b16 v[50:51], v24 offset:13600
    s_waitcnt lgkmcnt(6)
    v_mfma_f32_32x32x16_bf16 v[64:79], v[56:59], v[40:43], v[64:79]
    ds_read_b128 v[36:39], v22 offset:512
    ds_read_b64_tr_b16 v[52:53], v24 offset:14080
    ds_read_b64_tr_b16 v[54:55], v24 offset:14240
    s_waitcnt lgkmcnt(6)
    v_mfma_f32_32x32x16_bf16 v[64:79], v[44:47], v[28:31], v[64:79]
    ds_read_b128 v[40:43], v23 offset:512
    ds_read_b64_tr_b16 v[56:57], v24 offset:14720
    ds_read_b64_tr_b16 v[58:59], v24 offset:14880
    s_waitcnt lgkmcnt(6)
    v_mfma_f32_32x32x16_bf16 v[64:79], v[48:51], v[32:35], v[64:79]
    ds_read_b128 v[28:31], v16 offset:768
    ds_read_b64_tr_b16 v[44:45], v24 offset:15360
    ds_read_b64_tr_b16 v[46:47], v24 offset:15520
    s_waitcnt lgkmcnt(6)
    v_mfma_f32_32x32x16_bf16 v[64:79], v[52:55], v[36:39], v[64:79]
    ds_read_b128 v[32:35], v17 offset:768
    ds_read_b64_tr_b16 v[48:49], v24 offset:16000
    ds_read_b64_tr_b16 v[50:51], v24 offset:16160
    s_waitcnt lgkmcnt(6)
    v_mfma_f32_32x32x16_bf16 v[64:79], v[56:59], v[40:43], v[64:79]
    ds_read_b128 v[36:39], v18 offset:768
    ds_read_b64_tr_b16 v[52:53], v24 offset:16640
    ds_read_b64_tr_b16 v[54:55], v24 offset:16800
    s_waitcnt lgkmcnt(6)
    v_mfma_f32_32x32x16_bf16 v[64:79], v[44:47], v[28:31], v[64:79]
    ds_read_b128 v[40:43], v19 offset:768
    ds_read_b64_tr_b16 v[56:57], v24 offset:17280
    ds_read_b64_tr_b16 v[58:59], v24 offset:17440
    s_waitcnt lgkmcnt(6)
    v_mfma_f32_32x32x16_bf16 v[64:79], v[48:51], v[32:35], v[64:79]
    ds_read_b128 v[28:31], v20 offset:768
    ds_read_b64_tr_b16 v[44:45], v24 offset:17920
    ds_read_b64_tr_b16 v[46:47], v24 offset:18080
    s_waitcnt lgkmcnt(6)
    v_mfma_f32_32x32x16_bf16 v[64:79], v[52:55], v[36:39], v[64:79]
    ds_read_b128 v[32:35], v21 offset:768
    ds_read_b64_tr_b16 v[48:49], v24 offset:18560
    ds_read_b64_tr_b16 v[50:51], v24 offset:18720
    s_waitcnt lgkmcnt(6)
    v_mfma_f32_32x32x16_bf16 v[64:79], v[56:59], v[40:43], v[64:79]
    ds_read_b128 v[36:39], v22 offset:768
    ds_read_b64_tr_b16 v[52:53], v24 offset:19200
    ds_read_b64_tr_b16 v[54:55], v24 offset:19360
    s_waitcnt lgkmcnt(6)
    v_mfma_f32_32x32x16_bf16 v[64:79], v[44:47], v[28:31], v[64:79]
    ds_read_b128 v[40:43], v23 offset:768
    ds_read_b64_tr_b16 v[56:57], v24 offset:19840
    ds_read_b64_tr_b16 v[58:59], v24 offset:20000
    s_waitcnt lgkmcnt(6)
    v_mfma_f32_32x32x16_bf16 v[64:79], v[48:51], v[32:35], v[64:79]
    ds_read_b128 v[28:31], v16 offset:1024
    ds_read_b64_tr_b16 v[44:45], v24 offset:20480
    ds_read_b64_tr_b16 v[46:47], v24 offset:20640
    s_waitcnt lgkmcnt(6)
    v_mfma_f32_32x32x16_bf16 v[64:79], v[52:55], v[36:39], v[64:79]
    ds_read_b128 v[32:35], v17 offset:1024
    ds_read_b64_tr_b16 v[48:49], v24 offset:21120
    ds_read_b64_tr_b16 v[50:51], v24 offset:21280
    s_waitcnt lgkmcnt(6)
    v_mfma_f32_32x32x16_bf16 v[64:79], v[56:59], v[40:43], v[64:79]
    ds_read_b128 v[36:39], v18 offset:1024
    ds_read_b64_tr_b16 v[52:53], v24 offset:21760
    ds_read_b64_tr_b16 v[54:55], v24 offset:21920
    s_waitcnt lgkmcnt(6)
    v_mfma_f32_32x32x16_bf16 v[64:79], v[44:47], v[28:31], v[64:79]
    ds_read_b128 v[40:43], v19 offset:1024
    ds_read_b64_tr_b16 v[56:57], v24 offset:22400
    ds_read_b64_tr_b16 v[58:59], v24 offset:22560
    s_waitcnt lgkmcnt(6)
    v_mfma_f32_32x32x16_bf16 v[64:79], v[48:51], v[32:35], v[64:79]
    ds_read_b128 v[28:31], v20 offset:1024
    ds_read_b64_tr_b16 v[44:45], v24 offset:23040
    ds_read_b64_tr_b16 v[46:47], v24 offset:23200
    s_waitcnt lgkmcnt(6)
    v_mfma_f32_32x32x16_bf16 v[64:79], v[52:55], v[36:39], v[64:79]
    ds_read_b128 v[32:35], v21 offset:1024
    ds_read_b64_tr_b16 v[48:49], v24 offset:23680
    ds_read_b64_tr_b16 v[50:51], v24 offset:23840
    s_waitcnt lgkmcnt(6)
    v_mfma_f32_32x32x16_bf16 v[64:79], v[56:59], v[40:43], v[64:79]
    ds_read_b128 v[36:39], v22 offset:1024
    ds_read_b64_tr_b16 v[52:53], v24 offset:24320
    ds_read_b64_tr_b16 v[54:55], v24 offset:24480
    s_waitcnt lgkmcnt(6)
    v_mfma_f32_32x32x16_bf16 v[64:79], v[44:47], v[28:31], v[64:79]
    ds_read_b128 v[40:43], v23 offset:1024
    ds_read_b64_tr_b16 v[56:57], v24 offset:24960
    ds_read_b64_tr_b16 v[58:59], v24 offset:25120
    s_waitcnt lgkmcnt(6)
    v_mfma_f32_32x32x16_bf16 v[64:79], v[48:51], v[32:35], v[64:79]
    s_waitcnt lgkmcnt(3)
    v_mfma_f32_32x32x16_bf16 v[64:79], v[52:55], v[36:39], v[64:79]
    s_waitcnt lgkmcnt(0)
    v_mfma_f32_32x32x16_bf16 v[64:79], v[56:59], v[40:43], v[64:79]
    s_mul_i32 s20, s49, 3072
    s_add_u32 s20, s20, 2621440
    v_cmp_eq_u32 vcc, 1, v14
    s_nop 7
    s_nop 1
    v_cvt_pk_bf16_f32 v80, v64, v65
    v_cvt_pk_bf16_f32 v81, v66, v67
    v_cvt_pk_bf16_f32 v82, v68, v69
    v_cvt_pk_bf16_f32 v83, v70, v71
    v_cvt_pk_bf16_f32 v84, v72, v73
    v_cvt_pk_bf16_f32 v85, v74, v75
    s_cmp_eq_u32 s47, 1
    s_cbranch_scc1 parallel_sum__grouped_kv_mqa__mixer_token_mlp__prompt_kernel_v
    buffer_store_dwordx4 v[80:83], v1, s[8:11], s20 offen sc1
    v_cndmask_b32_e64 v84, v84, 0, vcc
    v_cndmask_b32_e64 v85, v85, 0, vcc
    v_lshlrev_b32 v11, 3, v13
    s_mov_b32 exec_hi, 0
    buffer_store_dwordx2 v[84:85], v11, s[8:11], s20 offen offset:1024 sc1
    s_mov_b32 exec_hi, -1
    v_dot2_f32_bf16 v90, v80, v80, 0
    v_dot2_f32_bf16 v90, v81, v81, v90
    v_dot2_f32_bf16 v90, v82, v82, v90
    v_dot2_f32_bf16 v90, v83, v83, v90
    v_dot2_f32_bf16 v90, v84, v84, v90
    v_dot2_f32_bf16 v90, v85, v85, v90
    s_nop 2
    v_mov_b32 v10, v90
    s_nop 1
    v_permlane32_swap_b32 v90, v10
    s_nop 1
    v_add_f32 v90, v90, v10
    s_nop 1
    v_max_f32_dpp v90, v90, v90 row_ror:8 row_mask:0xf bank_mask:0xf
    s_nop 1
    v_max_f32_dpp v90, v90, v90 row_ror:4 row_mask:0xf bank_mask:0xf
    s_nop 1
    v_max_f32_dpp v90, v90, v90 row_ror:2 row_mask:0xf bank_mask:0xf
    s_nop 1
    v_max_f32_dpp v90, v90, v90 row_ror:1 row_mask:0xf bank_mask:0xf
    v_mov_b32 v10, v90
    s_nop 1
    v_permlane16_swap_b32 v90, v10
    s_nop 1
    v_max_f32 v90, v90, v10
    s_lshl_b32 s21, s49, 7
    s_add_u32 s21, s21, 2613248
    v_mov_b32 v10, 0
    s_mov_b64 exec, 1
    buffer_store_dword v90, v10, s[8:11], s21 offen sc1
    s_mov_b64 exec, -1
    s_branch parallel_sum__grouped_kv_mqa__mixer_token_mlp__prompt_kernel_h
parallel_sum__grouped_kv_mqa__mixer_token_mlp__prompt_kernel_v:
    v_lshlrev_b32 v10, 6, v13
    v_lshl_add_u32 v10, v14, 3, v10
    ds_write_b64 v10, v[80:81] offset:37376
    ds_write_b64 v10, v[82:83] offset:37392
    ds_write_b64 v10, v[84:85] offset:37408
    v_bfe_u32 v10, v0, 2, 2
    v_lshl_add_u32 v10, v14, 2, v10
    v_lshlrev_b32 v10, 6, v10
    v_bfe_u32 v11, v0, 4, 1
    v_lshl_add_u32 v10, v11, 5, v10
    v_and_b32 v11, 3, v0
    v_lshl_add_u32 v10, v11, 3, v10
    s_waitcnt lgkmcnt(0)
    ds_read_b64_tr_b16 v[80:81], v10 offset:37376
    ds_read_b64_tr_b16 v[82:83], v10 offset:37888
    ds_read_b64_tr_b16 v[84:85], v10 offset:38400
    ds_read_b64_tr_b16 v[86:87], v10 offset:38912
    v_cmp_eq_u32 vcc, 20, v13
    v_mov_b32 v11, s60
    s_nop 0
    v_cndmask_b32_e64 v11, 0, v11, vcc
    v_cmp_gt_u32 vcc, 20, v13
    v_mul_u32_u24 v12, 448, v14
    v_lshl_add_u32 v12, v13, 4, v12
    s_waitcnt lgkmcnt(0)
    v_cndmask_b32_e64 v80, v11, v80, vcc
    v_cndmask_b32_e64 v81, v11, v81, vcc
    v_cndmask_b32_e64 v82, v11, v82, vcc
    v_cndmask_b32_e64 v83, v11, v83, vcc
    v_cndmask_b32_e64 v84, v11, v84, vcc
    v_cndmask_b32_e64 v85, v11, v85, vcc
    v_cndmask_b32_e64 v86, v11, v86, vcc
    v_cndmask_b32_e64 v87, v11, v87, vcc
    v_cmp_eq_u32 vcc, 26, v13
    v_mov_b32 v11, 0x3f80
    s_nop 0
    v_cndmask_b32_e64 v80, v80, v11, vcc
    s_mov_b32 exec_lo, 0x0fffffff
    s_mov_b32 exec_hi, 0x0fffffff
    buffer_store_dwordx4 v[80:83], v12, s[8:11], s20 offen offset:1280 sc1
    buffer_store_dwordx4 v[84:87], v12, s[8:11], s20 offen offset:2176 sc1
    s_mov_b64 exec, -1
parallel_sum__grouped_kv_mqa__mixer_token_mlp__prompt_kernel_h:
    v_mov_b32 v92, 0
    global_load_dword v92, v92, s[78:79] sc1
parallel_sum__grouped_kv_mqa__mixer_token_mlp__prompt_kernel_lw15:
    ds_read_b32 v4, v3 offset:36
    s_waitcnt lgkmcnt(0)
    v_cmp_gt_u32 s[84:85], 4, v4
    s_nop 1
    s_cmp_eq_u64 s[84:85], 0
    s_cbranch_scc0 parallel_sum__grouped_kv_mqa__mixer_token_mlp__prompt_kernel_lx15
    s_lshr_b32 s7, s49, 2
    s_lshl_b32 s7, s7, 7
    s_add_u32 s7, s7, 2834432
    s_mov_b64 exec, -1
    s_waitcnt vmcnt(0)
    v_readfirstlane_b32 s3, v92
    v_mov_b32 v92, 0
    s_cmp_lg_u32 s3, 0
    s_cbranch_scc1 parallel_sum__grouped_kv_mqa__mixer_token_mlp__prompt_kernel_zk16
    s_mov_b32 s71, 0
    s_mov_b32 s3, 1
    s_mov_b64 exec, 1
parallel_sum__grouped_kv_mqa__mixer_token_mlp__prompt_kernel_gw17:
    global_load_dword v93, v92, s[78:79] sc1
    s_add_u32 s71, s71, 1
    s_waitcnt vmcnt(0)
    v_cmp_gt_u32 s[84:85], s3, v93
    s_nop 1
    s_cmp_eq_u64 s[84:85], 0
    s_cbranch_scc0 parallel_sum__grouped_kv_mqa__mixer_token_mlp__prompt_kernel_gx17
parallel_sum__grouped_kv_mqa__mixer_token_mlp__prompt_kernel_gy17:
    s_mov_b64 exec, -1
parallel_sum__grouped_kv_mqa__mixer_token_mlp__prompt_kernel_zk16:
    v_mov_b32 v93, s7
    v_mov_b32 v92, 1
    s_mov_b64 exec, 1
    global_atomic_add v93, v92, s[4:5] sc1
    s_mov_b64 exec, -1
    s_setprio 3
    s_add_u32 s8, s4, 2621440
    s_addc_u32 s9, s5, 0
    s_and_b32 s9, s9, 0xffff
    s_mov_b32 s10, 196608
    s_mov_b32 s11, 0x20000
    s_mov_b32 s12, 0
    s_mov_b32 s13, 4
    v_lshlrev_b32 v6, 3, v1
    v_add_u32 v6, 2834432, v6
    s_cmp_lg_u32 s2, 24
    s_cbranch_scc1 parallel_sum__grouped_kv_mqa__mixer_token_mlp__prompt_kernel_nm
    s_mov_b32 s71, 0
    s_mov_b32 s3, 16
    s_mov_b64 exec, 65535
parallel_sum__grouped_kv_mqa__mixer_token_mlp__prompt_kernel_gw18:
    global_load_dword v4, v6, s[4:5] sc1
    s_add_u32 s71, s71, 1
    s_waitcnt vmcnt(0)
    v_cmp_gt_u32 s[84:85], s3, v4
    s_nop 1
    s_cmp_eq_u64 s[84:85], 0
    s_cbranch_scc0 parallel_sum__grouped_kv_mqa__mixer_token_mlp__prompt_kernel_gx18
parallel_sum__grouped_kv_mqa__mixer_token_mlp__prompt_kernel_gy18:
    s_mov_b64 exec, -1
    v_lshlrev_b32 v6, 3, v1
    v_add_u32 v6, 2830336, v6
    s_mov_b32 exec_hi, 0
    global_store_dword v6, v5, s[4:5] sc1
    s_mov_b32 exec_hi, -1
parallel_sum__grouped_kv_mqa__mixer_token_mlp__prompt_kernel_nm:
    s_mov_b32 s24, s40
    s_and_b32 s25, s41, 0xffff
    s_mov_b32 s26, 7077888
    s_mov_b32 s27, 0x20000
    s_mul_i32 s7, s2, 27648
    v_and_b32 v2, 63, v0
    v_min_u32 v2, 53, v2
    v_lshlrev_b32 v2, 7, v2
    buffer_load_dword v127, v2, s[24:27], s7 offen
    s_add_u32 s7, s7, 6912
    buffer_load_dword v127, v2, s[24:27], s7 offen
    s_add_u32 s7, s7, 6912
    buffer_load_dword v127, v2, s[24:27], s7 offen
    s_add_u32 s7, s7, 6912
    buffer_load_dword v127, v2, s[24:27], s7 offen
    s_add_u32 s7, s7, 6912
parallel_sum__grouped_kv_mqa__mixer_token_mlp__prompt_kernel_pw19:
    s_lshl_b32 s17, s48, 7
    s_add_u32 s17, s17, 2830336
    v_mov_b32 v6, s17
    s_mov_b32 s71, 0
parallel_sum__grouped_kv_mqa__mixer_token_mlp__prompt_kernel_sw20:
    s_load_dword s3, s[4:5], s17 glc
    s_add_u32 s71, s71, 1
    s_waitcnt lgkmcnt(0)
    s_cmp_ge_u32 s3, 1
    s_cbranch_scc0 parallel_sum__grouped_kv_mqa__mixer_token_mlp__prompt_kernel_sx20
parallel_sum__grouped_kv_mqa__mixer_token_mlp__prompt_kernel_sy20:
    v_lshlrev_b32 v6, 3, v1
    v_add_u32 v6, 2613248, v6
    global_load_dword v7, v6, s[4:5] sc1
    ds_write_b32 v3, v5 offset:16
    s_mov_b32 m0, 0
    s_nop 0
    buffer_load_dwordx4 v1, s[8:11], s12 offen offset:0 sc1 lds
    buffer_load_dwordx4 v1, s[8:11], s12 offen offset:1024 sc1 lds
    buffer_load_dwordx4 v1, s[8:11], s12 offen offset:2048 sc1 lds
    buffer_load_dwordx4 v1, s[8:11], s12 offen offset:3072 sc1 lds
    s_add_u32 s12, s12, 4096
    s_mov_b32 m0, 4096
    s_nop 0
    buffer_load_dwordx4 v1, s[8:11], s12 offen offset:0 sc1 lds
    buffer_load_dwordx4 v1, s[8:11], s12 offen offset:1024 sc1 lds
    buffer_load_dwordx4 v1, s[8:11], s12 offen offset:2048 sc1 lds
    buffer_load_dwordx4 v1, s[8:11], s12 offen offset:3072 sc1 lds
    s_add_u32 s12, s12, 4096
    s_mov_b32 m0, 8192
    s_nop 0
    buffer_load_dwordx4 v1, s[8:11], s12 offen offset:0 sc1 lds
    buffer_load_dwordx4 v1, s[8:11], s12 offen offset:1024 sc1 lds
    buffer_load_dwordx4 v1, s[8:11], s12 offen offset:2048 sc1 lds
    buffer_load_dwordx4 v1, s[8:11], s12 offen offset:3072 sc1 lds
    s_add_u32 s12, s12, 4096
    s_mov_b32 m0, 12288
    s_nop 0
    buffer_load_dwordx4 v1, s[8:11], s12 offen offset:0 sc1 lds
    buffer_load_dwordx4 v1, s[8:11], s12 offen offset:1024 sc1 lds
    buffer_load_dwordx4 v1, s[8:11], s12 offen offset:2048 sc1 lds
    buffer_load_dwordx4 v1, s[8:11], s12 offen offset:3072 sc1 lds
    s_add_u32 s12, s12, 4096
    s_mov_b32 m0, 16384
    s_nop 0
    buffer_load_dwordx4 v1, s[8:11], s12 offen offset:0 sc1 lds
    buffer_load_dwordx4 v1, s[8:11], s12 offen offset:1024 sc1 lds
    buffer_load_dwordx4 v1, s[8:11], s12 offen offset:2048 sc1 lds
    buffer_load_dwordx4 v1, s[8:11], s12 offen offset:3072 sc1 lds
    s_add_u32 s12, s12, 4096
    s_mov_b32 m0, 20480
    s_nop 0
    buffer_load_dwordx4 v1, s[8:11], s12 offen offset:0 sc1 lds
    buffer_load_dwordx4 v1, s[8:11], s12 offen offset:1024 sc1 lds
    buffer_load_dwordx4 v1, s[8:11], s12 offen offset:2048 sc1 lds
    buffer_load_dwordx4 v1, s[8:11], s12 offen offset:3072 sc1 lds
    s_add_u32 s12, s12, 4096
    s_waitcnt vmcnt(24)
    s_nop 1
    v_max_f32_dpp v7, v7, v7 row_ror:8 row_mask:0xf bank_mask:0xf
    s_nop 1
    v_max_f32_dpp v7, v7, v7 row_ror:4 row_mask:0xf bank_mask:0xf
    s_nop 1
    v_max_f32_dpp v7, v7, v7 row_ror:2 row_mask:0xf bank_mask:0xf
    s_nop 1
    v_max_f32_dpp v7, v7, v7 row_ror:1 row_mask:0xf bank_mask:0xf
    v_mov_b32 v6, v7
    s_nop 1
    v_permlane16_swap_b32 v7, v6
    s_nop 1
    v_max_f32 v7, v7, v6
    v_mov_b32 v6, v7
    s_nop 1
    v_permlane32_swap_b32 v7, v6
    s_nop 1
    v_max_f32 v7, v7, v6
    ds_write_b32 v3, v7 offset:20
    s_waitcnt vmcnt(12)
    s_mov_b64 exec, 1
    ds_add_u32 v3, v5 offset:0
    s_mov_b64 exec, -1
    s_waitcnt vmcnt(0)
    s_mov_b64 exec, 1
    ds_add_u32 v3, v5 offset:4
    s_mov_b64 exec, -1
parallel_sum__grouped_kv_mqa__mixer_token_mlp__prompt_kernel_lw21:
    ds_read_b32 v4, v3 offset:24
    s_waitcnt lgkmcnt(0)
    v_cmp_gt_u32 s[84:85], 4, v4
    s_nop 1
    s_cmp_eq_u64 s[84:85], 0
    s_cbranch_scc0 parallel_sum__grouped_kv_mqa__mixer_token_mlp__prompt_kernel_lx21
    s_mov_b32 m0, 24576
    s_nop 0
    buffer_load_dwordx4 v1, s[8:11], s12 offen offset:0 sc1 lds
    buffer_load_dwordx4 v1, s[8:11], s12 offen offset:1024 sc1 lds
    buffer_load_dwordx4 v1, s[8:11], s12 offen offset:2048 sc1 lds
    buffer_load_dwordx4 v1, s[8:11], s12 offen offset:3072 sc1 lds
    s_add_u32 s12, s12, 4096
    s_mov_b32 m0, 28672
    s_nop 0
    buffer_load_dwordx4 v1, s[8:11], s12 offen offset:0 sc1 lds
    buffer_load_dwordx4 v1, s[8:11], s12 offen offset:1024 sc1 lds
    buffer_load_dwordx4 v1, s[8:11], s12 offen offset:2048 sc1 lds
    buffer_load_dwordx4 v1, s[8:11], s12 offen offset:3072 sc1 lds
    s_add_u32 s12, s12, 4096
    s_mov_b32 m0, 32768
    s_nop 0
    buffer_load_dwordx4 v1, s[8:11], s12 offen offset:0 sc1 lds
    buffer_load_dwordx4 v1, s[8:11], s12 offen offset:1024 sc1 lds
    buffer_load_dwordx4 v1, s[8:11], s12 offen offset:2048 sc1 lds
    buffer_load_dwordx4 v1, s[8:11], s12 offen offset:3072 sc1 lds
    s_add_u32 s12, s12, 4096
    s_mov_b32 m0, 36864
    s_nop 0
    buffer_load_dwordx4 v1, s[8:11], s12 offen offset:0 sc1 lds
    buffer_load_dwordx4 v1, s[8:11], s12 offen offset:1024 sc1 lds
    buffer_load_dwordx4 v1, s[8:11], s12 offen offset:2048 sc1 lds
    buffer_load_dwordx4 v1, s[8:11], s12 offen offset:3072 sc1 lds
    s_add_u32 s12, s12, 4096
    s_mov_b32 m0, 40960
    s_nop 0
    buffer_load_dwordx4 v1, s[8:11], s12 offen offset:0 sc1 lds
    buffer_load_dwordx4 v1, s[8:11], s12 offen offset:1024 sc1 lds
    buffer_load_dwordx4 v1, s[8:11], s12 offen offset:2048 sc1 lds
    buffer_load_dwordx4 v1, s[8:11], s12 offen offset:3072 sc1 lds
    s_add_u32 s12, s12, 4096
    s_mov_b32 m0, 45056
    s_nop 0
    buffer_load_dwordx4 v1, s[8:11], s12 offen offset:0 sc1 lds
    buffer_load_dwordx4 v1, s[8:11], s12 offen offset:1024 sc1 lds
    buffer_load_dwordx4 v1, s[8:11], s12 offen offset:2048 sc1 lds
    buffer_load_dwordx4 v1, s[8:11], s12 offen offset:3072 sc1 lds
    s_add_u32 s12, s12, 4096
    s_waitcnt vmcnt(12)
    s_mov_b64 exec, 1
    ds_add_u32 v3, v5 offset:8
    s_mov_b64 exec, -1
    s_waitcnt vmcnt(0)
    s_mov_b64 exec, 1
    ds_add_u32 v3, v5 offset:12
    s_mov_b64 exec, -1
parallel_sum__grouped_kv_mqa__mixer_token_mlp__prompt_kernel_ld:
    s_and_b32 s14, s13, 3
    s_add_u32 s15, s14, 1
    s_and_b32 s15, s15, 3
    s_lshl_b32 s15, s15, 2
    s_add_u32 s15, s15, 162816
    v_mov_b32 v2, s15
    s_add_u32 s15, s13, 1
    s_andn2_b32 s15, s15, 3
parallel_sum__grouped_kv_mqa__mixer_token_mlp__prompt_kernel_lw22:
    ds_read_b32 v4, v2 offset:120
    s_waitcnt lgkmcnt(0)
    v_cmp_gt_u32 s[84:85], s15, v4
    s_nop 1
    s_cmp_eq_u64 s[84:85], 0
    s_cbranch_scc0 parallel_sum__grouped_kv_mqa__mixer_token_mlp__prompt_kernel_lx22
    s_mul_i32 s16, s14, 12288
    s_add_u32 m0, s16, 0
    s_nop 0
    buffer_load_dwordx4 v1, s[8:11], s12 offen offset:0 sc1 lds
    buffer_load_dwordx4 v1, s[8:11], s12 offen offset:1024 sc1 lds
    buffer_load_dwordx4 v1, s[8:11], s12 offen offset:2048 sc1 lds
    buffer_load_dwordx4 v1, s[8:11], s12 offen offset:3072 sc1 lds
    s_add_u32 s12, s12, 4096
    s_add_u32 m0, s16, 4096
    s_nop 0
    buffer_load_dwordx4 v1, s[8:11], s12 offen offset:0 sc1 lds
    buffer_load_dwordx4 v1, s[8:11], s12 offen offset:1024 sc1 lds
    buffer_load_dwordx4 v1, s[8:11], s12 offen offset:2048 sc1 lds
    buffer_load_dwordx4 v1, s[8:11], s12 offen offset:3072 sc1 lds
    s_add_u32 s12, s12, 4096
    s_add_u32 m0, s16, 8192
    s_nop 0
    buffer_load_dwordx4 v1, s[8:11], s12 offen offset:0 sc1 lds
    buffer_load_dwordx4 v1, s[8:11], s12 offen offset:1024 sc1 lds
    buffer_load_dwordx4 v1, s[8:11], s12 offen offset:2048 sc1 lds
    buffer_load_dwordx4 v1, s[8:11], s12 offen offset:3072 sc1 lds
    s_add_u32 s12, s12, 4096
    s_lshl_b32 s14, s14, 2
    s_add_u32 s14, s14, 162816
    v_mov_b32 v2, s14
    s_add_u32 s13, s13, 1
    s_waitcnt vmcnt(0)
    s_mov_b64 exec, 1
    ds_add_u32 v2, v5 offset:0
    s_mov_b64 exec, -1
    s_cmp_lg_u32 s13, 7
    s_cbranch_scc1 parallel_sum__grouped_kv_mqa__mixer_token_mlp__prompt_kernel_ld_np
    s_cmp_lt_u32 s2, 224
    s_cbranch_scc1 parallel_sum__grouped_kv_mqa__mixer_token_mlp__prompt_kernel_ld_np
    s_mov_b32 s24, s76
    s_and_b32 s25, s77, 0xffff
    s_mov_b32 s26, 7077888
    s_mov_b32 s27, 0x20000
    s_sub_u32 s17, s2, 224
    s_mul_i32 s18, s17, 221184
    v_and_b32 v6, 63, v0
    v_lshlrev_b32 v6, 7, v6
    s_mov_b32 s17, 27
parallel_sum__grouped_kv_mqa__mixer_token_mlp__prompt_kernel_pfl:
    buffer_load_dword v8, v6, s[24:27], s18 offen
    s_add_u32 s18, s18, 8192
    s_sub_u32 s17, s17, 1
    s_cmp_lg_u32 s17, 0
    s_cbranch_scc1 parallel_sum__grouped_kv_mqa__mixer_token_mlp__prompt_kernel_pfl
parallel_sum__grouped_kv_mqa__mixer_token_mlp__prompt_kernel_ld_np:
    s_cmp_lg_u32 s13, 16
    s_cbranch_scc1 parallel_sum__grouped_kv_mqa__mixer_token_mlp__prompt_kernel_ld
    s_mov_b32 s24, s4
    s_and_b32 s25, s5, 0xffff
    s_mov_b32 s26, 16617472
    s_mov_b32 s27, 0x20000
    v_mov_b32 v6, 2822528
    s_mov_b32 s71, 0
    s_mov_b32 s3, 80
    s_mov_b64 exec, 1
parallel_sum__grouped_kv_mqa__mixer_token_mlp__prompt_kernel_gw23:
    global_load_dword v7, v6, s[4:5] sc1
    s_add_u32 s71, s71, 1
    s_waitcnt vmcnt(0)
    v_cmp_gt_u32 s[84:85], s3, v7
    s_nop 1
    s_cmp_eq_u64 s[84:85], 0
    s_cbranch_scc0 parallel_sum__grouped_kv_mqa__mixer_token_mlp__prompt_kernel_gx23
parallel_sum__grouped_kv_mqa__mixer_token_mlp__prompt_kernel_gy23:
    s_mov_b64 exec, -1
    ds_write_b32 v3, v5 offset:172
    s_lshr_b32 s17, s2, 3
    s_and_b32 s20, s17, 7
    s_mul_i32 s17, s17, 25600
    s_add_u32 s17, s17, 10293248
    v_and_b32 v6, 63, v0
    v_min_u32 v6, 49, v6
    v_lshlrev_b32 v6, 7, v6
    buffer_load_dword v8, v6, s[24:27], s17 offen
    s_add_u32 s17, s17, 6400
    buffer_load_dword v8, v6, s[24:27], s17 offen
    s_add_u32 s17, s17, 6400
    buffer_load_dword v8, v6, s[24:27], s17 offen
    s_add_u32 s17, s17, 6400
    buffer_load_dword v8, v6, s[24:27], s17 offen
    s_add_u32 s17, s17, 6400
    v_and_b32 v6, 15, v0
    v_bfe_u32 v7, v0, 4, 2
    v_mul_u32_u24 v7, 10240, v7
    v_lshl_add_u32 v6, v6, 4, v7
    s_mul_i32 s20, s20, 1280
    s_add_u32 s20, s20, 10293248
    s_mov_b32 m0, 143360
    s_nop 0
    buffer_load_dwordx4 v6, s[24:27], s20 offen offset:0 sc1 lds
    s_mov_b32 m0, 144128
    s_nop 0
    buffer_load_dwordx4 v6, s[24:27], s20 offen offset:256 sc1 lds
    s_mov_b32 m0, 144896
    s_nop 0
    buffer_load_dwordx4 v6, s[24:27], s20 offen offset:512 sc1 lds
    s_mov_b32 m0, 145664
    s_nop 0
    buffer_load_dwordx4 v6, s[24:27], s20 offen offset:768 sc1 lds
    s_mov_b32 m0, 146432
    s_nop 0
    buffer_load_dwordx4 v6, s[24:27], s20 offen offset:1024 sc1 lds
    s_add_u32 s20, s20, 40960
    s_mov_b32 m0, 148480
    s_nop 0
    buffer_load_dwordx4 v6, s[24:27], s20 offen offset:0 sc1 lds
    s_mov_b32 m0, 149248
    s_nop 0
    buffer_load_dwordx4 v6, s[24:27], s20 offen offset:256 sc1 lds
    s_mov_b32 m0, 150016
    s_nop 0
    buffer_load_dwordx4 v6, s[24:27], s20 offen offset:512 sc1 lds
    s_mov_b32 m0, 150784
    s_nop 0
    buffer_load_dwordx4 v6, s[24:27], s20 offen offset:768 sc1 lds
    s_mov_b32 m0, 151552
    s_nop 0
    buffer_load_dwordx4 v6, s[24:27], s20 offen offset:1024 sc1 lds
    s_add_u32 s20, s20, 40960
parallel_sum__grouped_kv_mqa__mixer_token_mlp__prompt_kernel_lw24:
    ds_read_b32 v4, v3 offset:124
    s_waitcnt lgkmcnt(0)
    v_cmp_gt_u32 s[84:85], 16, v4
    s_nop 1
    s_cmp_eq_u64 s[84:85], 0
    s_cbranch_scc0 parallel_sum__grouped_kv_mqa__mixer_token_mlp__prompt_kernel_lx24
    s_mov_b32 m0, 0
    s_nop 0
    buffer_load_dwordx4 v6, s[24:27], s20 offen offset:0 sc1 lds
    s_mov_b32 m0, 768
    s_nop 0
    buffer_load_dwordx4 v6, s[24:27], s20 offen offset:256 sc1 lds
    s_mov_b32 m0, 1536
    s_nop 0
    buffer_load_dwordx4 v6, s[24:27], s20 offen offset:512 sc1 lds
    s_mov_b32 m0, 2304
    s_nop 0
    buffer_load_dwordx4 v6, s[24:27], s20 offen offset:768 sc1 lds
    s_mov_b32 m0, 3072
    s_nop 0
    buffer_load_dwordx4 v6, s[24:27], s20 offen offset:1024 sc1 lds
    s_add_u32 s20, s20, 40960
    s_mov_b32 m0, 5120
    s_nop 0
    buffer_load_dwordx4 v6, s[24:27], s20 offen offset:0 sc1 lds
    s_mov_b32 m0, 5888
    s_nop 0
    buffer_load_dwordx4 v6, s[24:27], s20 offen offset:256 sc1 lds
    s_mov_b32 m0, 6656
    s_nop 0
    buffer_load_dwordx4 v6, s[24:27], s20 offen offset:512 sc1 lds
    s_mov_b32 m0, 7424
    s_nop 0
    buffer_load_dwordx4 v6, s[24:27], s20 offen offset:768 sc1 lds
    s_mov_b32 m0, 8192
    s_nop 0
    buffer_load_dwordx4 v6, s[24:27], s20 offen offset:1024 sc1 lds
    s_add_u32 s20, s20, 40960
parallel_sum__grouped_kv_mqa__mixer_token_mlp__prompt_kernel_lw25:
    ds_read_b32 v4, v3 offset:128
    s_waitcnt lgkmcnt(0)
    v_cmp_gt_u32 s[84:85], 16, v4
    s_nop 1
    s_cmp_eq_u64 s[84:85], 0
    s_cbranch_scc0 parallel_sum__grouped_kv_mqa__mixer_token_mlp__prompt_kernel_lx25
    s_mov_b32 m0, 12288
    s_nop 0
    buffer_load_dwordx4 v6, s[24:27], s20 offen offset:0 sc1 lds
    s_mov_b32 m0, 13056
    s_nop 0
    buffer_load_dwordx4 v6, s[24:27], s20 offen offset:256 sc1 lds
    s_mov_b32 m0, 13824
    s_nop 0
    buffer_load_dwordx4 v6, s[24:27], s20 offen offset:512 sc1 lds
    s_mov_b32 m0, 14592
    s_nop 0
    buffer_load_dwordx4 v6, s[24:27], s20 offen offset:768 sc1 lds
    s_mov_b32 m0, 15360
    s_nop 0
    buffer_load_dwordx4 v6, s[24:27], s20 offen offset:1024 sc1 lds
    s_add_u32 s20, s20, 40960
    s_mov_b32 m0, 17408
    s_nop 0
    buffer_load_dwordx4 v6, s[24:27], s20 offen offset:0 sc1 lds
    s_mov_b32 m0, 18176
    s_nop 0
    buffer_load_dwordx4 v6, s[24:27], s20 offen offset:256 sc1 lds
    s_mov_b32 m0, 18944
    s_nop 0
    buffer_load_dwordx4 v6, s[24:27], s20 offen offset:512 sc1 lds
    s_mov_b32 m0, 19712
    s_nop 0
    buffer_load_dwordx4 v6, s[24:27], s20 offen offset:768 sc1 lds
    s_mov_b32 m0, 20480
    s_nop 0
    buffer_load_dwordx4 v6, s[24:27], s20 offen offset:1024 sc1 lds
    s_add_u32 s20, s20, 40960
parallel_sum__grouped_kv_mqa__mixer_token_mlp__prompt_kernel_lw26:
    ds_read_b32 v4, v3 offset:132
    s_waitcnt lgkmcnt(0)
    v_cmp_gt_u32 s[84:85], 16, v4
    s_nop 1
    s_cmp_eq_u64 s[84:85], 0
    s_cbranch_scc0 parallel_sum__grouped_kv_mqa__mixer_token_mlp__prompt_kernel_lx26
    s_mov_b32 m0, 24576
    s_nop 0
    buffer_load_dwordx4 v6, s[24:27], s20 offen offset:0 sc1 lds
    s_mov_b32 m0, 25344
    s_nop 0
    buffer_load_dwordx4 v6, s[24:27], s20 offen offset:256 sc1 lds
    s_mov_b32 m0, 26112
    s_nop 0
    buffer_load_dwordx4 v6, s[24:27], s20 offen offset:512 sc1 lds
    s_mov_b32 m0, 26880
    s_nop 0
    buffer_load_dwordx4 v6, s[24:27], s20 offen offset:768 sc1 lds
    s_mov_b32 m0, 27648
    s_nop 0
    buffer_load_dwordx4 v6, s[24:27], s20 offen offset:1024 sc1 lds
    s_add_u32 s20, s20, 40960
    s_mov_b32 m0, 29696
    s_nop 0
    buffer_load_dwordx4 v6, s[24:27], s20 offen offset:0 sc1 lds
    s_mov_b32 m0, 30464
    s_nop 0
    buffer_load_dwordx4 v6, s[24:27], s20 offen offset:256 sc1 lds
    s_mov_b32 m0, 31232
    s_nop 0
    buffer_load_dwordx4 v6, s[24:27], s20 offen offset:512 sc1 lds
    s_mov_b32 m0, 32000
    s_nop 0
    buffer_load_dwordx4 v6, s[24:27], s20 offen offset:768 sc1 lds
    s_mov_b32 m0, 32768
    s_nop 0
    buffer_load_dwordx4 v6, s[24:27], s20 offen offset:1024 sc1 lds
    s_add_u32 s20, s20, 40960
    s_lshl_b32 s17, s48, 7
    s_add_u32 s17, s17, 2826240
    v_mov_b32 v6, s17
    s_waitcnt vmcnt(0)
    s_endpgm
parallel_sum__grouped_kv_mqa__mixer_token_mlp__prompt_kernel_g:
    s_sub_u32 s6, s70, 4
    s_lshr_b32 s47, s2, 3
    s_mov_b32 s60, s48
    s_and_b32 s48, s46, 1
    s_lshl_b32 s48, s48, 2
    s_and_b32 s49, s47, 3
    s_add_u32 s48, s48, s49
    s_lshr_b32 s49, s46, 1
    s_lshr_b32 s50, s47, 2
    s_and_b32 s64, s47, 7
    s_mul_i32 s49, s49, 7
    s_add_u32 s49, s49, s50
    s_mul_i32 s52, s48, 1280
    v_mov_b32 v7, 1
    s_mov_b32 s8, s4
    s_and_b32 s9, s5, 0xffff
    s_mov_b32 s10, 16617472
    s_mov_b32 s11, 0x20000
    v_and_b32 v112, 63, v0
    v_and_b32 v113, 15, v0
    v_bfe_u32 v114, v0, 4, 2
    s_mul_i32 s28, s6, 23552
    s_add_u32 s28, s28, 49152
    v_lshrrev_b32 v115, 1, v114
    v_lshlrev_b32 v115, 4, v115
    v_and_b32 v116, 1, v114
    v_lshl_add_u32 v115, v116, 2, v115
    v_lshrrev_b32 v117, 2, v113
    v_add_u32 v115, v115, v117
    v_lshlrev_b32 v115, 7, v115
    v_and_b32 v117, 3, v113
    v_lshl_add_u32 v115, v117, 3, v115
    v_add_u32 v115, s28, v115
    v_lshrrev_b32 v117, 3, v113
    v_lshl_add_u32 v117, v116, 1, v117
    s_add_u32 s7, s6, 0
    s_and_b32 s7, s7, 3
    v_xor_b32 v118, s7, v117
    v_lshl_add_u32 v8, v118, 5, v115
    s_add_u32 s7, s6, 1
    s_and_b32 s7, s7, 3
    v_xor_b32 v118, s7, v117
    v_lshl_add_u32 v9, v118, 5, v115
    s_add_u32 s7, s6, 2
    s_and_b32 s7, s7, 3
    v_xor_b32 v118, s7, v117
    v_lshl_add_u32 v10, v118, 5, v115
    s_add_u32 s7, s6, 3
    s_and_b32 s7, s7, 3
    v_xor_b32 v118, s7, v117
    v_lshl_add_u32 v11, v118, 5, v115
    v_mul_u32_u24 v6, 10240, v114
    v_lshl_add_u32 v6, v113, 4, v6
    s_cmp_eq_u32 s50, 7
    s_cbranch_scc1 parallel_sum__grouped_kv_mqa__mixer_token_mlp__prompt_kernel_wo
    s_cmp_ge_u32 s49, 27
    s_cbranch_scc1 parallel_sum__grouped_kv_mqa__mixer_token_mlp__prompt_kernel_nob1
    s_mov_b32 s12, s40
    s_and_b32 s13, s41, 0xffff
    s_mov_b32 s14, 7077888
    s_mov_b32 s15, 0x20000
    s_add_u32 s16, s4, 2838528
    s_addc_u32 s17, s5, 0
    s_and_b32 s17, s17, 0xffff
    s_mov_b32 s18, 2621440
    s_mov_b32 s19, 0x20000
    s_mov_b32 s20, s42
    s_and_b32 s21, s43, 0xffff
    s_mov_b32 s22, 3456
    s_mov_b32 s23, 0x20000
    v_bfe_u32 v118, v0, 3, 2
    v_bfe_u32 v119, v0, 5, 1
    v_lshl_add_u32 v118, v119, 3, v118
    v_mul_u32_u24 v5, 3456, v118
    v_and_b32 v118, 7, v0
    v_lshlrev_b32 v119, 1, v114
    v_xor_b32 v118, v118, v119
    v_lshl_add_u32 v5, v118, 4, v5
    s_lshl_b32 s51, s49, 7
    s_mul_i32 s7, s6, 110592
    s_add_u32 s32, s7, s51
    s_add_u32 s33, s32, 12800
    s_add_u32 s34, s32, 53248
    s_add_u32 s35, s32, 66048
    s_mul_i32 s7, s6, 40960
    s_add_u32 s36, s7, s52
    v_lshlrev_b32 v1, 3, v114
    s_lshl_b32 s53, s6, 5
    s_add_u32 s53, s53, s51
    buffer_load_dwordx2 v[2:3], v1, s[20:23], s53 offen
    s_lshl_b32 s54, s49, 3
    s_lshl_b32 s55, s6, 1
    s_add_u32 s54, s54, s55
    s_mul_i32 s54, s54, 10240
    s_add_u32 s54, s54, s52
    s_add_u32 s54, s54, 5459968
    v_mov_b32 v1, 162816
parallel_sum__grouped_kv_mqa__mixer_token_mlp__prompt_kernel_lw27:
    ds_read_b32 v4, v1 offset:24
    s_waitcnt lgkmcnt(0)
    v_cmp_gt_u32 s[84:85], 4, v4
    s_nop 1
    s_cmp_eq_u64 s[84:85], 0
    s_cbranch_scc0 parallel_sum__grouped_kv_mqa__mixer_token_mlp__prompt_kernel_lx27
parallel_sum__grouped_kv_mqa__mixer_token_mlp__prompt_kernel_lw28:
    ds_read_b32 v4, v1 offset:16
    s_waitcnt lgkmcnt(0)
    v_cmp_gt_u32 s[84:85], 1, v4
    s_nop 1
    s_cmp_eq_u64 s[84:85], 0
    s_cbranch_scc0 parallel_sum__grouped_kv_mqa__mixer_token_mlp__prompt_kernel_lx28
    s_add_u32 m0, s28, 0
    s_nop 0
    buffer_load_dwordx4 v5, s[12:15], s32 offen offset:0 lds
    buffer_load_dwordx4 v5, s[12:15], s33 offen offset:1024 lds
    buffer_load_dwordx4 v5, s[12:15], s34 offen offset:2048 lds
    buffer_load_dwordx4 v5, s[12:15], s35 offen offset:3072 lds
    s_add_u32 s32, s32, 442368
    s_add_u32 s33, s33, 442368
    s_add_u32 s34, s34, 442368
    s_add_u32 s35, s35, 442368
    buffer_load_dwordx4 v[92:95], v6, s[16:19], s36 offen offset:0 sc1
    buffer_load_dwordx4 v[96:99], v6, s[16:19], s36 offen offset:256 sc1
    buffer_load_dwordx4 v[100:103], v6, s[16:19], s36 offen offset:512 sc1
    buffer_load_dwordx4 v[104:107], v6, s[16:19], s36 offen offset:768 sc1
    buffer_load_dwordx4 v[108:111], v6, s[16:19], s36 offen offset:1024 sc1
    s_add_u32 s36, s36, 163840
    s_add_u32 m0, s28, 4096
    s_nop 0
    buffer_load_dwordx4 v5, s[12:15], s32 offen offset:0 lds
    buffer_load_dwordx4 v5, s[12:15], s33 offen offset:1024 lds
    buffer_load_dwordx4 v5, s[12:15], s34 offen offset:2048 lds
    buffer_load_dwordx4 v5, s[12:15], s35 offen offset:3072 lds
    s_add_u32 s32, s32, 442368
    s_add_u32 s33, s33, 442368
    s_add_u32 s34, s34, 442368
    s_add_u32 s35, s35, 442368
    buffer_load_dwordx4 v[112:115], v6, s[16:19], s36 offen offset:0 sc1
    buffer_load_dwordx4 v[116:119], v6, s[16:19], s36 offen offset:256 sc1
    buffer_load_dwordx4 v[120:123], v6, s[16:19], s36 offen offset:512 sc1
    buffer_load_dwordx4 v[124:127], v6, s[16:19], s36 offen offset:768 sc1
    buffer_load_dwordx4 v[128:131], v6, s[16:19], s36 offen offset:1024 sc1
    s_add_u32 s36, s36, 163840
    s_add_u32 m0, s28, 8192
    s_nop 0
    buffer_load_dwordx4 v5, s[12:15], s32 offen offset:0 lds
    buffer_load_dwordx4 v5, s[12:15], s33 offen offset:1024 lds
    buffer_load_dwordx4 v5, s[12:15], s34 offen offset:2048 lds
    buffer_load_dwordx4 v5, s[12:15], s35 offen offset:3072 lds
    s_add_u32 s32, s32, 442368
    s_add_u32 s33, s33, 442368
    s_add_u32 s34, s34, 442368
    s_add_u32 s35, s35, 442368
    s_mov_b32 s37, 15
    s_waitcnt vmcnt(18)
    ds_read_b64_tr_b16 v[152:153], v8 offset:0
    ds_read_b64_tr_b16 v[154:155], v8 offset:1024
    ds_read_b64_tr_b16 v[156:157], v9 offset:0
    ds_read_b64_tr_b16 v[158:159], v9 offset:1024
    ds_read_b64_tr_b16 v[160:161], v10 offset:0
    ds_read_b64_tr_b16 v[162:163], v10 offset:1024
    ds_read_b64_tr_b16 v[164:165], v11 offset:0
    ds_read_b64_tr_b16 v[166:167], v11 offset:1024
    s_waitcnt vmcnt(13)
    s_waitcnt lgkmcnt(6)
    v_mfma_f32_16x16x32_bf16 v[12:15], v[152:155], v[92:95], 0
    s_add_u32 m0, s28, 0
    v_mfma_f32_16x16x32_bf16 v[16:19], v[152:155], v[96:99], 0
    buffer_load_dwordx4 v[132:135], v6, s[16:19], s36 offen offset:0 sc1
    v_mfma_f32_16x16x32_bf16 v[20:23], v[152:155], v[100:103], 0
    v_mfma_f32_16x16x32_bf16 v[24:27], v[152:155], v[104:107], 0
    buffer_load_dwordx4 v[136:139], v6, s[16:19], s36 offen offset:256 sc1
    v_mfma_f32_16x16x32_bf16 v[28:31], v[152:155], v[108:111], 0
    s_waitcnt vmcnt(11)
    ds_read_b64_tr_b16 v[152:153], v8 offset:4096
    ds_read_b64_tr_b16 v[154:155], v8 offset:5120
    s_waitcnt lgkmcnt(6)
    v_mfma_f32_16x16x32_bf16 v[32:35], v[156:159], v[92:95], 0
    v_mfma_f32_16x16x32_bf16 v[36:39], v[156:159], v[96:99], 0
    buffer_load_dwordx4 v[140:143], v6, s[16:19], s36 offen offset:512 sc1
    v_mfma_f32_16x16x32_bf16 v[40:43], v[156:159], v[100:103], 0
    v_mfma_f32_16x16x32_bf16 v[44:47], v[156:159], v[104:107], 0
    buffer_load_dwordx4 v[144:147], v6, s[16:19], s36 offen offset:768 sc1
    v_mfma_f32_16x16x32_bf16 v[48:51], v[156:159], v[108:111], 0
    ds_read_b64_tr_b16 v[156:157], v9 offset:4096
    ds_read_b64_tr_b16 v[158:159], v9 offset:5120
    s_waitcnt lgkmcnt(6)
    v_mfma_f32_16x16x32_bf16 v[52:55], v[160:163], v[92:95], 0
    v_mfma_f32_16x16x32_bf16 v[56:59], v[160:163], v[96:99], 0
    buffer_load_dwordx4 v[148:151], v6, s[16:19], s36 offen offset:1024 sc1
    s_add_u32 s36, s36, 163840
    v_mfma_f32_16x16x32_bf16 v[60:63], v[160:163], v[100:103], 0
    v_mfma_f32_16x16x32_bf16 v[64:67], v[160:163], v[104:107], 0
    v_mfma_f32_16x16x32_bf16 v[68:71], v[160:163], v[108:111], 0
    ds_read_b64_tr_b16 v[160:161], v10 offset:4096
    ds_read_b64_tr_b16 v[162:163], v10 offset:5120
    s_waitcnt lgkmcnt(6)
    v_mfma_f32_16x16x32_bf16 v[72:75], v[164:167], v[92:95], 0
    buffer_load_dwordx4 v5, s[12:15], s32 offen offset:0 lds
    v_mfma_f32_16x16x32_bf16 v[76:79], v[164:167], v[96:99], 0
    buffer_load_dwordx4 v5, s[12:15], s33 offen offset:1024 lds
    v_mfma_f32_16x16x32_bf16 v[80:83], v[164:167], v[100:103], 0
    buffer_load_dwordx4 v5, s[12:15], s34 offen offset:2048 lds
    v_mfma_f32_16x16x32_bf16 v[84:87], v[164:167], v[104:107], 0
    buffer_load_dwordx4 v5, s[12:15], s35 offen offset:3072 lds
    s_add_u32 s32, s32, 442368
    s_add_u32 s33, s33, 442368
    s_add_u32 s34, s34, 442368
    s_add_u32 s35, s35, 442368
    v_mfma_f32_16x16x32_bf16 v[88:91], v[164:167], v[108:111], 0
    ds_read_b64_tr_b16 v[164:165], v11 offset:4096
    ds_read_b64_tr_b16 v[166:167], v11 offset:5120
parallel_sum__grouped_kv_mqa__mixer_token_mlp__prompt_kernel_b1_loop:
    s_waitcnt vmcnt(13)
    s_waitcnt lgkmcnt(6)
    v_mfma_f32_16x16x32_bf16 v[12:15], v[152:155], v[112:115], v[12:15]
    s_add_u32 m0, s28, 4096
    v_mfma_f32_16x16x32_bf16 v[16:19], v[152:155], v[116:119], v[16:19]
    buffer_load_dwordx4 v[92:95], v6, s[16:19], s36 offen offset:0 sc1
    v_mfma_f32_16x16x32_bf16 v[20:23], v[152:155], v[120:123], v[20:23]
    v_mfma_f32_16x16x32_bf16 v[24:27], v[152:155], v[124:127], v[24:27]
    buffer_load_dwordx4 v[96:99], v6, s[16:19], s36 offen offset:256 sc1
    v_mfma_f32_16x16x32_bf16 v[28:31], v[152:155], v[128:131], v[28:31]
    s_waitcnt vmcnt(11)
    ds_read_b64_tr_b16 v[152:153], v8 offset:8192
    ds_read_b64_tr_b16 v[154:155], v8 offset:9216
    s_waitcnt lgkmcnt(6)
    v_mfma_f32_16x16x32_bf16 v[32:35], v[156:159], v[112:115], v[32:35]
    v_mfma_f32_16x16x32_bf16 v[36:39], v[156:159], v[116:119], v[36:39]
    buffer_load_dwordx4 v[100:103], v6, s[16:19], s36 offen offset:512 sc1
    v_mfma_f32_16x16x32_bf16 v[40:43], v[156:159], v[120:123], v[40:43]
    v_mfma_f32_16x16x32_bf16 v[44:47], v[156:159], v[124:127], v[44:47]
    buffer_load_dwordx4 v[104:107], v6, s[16:19], s36 offen offset:768 sc1
    v_mfma_f32_16x16x32_bf16 v[48:51], v[156:159], v[128:131], v[48:51]
    ds_read_b64_tr_b16 v[156:157], v9 offset:8192
    ds_read_b64_tr_b16 v[158:159], v9 offset:9216
    s_waitcnt lgkmcnt(6)
    v_mfma_f32_16x16x32_bf16 v[52:55], v[160:163], v[112:115], v[52:55]
    v_mfma_f32_16x16x32_bf16 v[56:59], v[160:163], v[116:119], v[56:59]
    buffer_load_dwordx4 v[108:111], v6, s[16:19], s36 offen offset:1024 sc1
    s_add_u32 s36, s36, 163840
    v_mfma_f32_16x16x32_bf16 v[60:63], v[160:163], v[120:123], v[60:63]
    v_mfma_f32_16x16x32_bf16 v[64:67], v[160:163], v[124:127], v[64:67]
    v_mfma_f32_16x16x32_bf16 v[68:71], v[160:163], v[128:131], v[68:71]
    ds_read_b64_tr_b16 v[160:161], v10 offset:8192
    ds_read_b64_tr_b16 v[162:163], v10 offset:9216
    s_waitcnt lgkmcnt(6)
    v_mfma_f32_16x16x32_bf16 v[72:75], v[164:167], v[112:115], v[72:75]
    buffer_load_dwordx4 v5, s[12:15], s32 offen offset:0 lds
    v_mfma_f32_16x16x32_bf16 v[76:79], v[164:167], v[116:119], v[76:79]
    buffer_load_dwordx4 v5, s[12:15], s33 offen offset:1024 lds
    v_mfma_f32_16x16x32_bf16 v[80:83], v[164:167], v[120:123], v[80:83]
    buffer_load_dwordx4 v5, s[12:15], s34 offen offset:2048 lds
    v_mfma_f32_16x16x32_bf16 v[84:87], v[164:167], v[124:127], v[84:87]
    buffer_load_dwordx4 v5, s[12:15], s35 offen offset:3072 lds
    s_add_u32 s32, s32, 442368
    s_add_u32 s33, s33, 442368
    s_add_u32 s34, s34, 442368
    s_add_u32 s35, s35, 442368
    v_mfma_f32_16x16x32_bf16 v[88:91], v[164:167], v[128:131], v[88:91]
    ds_read_b64_tr_b16 v[164:165], v11 offset:8192
    ds_read_b64_tr_b16 v[166:167], v11 offset:9216
    s_sub_u32 s37, s37, 1
    s_cmp_eq_u32 s37, 0
    s_cbranch_scc1 parallel_sum__grouped_kv_mqa__mixer_token_mlp__prompt_kernel_b1_done
    s_waitcnt vmcnt(13)
    s_waitcnt lgkmcnt(6)
    v_mfma_f32_16x16x32_bf16 v[12:15], v[152:155], v[132:135], v[12:15]
    s_add_u32 m0, s28, 8192
    v_mfma_f32_16x16x32_bf16 v[16:19], v[152:155], v[136:139], v[16:19]
    buffer_load_dwordx4 v[112:115], v6, s[16:19], s36 offen offset:0 sc1
    v_mfma_f32_16x16x32_bf16 v[20:23], v[152:155], v[140:143], v[20:23]
    v_mfma_f32_16x16x32_bf16 v[24:27], v[152:155], v[144:147], v[24:27]
    buffer_load_dwordx4 v[116:119], v6, s[16:19], s36 offen offset:256 sc1
    v_mfma_f32_16x16x32_bf16 v[28:31], v[152:155], v[148:151], v[28:31]
    s_waitcnt vmcnt(11)
    ds_read_b64_tr_b16 v[152:153], v8 offset:0
    ds_read_b64_tr_b16 v[154:155], v8 offset:1024
    s_waitcnt lgkmcnt(6)
    v_mfma_f32_16x16x32_bf16 v[32:35], v[156:159], v[132:135], v[32:35]
    v_mfma_f32_16x16x32_bf16 v[36:39], v[156:159], v[136:139], v[36:39]
    buffer_load_dwordx4 v[120:123], v6, s[16:19], s36 offen offset:512 sc1
    v_mfma_f32_16x16x32_bf16 v[40:43], v[156:159], v[140:143], v[40:43]
    v_mfma_f32_16x16x32_bf16 v[44:47], v[156:159], v[144:147], v[44:47]
    buffer_load_dwordx4 v[124:127], v6, s[16:19], s36 offen offset:768 sc1
    v_mfma_f32_16x16x32_bf16 v[48:51], v[156:159], v[148:151], v[48:51]
    ds_read_b64_tr_b16 v[156:157], v9 offset:0
    ds_read_b64_tr_b16 v[158:159], v9 offset:1024
    s_waitcnt lgkmcnt(6)
    v_mfma_f32_16x16x32_bf16 v[52:55], v[160:163], v[132:135], v[52:55]
    v_mfma_f32_16x16x32_bf16 v[56:59], v[160:163], v[136:139], v[56:59]
    buffer_load_dwordx4 v[128:131], v6, s[16:19], s36 offen offset:1024 sc1
    s_add_u32 s36, s36, 163840
    v_mfma_f32_16x16x32_bf16 v[60:63], v[160:163], v[140:143], v[60:63]
    v_mfma_f32_16x16x32_bf16 v[64:67], v[160:163], v[144:147], v[64:67]
    v_mfma_f32_16x16x32_bf16 v[68:71], v[160:163], v[148:151], v[68:71]
    ds_read_b64_tr_b16 v[160:161], v10 offset:0
    ds_read_b64_tr_b16 v[162:163], v10 offset:1024
    s_waitcnt lgkmcnt(6)
    v_mfma_f32_16x16x32_bf16 v[72:75], v[164:167], v[132:135], v[72:75]
    buffer_load_dwordx4 v5, s[12:15], s32 offen offset:0 lds
    v_mfma_f32_16x16x32_bf16 v[76:79], v[164:167], v[136:139], v[76:79]
    buffer_load_dwordx4 v5, s[12:15], s33 offen offset:1024 lds
    v_mfma_f32_16x16x32_bf16 v[80:83], v[164:167], v[140:143], v[80:83]
    buffer_load_dwordx4 v5, s[12:15], s34 offen offset:2048 lds
    v_mfma_f32_16x16x32_bf16 v[84:87], v[164:167], v[144:147], v[84:87]
    buffer_load_dwordx4 v5, s[12:15], s35 offen offset:3072 lds
    s_add_u32 s32, s32, 442368
    s_add_u32 s33, s33, 442368
    s_add_u32 s34, s34, 442368
    s_add_u32 s35, s35, 442368
    v_mfma_f32_16x16x32_bf16 v[88:91], v[164:167], v[148:151], v[88:91]
    ds_read_b64_tr_b16 v[164:165], v11 offset:0
    ds_read_b64_tr_b16 v[166:167], v11 offset:1024
    s_sub_u32 s37, s37, 1
    s_cmp_eq_u32 s37, 0
    s_cbranch_scc1 parallel_sum__grouped_kv_mqa__mixer_token_mlp__prompt_kernel_b1_done
    s_waitcnt vmcnt(13)
    s_waitcnt lgkmcnt(6)
    v_mfma_f32_16x16x32_bf16 v[12:15], v[152:155], v[92:95], v[12:15]
    s_add_u32 m0, s28, 0
    v_mfma_f32_16x16x32_bf16 v[16:19], v[152:155], v[96:99], v[16:19]
    buffer_load_dwordx4 v[132:135], v6, s[16:19], s36 offen offset:0 sc1
    v_mfma_f32_16x16x32_bf16 v[20:23], v[152:155], v[100:103], v[20:23]
    v_mfma_f32_16x16x32_bf16 v[24:27], v[152:155], v[104:107], v[24:27]
    buffer_load_dwordx4 v[136:139], v6, s[16:19], s36 offen offset:256 sc1
    v_mfma_f32_16x16x32_bf16 v[28:31], v[152:155], v[108:111], v[28:31]
    s_waitcnt vmcnt(11)
    ds_read_b64_tr_b16 v[152:153], v8 offset:4096
    ds_read_b64_tr_b16 v[154:155], v8 offset:5120
    s_waitcnt lgkmcnt(6)
    v_mfma_f32_16x16x32_bf16 v[32:35], v[156:159], v[92:95], v[32:35]
    v_mfma_f32_16x16x32_bf16 v[36:39], v[156:159], v[96:99], v[36:39]
    buffer_load_dwordx4 v[140:143], v6, s[16:19], s36 offen offset:512 sc1
    v_mfma_f32_16x16x32_bf16 v[40:43], v[156:159], v[100:103], v[40:43]
    v_mfma_f32_16x16x32_bf16 v[44:47], v[156:159], v[104:107], v[44:47]
    buffer_load_dwordx4 v[144:147], v6, s[16:19], s36 offen offset:768 sc1
    v_mfma_f32_16x16x32_bf16 v[48:51], v[156:159], v[108:111], v[48:51]
    ds_read_b64_tr_b16 v[156:157], v9 offset:4096
    ds_read_b64_tr_b16 v[158:159], v9 offset:5120
    s_waitcnt lgkmcnt(6)
    v_mfma_f32_16x16x32_bf16 v[52:55], v[160:163], v[92:95], v[52:55]
    v_mfma_f32_16x16x32_bf16 v[56:59], v[160:163], v[96:99], v[56:59]
    buffer_load_dwordx4 v[148:151], v6, s[16:19], s36 offen offset:1024 sc1
    s_add_u32 s36, s36, 163840
    v_mfma_f32_16x16x32_bf16 v[60:63], v[160:163], v[100:103], v[60:63]
    v_mfma_f32_16x16x32_bf16 v[64:67], v[160:163], v[104:107], v[64:67]
    v_mfma_f32_16x16x32_bf16 v[68:71], v[160:163], v[108:111], v[68:71]
    ds_read_b64_tr_b16 v[160:161], v10 offset:4096
    ds_read_b64_tr_b16 v[162:163], v10 offset:5120
    s_waitcnt lgkmcnt(6)
    v_mfma_f32_16x16x32_bf16 v[72:75], v[164:167], v[92:95], v[72:75]
    buffer_load_dwordx4 v5, s[12:15], s32 offen offset:0 lds
    v_mfma_f32_16x16x32_bf16 v[76:79], v[164:167], v[96:99], v[76:79]
    buffer_load_dwordx4 v5, s[12:15], s33 offen offset:1024 lds
    v_mfma_f32_16x16x32_bf16 v[80:83], v[164:167], v[100:103], v[80:83]
    buffer_load_dwordx4 v5, s[12:15], s34 offen offset:2048 lds
    v_mfma_f32_16x16x32_bf16 v[84:87], v[164:167], v[104:107], v[84:87]
    buffer_load_dwordx4 v5, s[12:15], s35 offen offset:3072 lds
    s_add_u32 s32, s32, 442368
    s_add_u32 s33, s33, 442368
    s_add_u32 s34, s34, 442368
    s_add_u32 s35, s35, 442368
    v_mfma_f32_16x16x32_bf16 v[88:91], v[164:167], v[108:111], v[88:91]
    ds_read_b64_tr_b16 v[164:165], v11 offset:4096
    ds_read_b64_tr_b16 v[166:167], v11 offset:5120
    s_sub_u32 s37, s37, 1
    s_cmp_eq_u32 s37, 0
    s_cbranch_scc0 parallel_sum__grouped_kv_mqa__mixer_token_mlp__prompt_kernel_b1_loop
parallel_sum__grouped_kv_mqa__mixer_token_mlp__prompt_kernel_b1_done:
    s_setprio 2
    v_and_b32 v1, 63, v0
    v_lshlrev_b32 v1, 4, v1
    v_add_u32 v1, s28, v1
    ds_write_b128 v1, v[48:51] offset:12288
    ds_write_b128 v1, v[52:55] offset:13312
    ds_write_b128 v1, v[56:59] offset:14336
    ds_write_b128 v1, v[60:63] offset:15360
    ds_write_b128 v1, v[64:67] offset:16384
    ds_write_b128 v1, v[68:71] offset:17408
    ds_write_b128 v1, v[72:75] offset:18432
    ds_write_b128 v1, v[76:79] offset:19456
    ds_write_b128 v1, v[80:83] offset:20480
    ds_write_b128 v1, v[84:87] offset:21504
    ds_write_b128 v1, v[88:91] offset:22528
    s_waitcnt vmcnt(0)
    ds_write_b128 v1, v[32:35] offset:8192
    ds_write_b128 v1, v[36:39] offset:9216
    ds_write_b128 v1, v[40:43] offset:10240
    ds_write_b128 v1, v[44:47] offset:11264
    v_and_b32 v112, 63, v0
    v_lshlrev_b32 v112, 4, v112
    s_mov_b32 s20, s56
    s_and_b32 s21, s57, 0xffff
    s_mov_b32 s22, 2621440
    s_mov_b32 s23, 0x20000
    s_mov_b32 s24, s72
    s_and_b32 s25, s73, 0xffff
    s_mov_b32 s26, 4096
    s_mov_b32 s27, 0x20000
    s_lshl_b32 s53, s60, 2
    s_add_u32 s53, s53, s6
    s_lshl_b32 s7, s53, 5
    s_mul_i32 s53, s53, 20480
    s_mul_i32 s55, s64, 160
    s_add_u32 s53, s53, s55
    v_and_b32 v1, 15, v0
    v_lshlrev_b32 v4, 1, v1
    v_mul_u32_u24 v1, 1280, v1
    v_bfe_u32 v5, v0, 4, 2
    v_lshl_add_u32 v1, v5, 3, v1
    buffer_load_ushort v4, v4, s[24:27], s7 offen
    buffer_load_dwordx2 v[132:133], v1, s[20:23], s53 offen offset:0
    buffer_load_dwordx2 v[134:135], v1, s[20:23], s53 offen offset:32
    buffer_load_dwordx2 v[136:137], v1, s[20:23], s53 offen offset:64
    buffer_load_dwordx2 v[138:139], v1, s[20:23], s53 offen offset:96
    buffer_load_dwordx2 v[140:141], v1, s[20:23], s53 offen offset:128
    s_sub_u32 s7, s6, 1
    s_and_b32 s7, s7, 3
    s_mul_i32 s7, s7, 23552
    s_add_u32 s7, s7, 57344
    v_add_u32 v114, s7, v112
    s_sub_u32 s7, s6, 2
    s_and_b32 s7, s7, 3
    s_mul_i32 s7, s7, 23552
    s_add_u32 s7, s7, 62464
    v_add_u32 v115, s7, v112
    s_sub_u32 s7, s6, 3
    s_and_b32 s7, s7, 3
    s_mul_i32 s7, s7, 23552
    s_add_u32 s7, s7, 67584
    v_add_u32 v116, s7, v112
    s_waitcnt lgkmcnt(0)
    v_mov_b32 v120, 162816
    s_mov_b64 exec, 1
    ds_add_u32 v120, v7 offset:136
    s_mov_b64 exec, -1
parallel_sum__grouped_kv_mqa__mixer_token_mlp__prompt_kernel_lw29:
    ds_read_b32 v122, v120 offset:136
    s_waitcnt lgkmcnt(0)
    v_cmp_gt_u32 s[84:85], 4, v122
    s_nop 1
    s_cmp_eq_u64 s[84:85], 0
    s_cbranch_scc0 parallel_sum__grouped_kv_mqa__mixer_token_mlp__prompt_kernel_lx29
    ds_read_b128 v[32:35], v114 offset:0
    ds_read_b128 v[36:39], v114 offset:1024
    ds_read_b128 v[40:43], v114 offset:2048
    ds_read_b128 v[44:47], v114 offset:3072
    ds_read_b128 v[48:51], v114 offset:4096
    ds_read_b128 v[52:55], v115 offset:0
    ds_read_b128 v[56:59], v115 offset:1024
    ds_read_b128 v[60:63], v115 offset:2048
    ds_read_b128 v[64:67], v115 offset:3072
    ds_read_b128 v[68:71], v115 offset:4096
    ds_read_b128 v[72:75], v116 offset:0
    ds_read_b128 v[76:79], v116 offset:1024
    ds_read_b128 v[80:83], v116 offset:2048
    ds_read_b128 v[84:87], v116 offset:3072
    ds_read_b128 v[88:91], v116 offset:4096
    s_waitcnt lgkmcnt(10)
    v_pk_add_f32 v[12:13], v[12:13], v[32:33]
    v_pk_add_f32 v[14:15], v[14:15], v[34:35]
    v_pk_add_f32 v[16:17], v[16:17], v[36:37]
    v_pk_add_f32 v[18:19], v[18:19], v[38:39]
    v_pk_add_f32 v[20:21], v[20:21], v[40:41]
    v_pk_add_f32 v[22:23], v[22:23], v[42:43]
    v_pk_add_f32 v[24:25], v[24:25], v[44:45]
    v_pk_add_f32 v[26:27], v[26:27], v[46:47]
    v_pk_add_f32 v[28:29], v[28:29], v[48:49]
    v_pk_add_f32 v[30:31], v[30:31], v[50:51]
    s_waitcnt lgkmcnt(5)
    v_pk_add_f32 v[12:13], v[12:13], v[52:53]
    v_pk_add_f32 v[14:15], v[14:15], v[54:55]
    v_pk_add_f32 v[16:17], v[16:17], v[56:57]
    v_pk_add_f32 v[18:19], v[18:19], v[58:59]
    v_pk_add_f32 v[20:21], v[20:21], v[60:61]
    v_pk_add_f32 v[22:23], v[22:23], v[62:63]
    v_pk_add_f32 v[24:25], v[24:25], v[64:65]
    v_pk_add_f32 v[26:27], v[26:27], v[66:67]
    v_pk_add_f32 v[28:29], v[28:29], v[68:69]
    v_pk_add_f32 v[30:31], v[30:31], v[70:71]
    s_waitcnt lgkmcnt(0)
    v_pk_add_f32 v[12:13], v[12:13], v[72:73]
    v_pk_add_f32 v[14:15], v[14:15], v[74:75]
    v_pk_add_f32 v[16:17], v[16:17], v[76:77]
    v_pk_add_f32 v[18:19], v[18:19], v[78:79]
    v_pk_add_f32 v[20:21], v[20:21], v[80:81]
    v_pk_add_f32 v[22:23], v[22:23], v[82:83]
    v_pk_add_f32 v[24:25], v[24:25], v[84:85]
    v_pk_add_f32 v[26:27], v[26:27], v[86:87]
    v_pk_add_f32 v[28:29], v[28:29], v[88:89]
    v_pk_add_f32 v[30:31], v[30:31], v[90:91]
    v_lshlrev_b32 v112, 16, v2
    v_and_b32 v113, 0xffff0000, v2
    v_lshlrev_b32 v114, 16, v3
    v_and_b32 v115, 0xffff0000, v3
    v_mov_b32 v72, 0xc0135761
    v_mov_b32 v73, 0xc0135761
    v_mov_b32 v74, 0xbdd2d3e8
    v_mov_b32 v75, 0xbdd2d3e8
    v_mov_b32 v76, 0x3f800000
    v_mov_b32 v77, 0x3f800000
    v_pk_add_f32 v[12:13], v[12:13], v[112:113]
    v_pk_add_f32 v[14:15], v[14:15], v[114:115]
    v_pk_add_f32 v[16:17], v[16:17], v[112:113]
    v_pk_add_f32 v[18:19], v[18:19], v[114:115]
    v_pk_add_f32 v[20:21], v[20:21], v[112:113]
    v_pk_add_f32 v[22:23], v[22:23], v[114:115]
    v_pk_add_f32 v[24:25], v[24:25], v[112:113]
    v_pk_add_f32 v[26:27], v[26:27], v[114:115]
    v_pk_add_f32 v[28:29], v[28:29], v[112:113]
    v_pk_add_f32 v[30:31], v[30:31], v[114:115]
    v_pk_mul_f32 v[32:33], v[12:13], v[12:13]
    v_pk_mul_f32 v[34:35], v[14:15], v[14:15]
    v_pk_mul_f32 v[36:37], v[16:17], v[16:17]
    v_pk_mul_f32 v[38:39], v[18:19], v[18:19]
    v_pk_mul_f32 v[40:41], v[20:21], v[20:21]
    v_pk_mul_f32 v[42:43], v[22:23], v[22:23]
    v_pk_mul_f32 v[44:45], v[24:25], v[24:25]
    v_pk_mul_f32 v[46:47], v[26:27], v[26:27]
    v_pk_mul_f32 v[48:49], v[28:29], v[28:29]
    v_pk_mul_f32 v[50:51], v[30:31], v[30:31]
    v_pk_fma_f32 v[32:33], v[32:33], v[74:75], v[72:73]
    v_pk_fma_f32 v[34:35], v[34:35], v[74:75], v[72:73]
    v_pk_fma_f32 v[36:37], v[36:37], v[74:75], v[72:73]
    v_pk_fma_f32 v[38:39], v[38:39], v[74:75], v[72:73]
    v_pk_fma_f32 v[40:41], v[40:41], v[74:75], v[72:73]
    v_pk_fma_f32 v[42:43], v[42:43], v[74:75], v[72:73]
    v_pk_fma_f32 v[44:45], v[44:45], v[74:75], v[72:73]
    v_pk_fma_f32 v[46:47], v[46:47], v[74:75], v[72:73]
    v_pk_fma_f32 v[48:49], v[48:49], v[74:75], v[72:73]
    v_pk_fma_f32 v[50:51], v[50:51], v[74:75], v[72:73]
    v_pk_mul_f32 v[32:33], v[32:33], v[12:13]
    v_pk_mul_f32 v[34:35], v[34:35], v[14:15]
    v_pk_mul_f32 v[36:37], v[36:37], v[16:17]
    v_pk_mul_f32 v[38:39], v[38:39], v[18:19]
    v_pk_mul_f32 v[40:41], v[40:41], v[20:21]
    v_pk_mul_f32 v[42:43], v[42:43], v[22:23]
    v_pk_mul_f32 v[44:45], v[44:45], v[24:25]
    v_pk_mul_f32 v[46:47], v[46:47], v[26:27]
    v_pk_mul_f32 v[48:49], v[48:49], v[28:29]
    v_pk_mul_f32 v[50:51], v[50:51], v[30:31]
    v_exp_f32 v32, v32
    v_exp_f32 v33, v33
    v_exp_f32 v34, v34
    v_exp_f32 v35, v35
    v_exp_f32 v36, v36
    v_exp_f32 v37, v37
    v_exp_f32 v38, v38
    v_exp_f32 v39, v39
    v_exp_f32 v40, v40
    v_exp_f32 v41, v41
    v_exp_f32 v42, v42
    v_exp_f32 v43, v43
    v_exp_f32 v44, v44
    v_exp_f32 v45, v45
    v_exp_f32 v46, v46
    v_exp_f32 v47, v47
    v_exp_f32 v48, v48
    v_exp_f32 v49, v49
    v_exp_f32 v50, v50
    v_exp_f32 v51, v51
    v_pk_add_f32 v[32:33], v[32:33], v[76:77]
    v_pk_add_f32 v[34:35], v[34:35], v[76:77]
    v_pk_add_f32 v[36:37], v[36:37], v[76:77]
    v_pk_add_f32 v[38:39], v[38:39], v[76:77]
    v_pk_add_f32 v[40:41], v[40:41], v[76:77]
    v_pk_add_f32 v[42:43], v[42:43], v[76:77]
    v_pk_add_f32 v[44:45], v[44:45], v[76:77]
    v_pk_add_f32 v[46:47], v[46:47], v[76:77]
    v_pk_add_f32 v[48:49], v[48:49], v[76:77]
    v_pk_add_f32 v[50:51], v[50:51], v[76:77]
    v_rcp_f32 v32, v32
    v_rcp_f32 v33, v33
    v_rcp_f32 v34, v34
    v_rcp_f32 v35, v35
    v_rcp_f32 v36, v36
    v_rcp_f32 v37, v37
    v_rcp_f32 v38, v38
    v_rcp_f32 v39, v39
    v_rcp_f32 v40, v40
    v_rcp_f32 v41, v41
    v_rcp_f32 v42, v42
    v_rcp_f32 v43, v43
    v_rcp_f32 v44, v44
    v_rcp_f32 v45, v45
    v_rcp_f32 v46, v46
    v_rcp_f32 v47, v47
    v_rcp_f32 v48, v48
    v_rcp_f32 v49, v49
    v_rcp_f32 v50, v50
    v_rcp_f32 v51, v51
    v_pk_mul_f32 v[32:33], v[32:33], v[12:13]
    v_pk_mul_f32 v[34:35], v[34:35], v[14:15]
    v_pk_mul_f32 v[36:37], v[36:37], v[16:17]
    v_pk_mul_f32 v[38:39], v[38:39], v[18:19]
    v_pk_mul_f32 v[40:41], v[40:41], v[20:21]
    v_pk_mul_f32 v[42:43], v[42:43], v[22:23]
    v_pk_mul_f32 v[44:45], v[44:45], v[24:25]
    v_pk_mul_f32 v[46:47], v[46:47], v[26:27]
    v_pk_mul_f32 v[48:49], v[48:49], v[28:29]
    v_pk_mul_f32 v[50:51], v[50:51], v[30:31]
    v_cvt_pk_bf16_f32 v52, v32, v33
    v_cvt_pk_bf16_f32 v53, v34, v35
    v_cvt_pk_bf16_f32 v54, v36, v37
    v_cvt_pk_bf16_f32 v55, v38, v39
    v_cvt_pk_bf16_f32 v56, v40, v41
    v_cvt_pk_bf16_f32 v57, v42, v43
    v_cvt_pk_bf16_f32 v58, v44, v45
    v_cvt_pk_bf16_f32 v59, v46, v47
    v_cvt_pk_bf16_f32 v60, v48, v49
    v_cvt_pk_bf16_f32 v61, v50, v51
    v_mov_b32 v62, v60
    v_mov_b32 v63, v61
    v_and_b32 v112, 15, v0
    v_bfe_u32 v113, v0, 4, 1
    v_bfe_u32 v114, v0, 5, 1
    v_lshl_add_u32 v112, v113, 4, v112
    v_lshlrev_b32 v112, 4, v112
    v_mul_u32_u24 v114, 10240, v114
    v_add_u32 v112, v112, v114
    v_permlane16_swap_b32 v52, v54
    v_permlane16_swap_b32 v53, v55
    v_permlane16_swap_b32 v56, v58
    v_permlane16_swap_b32 v57, v59
    v_permlane16_swap_b32 v60, v62
    v_permlane16_swap_b32 v61, v63
    s_nop 1
    buffer_store_dwordx4 v[52:55], v112, s[8:11], s54 offen offset:0 sc1
    buffer_store_dwordx4 v[56:59], v112, s[8:11], s54 offen offset:512 sc1
    s_mov_b32 exec_lo, 0xffff
    s_mov_b32 exec_hi, 0xffff
    buffer_store_dwordx4 v[60:63], v112, s[8:11], s54 offen offset:1024 sc1
    s_mov_b64 exec, -1
    s_mov_b32 s12, s76
    s_and_b32 s13, s77, 0xffff
    s_mov_b32 s14, 7077888
    s_mov_b32 s15, 0x20000
    s_add_u32 s16, s4, 5459968
    s_addc_u32 s17, s5, 0
    s_and_b32 s17, s17, 0xffff
    s_mov_b32 s18, 2211840
    s_mov_b32 s19, 0x20000
    v_bfe_u32 v114, v0, 4, 2
    v_bfe_u32 v118, v0, 3, 2
    v_bfe_u32 v119, v0, 5, 1
    v_lshl_add_u32 v118, v119, 3, v118
    v_mul_u32_u24 v5, 4096, v118
    v_and_b32 v118, 7, v0
    v_lshlrev_b32 v119, 1, v114
    v_xor_b32 v118, v118, v119
    v_lshl_add_u32 v5, v118, 4, v5
    s_lshl_b32 s51, s60, 7
    s_mul_i32 s52, s64, 1280
    s_add_u32 s63, s6, 2
    s_and_b32 s63, s63, 3
    s_mul_i32 s7, s63, 131072
    s_add_u32 s32, s7, s51
    s_add_u32 s33, s32, 15360
    s_add_u32 s34, s32, 63488
    s_add_u32 s35, s32, 78848
    s_mul_i32 s7, s63, 40960
    s_add_u32 s36, s7, s52
    s_add_u32 m0, s28, 0
    s_nop 0
    buffer_load_dwordx4 v5, s[12:15], s32 offen offset:0 lds
    buffer_load_dwordx4 v5, s[12:15], s33 offen offset:1024 lds
    buffer_load_dwordx4 v5, s[12:15], s34 offen offset:2048 lds
    buffer_load_dwordx4 v5, s[12:15], s35 offen offset:3072 lds
    s_add_u32 s32, s32, 524288
    s_add_u32 s33, s33, 524288
    s_add_u32 s34, s34, 524288
    s_add_u32 s35, s35, 524288
    s_add_u32 m0, s28, 4096
    s_nop 0
    buffer_load_dwordx4 v5, s[12:15], s32 offen offset:0 lds
    buffer_load_dwordx4 v5, s[12:15], s33 offen offset:1024 lds
    buffer_load_dwordx4 v5, s[12:15], s34 offen offset:2048 lds
    buffer_load_dwordx4 v5, s[12:15], s35 offen offset:3072 lds
    s_add_u32 s32, s32, 524288
    s_add_u32 s33, s33, 524288
    s_add_u32 s34, s34, 524288
    s_add_u32 s35, s35, 524288
    s_mul_i32 s3, s49, 57
    s_lshr_b32 s3, s3, 9
    s_lshl_b32 s7, s48, 2
    s_add_u32 s7, s7, s3
    s_lshl_b32 s7, s7, 7
    s_add_u32 s7, s7, 2822144
    v_mov_b32 v1, s7
    v_mov_b32 v2, 162816
    s_waitcnt vmcnt(8)
    s_mov_b64 exec, 1
    ds_add_rtn_u32 v2, v2, v7 offset:176
    s_waitcnt lgkmcnt(0)
    v_readfirstlane_b32 s3, v2
    s_nop 0
    s_cmp_lg_u32 s3, 3
    s_cbranch_scc1 parallel_sum__grouped_kv_mqa__mixer_token_mlp__prompt_kernel_nu
    global_atomic_add v1, v7, s[4:5] sc1
parallel_sum__grouped_kv_mqa__mixer_token_mlp__prompt_kernel_nu:
    s_mov_b64 exec, -1
    s_branch parallel_sum__grouped_kv_mqa__mixer_token_mlp__prompt_kernel_b2
parallel_sum__grouped_kv_mqa__mixer_token_mlp__prompt_kernel_wo:
    s_and_b32 s47, s47, 3
    s_lshl_b32 s47, s47, 3
    s_add_u32 s47, s47, s46
    s_lshl_b32 s47, s47, 2
    s_add_u32 s47, s47, s6
    s_cmp_ge_u32 s47, 80
    s_cbranch_scc1 parallel_sum__grouped_kv_mqa__mixer_token_mlp__prompt_kernel_nob1
    s_mul_i32 s51, s47, 10240
    s_add_u32 s53, s51, 10293248
    s_mov_b32 s12, s44
    s_and_b32 s13, s45, 0xffff
    s_mov_b32 s14, 819200
    s_mov_b32 s15, 0x20000
    v_mov_b32 v1, 162816
parallel_sum__grouped_kv_mqa__mixer_token_mlp__prompt_kernel_lw30:
    ds_read_b32 v2, v1 offset:24
    s_waitcnt lgkmcnt(0)
    v_cmp_gt_u32 s[84:85], 4, v2
    s_nop 1
    s_cmp_eq_u64 s[84:85], 0
    s_cbranch_scc0 parallel_sum__grouped_kv_mqa__mixer_token_mlp__prompt_kernel_lx30
parallel_sum__grouped_kv_mqa__mixer_token_mlp__prompt_kernel_lw31:
    ds_read_b32 v2, v1 offset:16
    s_waitcnt lgkmcnt(0)
    v_cmp_gt_u32 s[84:85], 1, v2
    s_nop 1
    s_cmp_eq_u64 s[84:85], 0
    s_cbranch_scc0 parallel_sum__grouped_kv_mqa__mixer_token_mlp__prompt_kernel_lx31
    v_mov_b32 v2, 1
    v_bfe_u32 v12, v0, 3, 3
    v_and_b32 v13, 7, v0
    v_mul_u32_u24 v14, 1280, v12
    v_lshl_add_u32 v14, v13, 4, v14
    buffer_load_dwordx4 v[20:23], v14, s[12:15], s51 offen offset:0
    buffer_load_dwordx4 v[24:27], v14, s[12:15], s51 offen offset:128
    buffer_load_dwordx4 v[28:31], v14, s[12:15], s51 offen offset:256
    buffer_load_dwordx4 v[32:35], v14, s[12:15], s51 offen offset:384
    buffer_load_dwordx4 v[36:39], v14, s[12:15], s51 offen offset:512
    buffer_load_dwordx4 v[40:43], v14, s[12:15], s51 offen offset:640
    buffer_load_dwordx4 v[44:47], v14, s[12:15], s51 offen offset:768
    buffer_load_dwordx4 v[48:51], v14, s[12:15], s51 offen offset:896
    buffer_load_dwordx4 v[52:55], v14, s[12:15], s51 offen offset:1024
    buffer_load_dwordx4 v[56:59], v14, s[12:15], s51 offen offset:1152
    v_mul_u32_u24 v14, 1344, v12
    v_lshl_add_u32 v14, v13, 4, v14
    v_add_u32 v14, s28, v14
    v_bfe_u32 v15, v0, 2, 2
    v_mul_u32_u24 v15, 1344, v15
    v_bfe_u32 v16, v0, 4, 2
    v_lshl_add_u32 v15, v16, 5, v15
    v_and_b32 v16, 3, v0
    v_lshl_add_u32 v15, v16, 3, v15
    v_add_u32 v15, s28, v15
    v_and_b32 v16, 63, v0
    v_lshlrev_b32 v16, 4, v16
    s_waitcnt vmcnt(0)
    ds_write_b128 v14, v[20:23] offset:0
    ds_write_b128 v14, v[24:27] offset:128
    ds_write_b128 v14, v[28:31] offset:256
    ds_write_b128 v14, v[32:35] offset:384
    ds_write_b128 v14, v[36:39] offset:512
    ds_write_b128 v14, v[40:43] offset:640
    ds_write_b128 v14, v[44:47] offset:768
    ds_write_b128 v14, v[48:51] offset:896
    ds_write_b128 v14, v[52:55] offset:1024
    ds_write_b128 v14, v[56:59] offset:1152
    s_waitcnt lgkmcnt(0)
    ds_read_b64_tr_b16 v[20:21], v15 offset:0
    ds_read_b64_tr_b16 v[22:23], v15 offset:5376
    ds_read_b64_tr_b16 v[24:25], v15 offset:128
    ds_read_b64_tr_b16 v[26:27], v15 offset:5504
    ds_read_b64_tr_b16 v[28:29], v15 offset:256
    ds_read_b64_tr_b16 v[30:31], v15 offset:5632
    ds_read_b64_tr_b16 v[32:33], v15 offset:384
    ds_read_b64_tr_b16 v[34:35], v15 offset:5760
    ds_read_b64_tr_b16 v[36:37], v15 offset:512
    ds_read_b64_tr_b16 v[38:39], v15 offset:5888
    ds_read_b64_tr_b16 v[40:41], v15 offset:640
    ds_read_b64_tr_b16 v[42:43], v15 offset:6016
    ds_read_b64_tr_b16 v[44:45], v15 offset:768
    ds_read_b64_tr_b16 v[46:47], v15 offset:6144
    ds_read_b64_tr_b16 v[48:49], v15 offset:896
    ds_read_b64_tr_b16 v[50:51], v15 offset:6272
    ds_read_b64_tr_b16 v[52:53], v15 offset:1024
    ds_read_b64_tr_b16 v[54:55], v15 offset:6400
    ds_read_b64_tr_b16 v[56:57], v15 offset:1152
    ds_read_b64_tr_b16 v[58:59], v15 offset:6528
    s_waitcnt lgkmcnt(12)
    buffer_store_dwordx4 v[20:23], v16, s[8:11], s53 offen offset:0 sc1
    buffer_store_dwordx4 v[24:27], v16, s[8:11], s53 offen offset:1024 sc1
    buffer_store_dwordx4 v[28:31], v16, s[8:11], s53 offen offset:2048 sc1
    buffer_store_dwordx4 v[32:35], v16, s[8:11], s53 offen offset:3072 sc1
    s_waitcnt lgkmcnt(4)
    s_add_u32 s53, s53, 4096
    buffer_store_dwordx4 v[36:39], v16, s[8:11], s53 offen offset:0 sc1
    buffer_store_dwordx4 v[40:43], v16, s[8:11], s53 offen offset:1024 sc1
    buffer_store_dwordx4 v[44:47], v16, s[8:11], s53 offen offset:2048 sc1
    buffer_store_dwordx4 v[48:51], v16, s[8:11], s53 offen offset:3072 sc1
    s_waitcnt lgkmcnt(0)
    s_add_u32 s53, s53, 4096
    buffer_store_dwordx4 v[52:55], v16, s[8:11], s53 offen offset:0 sc1
    buffer_store_dwordx4 v[56:59], v16, s[8:11], s53 offen offset:1024 sc1
    s_mov_b32 s7, 2822528
    s_mov_b64 exec, -1
    s_waitcnt vmcnt(0)
    v_readfirstlane_b32 s3, v2
    v_mov_b32 v2, 0
    s_cmp_lg_u32 s3, 0
    s_cbranch_scc1 parallel_sum__grouped_kv_mqa__mixer_token_mlp__prompt_kernel_zk32
    s_mov_b32 s71, 0
    s_mov_b32 s3, 1
    s_mov_b64 exec, 1
parallel_sum__grouped_kv_mqa__mixer_token_mlp__prompt_kernel_gw33:
    global_load_dword v1, v2, s[78:79] sc1
    s_add_u32 s71, s71, 1
    s_waitcnt vmcnt(0)
    v_cmp_gt_u32 s[84:85], s3, v1
    s_nop 1
    s_cmp_eq_u64 s[84:85], 0
    s_cbranch_scc0 parallel_sum__grouped_kv_mqa__mixer_token_mlp__prompt_kernel_gx33
parallel_sum__grouped_kv_mqa__mixer_token_mlp__prompt_kernel_gy33:
    s_mov_b64 exec, -1
parallel_sum__grouped_kv_mqa__mixer_token_mlp__prompt_kernel_zk32:
    v_and_b32 v1, 63, v0
    v_lshl_add_u32 v1, v1, 9, s7
    v_mov_b32 v2, 1
    s_mov_b64 exec, 255
    global_atomic_add v1, v2, s[4:5] sc1
    s_mov_b64 exec, -1
parallel_sum__grouped_kv_mqa__mixer_token_mlp__prompt_kernel_nob1:
    s_setprio 2
    v_mov_b32 v1, 162816
parallel_sum__grouped_kv_mqa__mixer_token_mlp__prompt_kernel_lw34:
    ds_read_b32 v2, v1 offset:24
    s_waitcnt lgkmcnt(0)
    v_cmp_gt_u32 s[84:85], 4, v2
    s_nop 1
    s_cmp_eq_u64 s[84:85], 0
    s_cbranch_scc0 parallel_sum__grouped_kv_mqa__mixer_token_mlp__prompt_kernel_lx34
    s_mov_b32 s20, s56
    s_and_b32 s21, s57, 0xffff
    s_mov_b32 s22, 2621440
    s_mov_b32 s23, 0x20000
    s_mov_b32 s24, s72
    s_and_b32 s25, s73, 0xffff
    s_mov_b32 s26, 4096
    s_mov_b32 s27, 0x20000
    s_lshl_b32 s53, s60, 2
    s_add_u32 s53, s53, s6
    s_lshl_b32 s7, s53, 5
    s_mul_i32 s53, s53, 20480
    s_mul_i32 s55, s64, 160
    s_add_u32 s53, s53, s55
    v_and_b32 v1, 15, v0
    v_lshlrev_b32 v4, 1, v1
    v_mul_u32_u24 v1, 1280, v1
    v_bfe_u32 v5, v0, 4, 2
    v_lshl_add_u32 v1, v5, 3, v1
    buffer_load_ushort v4, v4, s[24:27], s7 offen
    buffer_load_dwordx2 v[132:133], v1, s[20:23], s53 offen offset:0
    buffer_load_dwordx2 v[134:135], v1, s[20:23], s53 offen offset:32
    buffer_load_dwordx2 v[136:137], v1, s[20:23], s53 offen offset:64
    buffer_load_dwordx2 v[138:139], v1, s[20:23], s53 offen offset:96
    buffer_load_dwordx2 v[140:141], v1, s[20:23], s53 offen offset:128
    s_mov_b32 s12, s76
    s_and_b32 s13, s77, 0xffff
    s_mov_b32 s14, 7077888
    s_mov_b32 s15, 0x20000
    s_add_u32 s16, s4, 5459968
    s_addc_u32 s17, s5, 0
    s_and_b32 s17, s17, 0xffff
    s_mov_b32 s18, 2211840
    s_mov_b32 s19, 0x20000
    v_bfe_u32 v114, v0, 4, 2
    v_bfe_u32 v118, v0, 3, 2
    v_bfe_u32 v119, v0, 5, 1
    v_lshl_add_u32 v118, v119, 3, v118
    v_mul_u32_u24 v5, 4096, v118
    v_and_b32 v118, 7, v0
    v_lshlrev_b32 v119, 1, v114
    v_xor_b32 v118, v118, v119
    v_lshl_add_u32 v5, v118, 4, v5
    s_lshl_b32 s51, s60, 7
    s_mul_i32 s52, s64, 1280
    s_add_u32 s63, s6, 2
    s_and_b32 s63, s63, 3
    s_mul_i32 s7, s63, 131072
    s_add_u32 s32, s7, s51
    s_add_u32 s33, s32, 15360
    s_add_u32 s34, s32, 63488
    s_add_u32 s35, s32, 78848
    s_mul_i32 s7, s63, 40960
    s_add_u32 s36, s7, s52
    s_add_u32 m0, s28, 0
    s_nop 0
    buffer_load_dwordx4 v5, s[12:15], s32 offen offset:0 lds
    buffer_load_dwordx4 v5, s[12:15], s33 offen offset:1024 lds
    buffer_load_dwordx4 v5, s[12:15], s34 offen offset:2048 lds
    buffer_load_dwordx4 v5, s[12:15], s35 offen offset:3072 lds
    s_add_u32 s32, s32, 524288
    s_add_u32 s33, s33, 524288
    s_add_u32 s34, s34, 524288
    s_add_u32 s35, s35, 524288
    s_add_u32 m0, s28, 4096
    s_nop 0
    buffer_load_dwordx4 v5, s[12:15], s32 offen offset:0 lds
    buffer_load_dwordx4 v5, s[12:15], s33 offen offset:1024 lds
    buffer_load_dwordx4 v5, s[12:15], s34 offen offset:2048 lds
    buffer_load_dwordx4 v5, s[12:15], s35 offen offset:3072 lds
    s_add_u32 s32, s32, 524288
    s_add_u32 s33, s33, 524288
    s_add_u32 s34, s34, 524288
    s_add_u32 s35, s35, 524288
    v_mov_b32 v121, 162816
parallel_sum__grouped_kv_mqa__mixer_token_mlp__prompt_kernel_lw35:
    ds_read_b32 v122, v121 offset:128
    s_waitcnt lgkmcnt(0)
    v_cmp_ge_u32 s[84:85], 8, v122
    s_nop 1
    s_cmp_eq_u64 s[84:85], 0
    s_cbranch_scc0 parallel_sum__grouped_kv_mqa__mixer_token_mlp__prompt_kernel_lx35
    s_waitcnt vmcnt(8)
parallel_sum__grouped_kv_mqa__mixer_token_mlp__prompt_kernel_b2:
    v_mov_b32 v3, v4
    v_lshlrev_b32 v12, 16, v132
    v_and_b32 v13, 0xffff0000, v132
    v_lshlrev_b32 v14, 16, v133
    v_and_b32 v15, 0xffff0000, v133
    v_lshlrev_b32 v16, 16, v134
    v_and_b32 v17, 0xffff0000, v134
    v_lshlrev_b32 v18, 16, v135
    v_and_b32 v19, 0xffff0000, v135
    v_lshlrev_b32 v20, 16, v136
    v_and_b32 v21, 0xffff0000, v136
    v_lshlrev_b32 v22, 16, v137
    v_and_b32 v23, 0xffff0000, v137
    v_lshlrev_b32 v24, 16, v138
    v_and_b32 v25, 0xffff0000, v138
    v_lshlrev_b32 v26, 16, v139
    v_and_b32 v27, 0xffff0000, v139
    v_lshlrev_b32 v28, 16, v140
    v_and_b32 v29, 0xffff0000, v140
    v_lshlrev_b32 v30, 16, v141
    v_and_b32 v31, 0xffff0000, v141
    s_lshl_b32 s7, s64, 9
    s_add_u32 s7, s7, 2822144
    v_and_b32 v1, 3, v0
    v_lshl_add_u32 v1, v1, 7, s7
    s_add_u32 s82, s4, s7
    s_addc_u32 s83, s5, 0
    s_mov_b32 s62, 0
    s_add_u32 s68, s63, 4
    s_cmp_ge_u32 s63, 2
    s_cselect_b32 s65, 12, 13
    v_mov_b32 v123, 162984
    s_cmp_lg_u32 s6, 0
    s_cbranch_scc1 parallel_sum__grouped_kv_mqa__mixer_token_mlp__prompt_kernel_go2
parallel_sum__grouped_kv_mqa__mixer_token_mlp__prompt_kernel_poll:
    s_mov_b64 exec, 15
    global_load_dword v2, v1, s[4:5] sc1
    s_mov_b64 exec, -1
    s_waitcnt vmcnt(0)
    v_cmp_le_u32 vcc, 9, v2
    s_add_u32 s62, s62, 1
    s_cmp_ge_u32 s62, 1048576
    s_cbranch_scc1 parallel_sum__grouped_kv_mqa__mixer_token_mlp__prompt_kernel_go
    s_and_b32 s66, vcc_lo, 7
    s_xor_b32 s67, s66, 15
    s_ff1_i32_b32 s67, s67
    s_mul_i32 s66, s67, 18
    s_cmp_eq_u32 s67, 3
    s_cselect_b32 s66, 64, s66
    v_readlane_b32 s69, v2, 3
    s_nop 0
    s_cmp_lt_u32 s69, 80
    s_cselect_b32 s66, 0, s66
    s_cmp_lt_u32 s68, s66
    s_cbranch_scc1 parallel_sum__grouped_kv_mqa__mixer_token_mlp__prompt_kernel_go
    s_sleep 8
    s_branch parallel_sum__grouped_kv_mqa__mixer_token_mlp__prompt_kernel_poll
parallel_sum__grouped_kv_mqa__mixer_token_mlp__prompt_kernel_go:
    v_mov_b32 v120, s66
    ds_write_b32 v123, v120
    s_waitcnt lgkmcnt(0)
parallel_sum__grouped_kv_mqa__mixer_token_mlp__prompt_kernel_go2:
    v_mov_b32 v120, 162816
    s_mov_b64 exec, 1
    ds_add_u32 v120, v7 offset:140
    s_mov_b64 exec, -1
parallel_sum__grouped_kv_mqa__mixer_token_mlp__prompt_kernel_lw36:
    ds_read_b32 v122, v120 offset:140
    s_waitcnt lgkmcnt(0)
    v_cmp_gt_u32 s[84:85], 4, v122
    s_nop 1
    s_cmp_eq_u64 s[84:85], 0
    s_cbranch_scc0 parallel_sum__grouped_kv_mqa__mixer_token_mlp__prompt_kernel_lx36
    ds_read_b32 v120, v123
    s_waitcnt lgkmcnt(0)
    v_readfirstlane_b32 s66, v120
    buffer_load_dwordx4 v[92:95], v6, s[16:19], s36 offen offset:0 sc1
    buffer_load_dwordx4 v[96:99], v6, s[16:19], s36 offen offset:256 sc1
    buffer_load_dwordx4 v[100:103], v6, s[16:19], s36 offen offset:512 sc1
    buffer_load_dwordx4 v[104:107], v6, s[16:19], s36 offen offset:768 sc1
    buffer_load_dwordx4 v[108:111], v6, s[16:19], s36 offen offset:1024 sc1
    s_add_u32 s36, s36, 163840
    buffer_load_dwordx4 v[112:115], v6, s[16:19], s36 offen offset:0 sc1
    buffer_load_dwordx4 v[116:119], v6, s[16:19], s36 offen offset:256 sc1
    buffer_load_dwordx4 v[120:123], v6, s[16:19], s36 offen offset:512 sc1
    buffer_load_dwordx4 v[124:127], v6, s[16:19], s36 offen offset:768 sc1
    buffer_load_dwordx4 v[128:131], v6, s[16:19], s36 offen offset:1024 sc1
    s_add_u32 s36, s36, 163840
    s_add_u32 m0, s28, 8192
    s_nop 0
    buffer_load_dwordx4 v5, s[12:15], s32 offen offset:0 lds
    buffer_load_dwordx4 v5, s[12:15], s33 offen offset:1024 lds
    buffer_load_dwordx4 v5, s[12:15], s34 offen offset:2048 lds
    buffer_load_dwordx4 v5, s[12:15], s35 offen offset:3072 lds
    s_add_u32 s32, s32, 524288
    s_add_u32 s33, s33, 524288
    s_add_u32 s34, s34, 524288
    s_add_u32 s35, s35, 524288
    s_setprio 0
    s_mov_b32 s37, s65
    s_waitcnt vmcnt(14)
    ds_read_b64_tr_b16 v[152:153], v8 offset:0
    ds_read_b64_tr_b16 v[154:155], v8 offset:1024
    ds_read_b64_tr_b16 v[156:157], v9 offset:0
    ds_read_b64_tr_b16 v[158:159], v9 offset:1024
    ds_read_b64_tr_b16 v[160:161], v10 offset:0
    ds_read_b64_tr_b16 v[162:163], v10 offset:1024
    ds_read_b64_tr_b16 v[164:165], v11 offset:0
    ds_read_b64_tr_b16 v[166:167], v11 offset:1024
    s_waitcnt vmcnt(9)
    s_waitcnt lgkmcnt(6)
    v_mfma_f32_16x16x32_bf16 v[12:15], v[92:95], v[152:155], v[12:15]
    s_add_u32 m0, s28, 0
    s_add_u32 s68, s68, 4
    s_cmp_ge_u32 s68, s66
    s_cbranch_scc1 parallel_sum__grouped_kv_mqa__mixer_token_mlp__prompt_kernel_ck0
parallel_sum__grouped_kv_mqa__mixer_token_mlp__prompt_kernel_ckb0:
    v_mfma_f32_16x16x32_bf16 v[16:19], v[96:99], v[152:155], v[16:19]
    buffer_load_dwordx4 v[132:135], v6, s[16:19], s36 offen offset:0 sc1
    v_mfma_f32_16x16x32_bf16 v[20:23], v[100:103], v[152:155], v[20:23]
    v_mfma_f32_16x16x32_bf16 v[24:27], v[104:107], v[152:155], v[24:27]
    buffer_load_dwordx4 v[136:139], v6, s[16:19], s36 offen offset:256 sc1
    v_mfma_f32_16x16x32_bf16 v[28:31], v[108:111], v[152:155], v[28:31]
    s_waitcnt vmcnt(11)
    ds_read_b64_tr_b16 v[152:153], v8 offset:4096
    ds_read_b64_tr_b16 v[154:155], v8 offset:5120
    s_waitcnt lgkmcnt(6)
    v_mfma_f32_16x16x32_bf16 v[32:35], v[92:95], v[156:159], 0
    v_mfma_f32_16x16x32_bf16 v[36:39], v[96:99], v[156:159], 0
    buffer_load_dwordx4 v[140:143], v6, s[16:19], s36 offen offset:512 sc1
    v_mfma_f32_16x16x32_bf16 v[40:43], v[100:103], v[156:159], 0
    v_mfma_f32_16x16x32_bf16 v[44:47], v[104:107], v[156:159], 0
    buffer_load_dwordx4 v[144:147], v6, s[16:19], s36 offen offset:768 sc1
    v_mfma_f32_16x16x32_bf16 v[48:51], v[108:111], v[156:159], 0
    ds_read_b64_tr_b16 v[156:157], v9 offset:4096
    ds_read_b64_tr_b16 v[158:159], v9 offset:5120
    s_waitcnt lgkmcnt(6)
    v_mfma_f32_16x16x32_bf16 v[52:55], v[92:95], v[160:163], 0
    v_mfma_f32_16x16x32_bf16 v[56:59], v[96:99], v[160:163], 0
    buffer_load_dwordx4 v[148:151], v6, s[16:19], s36 offen offset:1024 sc1
    s_add_u32 s36, s36, 163840
    v_mfma_f32_16x16x32_bf16 v[60:63], v[100:103], v[160:163], 0
    v_mfma_f32_16x16x32_bf16 v[64:67], v[104:107], v[160:163], 0
    v_mfma_f32_16x16x32_bf16 v[68:71], v[108:111], v[160:163], 0
    ds_read_b64_tr_b16 v[160:161], v10 offset:4096
    ds_read_b64_tr_b16 v[162:163], v10 offset:5120
    s_waitcnt lgkmcnt(6)
    v_mfma_f32_16x16x32_bf16 v[72:75], v[92:95], v[164:167], 0
    buffer_load_dwordx4 v5, s[12:15], s32 offen offset:0 lds
    v_mfma_f32_16x16x32_bf16 v[76:79], v[96:99], v[164:167], 0
    buffer_load_dwordx4 v5, s[12:15], s33 offen offset:1024 lds
    v_mfma_f32_16x16x32_bf16 v[80:83], v[100:103], v[164:167], 0
    buffer_load_dwordx4 v5, s[12:15], s34 offen offset:2048 lds
    v_mfma_f32_16x16x32_bf16 v[84:87], v[104:107], v[164:167], 0
    buffer_load_dwordx4 v5, s[12:15], s35 offen offset:3072 lds
    s_add_u32 s32, s32, 524288
    s_add_u32 s33, s33, 524288
    s_add_u32 s34, s34, 524288
    s_add_u32 s35, s35, 524288
    v_mfma_f32_16x16x32_bf16 v[88:91], v[108:111], v[164:167], 0
    ds_read_b64_tr_b16 v[164:165], v11 offset:4096
    ds_read_b64_tr_b16 v[166:167], v11 offset:5120
parallel_sum__grouped_kv_mqa__mixer_token_mlp__prompt_kernel_b2l_loop:
    s_waitcnt vmcnt(13)
    s_waitcnt lgkmcnt(6)
    v_mfma_f32_16x16x32_bf16 v[12:15], v[112:115], v[152:155], v[12:15]
    s_add_u32 m0, s28, 4096
    s_add_u32 s68, s68, 4
    s_cmp_ge_u32 s68, s66
    s_cbranch_scc1 parallel_sum__grouped_kv_mqa__mixer_token_mlp__prompt_kernel_ck1
parallel_sum__grouped_kv_mqa__mixer_token_mlp__prompt_kernel_ckb1:
    v_mfma_f32_16x16x32_bf16 v[16:19], v[116:119], v[152:155], v[16:19]
    buffer_load_dwordx4 v[92:95], v6, s[16:19], s36 offen offset:0 sc1
    v_mfma_f32_16x16x32_bf16 v[20:23], v[120:123], v[152:155], v[20:23]
    v_mfma_f32_16x16x32_bf16 v[24:27], v[124:127], v[152:155], v[24:27]
    buffer_load_dwordx4 v[96:99], v6, s[16:19], s36 offen offset:256 sc1
    v_mfma_f32_16x16x32_bf16 v[28:31], v[128:131], v[152:155], v[28:31]
    s_waitcnt vmcnt(11)
    ds_read_b64_tr_b16 v[152:153], v8 offset:8192
    ds_read_b64_tr_b16 v[154:155], v8 offset:9216
    s_waitcnt lgkmcnt(6)
    v_mfma_f32_16x16x32_bf16 v[32:35], v[112:115], v[156:159], v[32:35]
    v_mfma_f32_16x16x32_bf16 v[36:39], v[116:119], v[156:159], v[36:39]
    buffer_load_dwordx4 v[100:103], v6, s[16:19], s36 offen offset:512 sc1
    v_mfma_f32_16x16x32_bf16 v[40:43], v[120:123], v[156:159], v[40:43]
    v_mfma_f32_16x16x32_bf16 v[44:47], v[124:127], v[156:159], v[44:47]
    buffer_load_dwordx4 v[104:107], v6, s[16:19], s36 offen offset:768 sc1
    v_mfma_f32_16x16x32_bf16 v[48:51], v[128:131], v[156:159], v[48:51]
    ds_read_b64_tr_b16 v[156:157], v9 offset:8192
    ds_read_b64_tr_b16 v[158:159], v9 offset:9216
    s_waitcnt lgkmcnt(6)
    v_mfma_f32_16x16x32_bf16 v[52:55], v[112:115], v[160:163], v[52:55]
    v_mfma_f32_16x16x32_bf16 v[56:59], v[116:119], v[160:163], v[56:59]
    buffer_load_dwordx4 v[108:111], v6, s[16:19], s36 offen offset:1024 sc1
    s_add_u32 s36, s36, 163840
    v_mfma_f32_16x16x32_bf16 v[60:63], v[120:123], v[160:163], v[60:63]
    v_mfma_f32_16x16x32_bf16 v[64:67], v[124:127], v[160:163], v[64:67]
    v_mfma_f32_16x16x32_bf16 v[68:71], v[128:131], v[160:163], v[68:71]
    ds_read_b64_tr_b16 v[160:161], v10 offset:8192
    ds_read_b64_tr_b16 v[162:163], v10 offset:9216
    s_waitcnt lgkmcnt(6)
    v_mfma_f32_16x16x32_bf16 v[72:75], v[112:115], v[164:167], v[72:75]
    buffer_load_dwordx4 v5, s[12:15], s32 offen offset:0 lds
    v_mfma_f32_16x16x32_bf16 v[76:79], v[116:119], v[164:167], v[76:79]
    buffer_load_dwordx4 v5, s[12:15], s33 offen offset:1024 lds
    v_mfma_f32_16x16x32_bf16 v[80:83], v[120:123], v[164:167], v[80:83]
    buffer_load_dwordx4 v5, s[12:15], s34 offen offset:2048 lds
    v_mfma_f32_16x16x32_bf16 v[84:87], v[124:127], v[164:167], v[84:87]
    buffer_load_dwordx4 v5, s[12:15], s35 offen offset:3072 lds
    s_add_u32 s32, s32, 524288
    s_add_u32 s33, s33, 524288
    s_add_u32 s34, s34, 524288
    s_add_u32 s35, s35, 524288
    v_mfma_f32_16x16x32_bf16 v[88:91], v[128:131], v[164:167], v[88:91]
    ds_read_b64_tr_b16 v[164:165], v11 offset:8192
    ds_read_b64_tr_b16 v[166:167], v11 offset:9216
    s_sub_u32 s37, s37, 1
    s_cmp_eq_u32 s37, 0
    s_cbranch_scc1 parallel_sum__grouped_kv_mqa__mixer_token_mlp__prompt_kernel_b2l_done
    s_waitcnt vmcnt(13)
    s_waitcnt lgkmcnt(6)
    v_mfma_f32_16x16x32_bf16 v[12:15], v[132:135], v[152:155], v[12:15]
    s_add_u32 m0, s28, 8192
    s_add_u32 s68, s68, 4
    s_cmp_ge_u32 s68, s66
    s_cbranch_scc1 parallel_sum__grouped_kv_mqa__mixer_token_mlp__prompt_kernel_ck2
parallel_sum__grouped_kv_mqa__mixer_token_mlp__prompt_kernel_ckb2:
    v_mfma_f32_16x16x32_bf16 v[16:19], v[136:139], v[152:155], v[16:19]
    buffer_load_dwordx4 v[112:115], v6, s[16:19], s36 offen offset:0 sc1
    v_mfma_f32_16x16x32_bf16 v[20:23], v[140:143], v[152:155], v[20:23]
    v_mfma_f32_16x16x32_bf16 v[24:27], v[144:147], v[152:155], v[24:27]
    buffer_load_dwordx4 v[116:119], v6, s[16:19], s36 offen offset:256 sc1
    v_mfma_f32_16x16x32_bf16 v[28:31], v[148:151], v[152:155], v[28:31]
    s_waitcnt vmcnt(11)
    ds_read_b64_tr_b16 v[152:153], v8 offset:0
    ds_read_b64_tr_b16 v[154:155], v8 offset:1024
    s_waitcnt lgkmcnt(6)
    v_mfma_f32_16x16x32_bf16 v[32:35], v[132:135], v[156:159], v[32:35]
    v_mfma_f32_16x16x32_bf16 v[36:39], v[136:139], v[156:159], v[36:39]
    buffer_load_dwordx4 v[120:123], v6, s[16:19], s36 offen offset:512 sc1
    v_mfma_f32_16x16x32_bf16 v[40:43], v[140:143], v[156:159], v[40:43]
    v_mfma_f32_16x16x32_bf16 v[44:47], v[144:147], v[156:159], v[44:47]
    buffer_load_dwordx4 v[124:127], v6, s[16:19], s36 offen offset:768 sc1
    v_mfma_f32_16x16x32_bf16 v[48:51], v[148:151], v[156:159], v[48:51]
    ds_read_b64_tr_b16 v[156:157], v9 offset:0
    ds_read_b64_tr_b16 v[158:159], v9 offset:1024
    s_waitcnt lgkmcnt(6)
    v_mfma_f32_16x16x32_bf16 v[52:55], v[132:135], v[160:163], v[52:55]
    v_mfma_f32_16x16x32_bf16 v[56:59], v[136:139], v[160:163], v[56:59]
    buffer_load_dwordx4 v[128:131], v6, s[16:19], s36 offen offset:1024 sc1
    s_add_u32 s36, s36, 163840
    v_mfma_f32_16x16x32_bf16 v[60:63], v[140:143], v[160:163], v[60:63]
    v_mfma_f32_16x16x32_bf16 v[64:67], v[144:147], v[160:163], v[64:67]
    v_mfma_f32_16x16x32_bf16 v[68:71], v[148:151], v[160:163], v[68:71]
    ds_read_b64_tr_b16 v[160:161], v10 offset:0
    ds_read_b64_tr_b16 v[162:163], v10 offset:1024
    s_waitcnt lgkmcnt(6)
    v_mfma_f32_16x16x32_bf16 v[72:75], v[132:135], v[164:167], v[72:75]
    buffer_load_dwordx4 v5, s[12:15], s32 offen offset:0 lds
    v_mfma_f32_16x16x32_bf16 v[76:79], v[136:139], v[164:167], v[76:79]
    buffer_load_dwordx4 v5, s[12:15], s33 offen offset:1024 lds
    v_mfma_f32_16x16x32_bf16 v[80:83], v[140:143], v[164:167], v[80:83]
    buffer_load_dwordx4 v5, s[12:15], s34 offen offset:2048 lds
    v_mfma_f32_16x16x32_bf16 v[84:87], v[144:147], v[164:167], v[84:87]
    buffer_load_dwordx4 v5, s[12:15], s35 offen offset:3072 lds
    s_add_u32 s32, s32, 524288
    s_add_u32 s33, s33, 524288
    s_add_u32 s34, s34, 524288
    s_add_u32 s35, s35, 524288
    v_mfma_f32_16x16x32_bf16 v[88:91], v[148:151], v[164:167], v[88:91]
    ds_read_b64_tr_b16 v[164:165], v11 offset:0
    ds_read_b64_tr_b16 v[166:167], v11 offset:1024
    s_sub_u32 s37, s37, 1
    s_cmp_eq_u32 s37, 0
    s_cbranch_scc1 parallel_sum__grouped_kv_mqa__mixer_token_mlp__prompt_kernel_b2l_done
    s_waitcnt vmcnt(13)
    s_waitcnt lgkmcnt(6)
    v_mfma_f32_16x16x32_bf16 v[12:15], v[92:95], v[152:155], v[12:15]
    s_add_u32 m0, s28, 0
    s_add_u32 s68, s68, 4
    s_cmp_ge_u32 s68, s66
    s_cbranch_scc1 parallel_sum__grouped_kv_mqa__mixer_token_mlp__prompt_kernel_ck3
parallel_sum__grouped_kv_mqa__mixer_token_mlp__prompt_kernel_ckb3:
    v_mfma_f32_16x16x32_bf16 v[16:19], v[96:99], v[152:155], v[16:19]
    buffer_load_dwordx4 v[132:135], v6, s[16:19], s36 offen offset:0 sc1
    v_mfma_f32_16x16x32_bf16 v[20:23], v[100:103], v[152:155], v[20:23]
    v_mfma_f32_16x16x32_bf16 v[24:27], v[104:107], v[152:155], v[24:27]
    buffer_load_dwordx4 v[136:139], v6, s[16:19], s36 offen offset:256 sc1
    v_mfma_f32_16x16x32_bf16 v[28:31], v[108:111], v[152:155], v[28:31]
    s_waitcnt vmcnt(11)
    ds_read_b64_tr_b16 v[152:153], v8 offset:4096
    ds_read_b64_tr_b16 v[154:155], v8 offset:5120
    s_waitcnt lgkmcnt(6)
    v_mfma_f32_16x16x32_bf16 v[32:35], v[92:95], v[156:159], v[32:35]
    v_mfma_f32_16x16x32_bf16 v[36:39], v[96:99], v[156:159], v[36:39]
    buffer_load_dwordx4 v[140:143], v6, s[16:19], s36 offen offset:512 sc1
    v_mfma_f32_16x16x32_bf16 v[40:43], v[100:103], v[156:159], v[40:43]
    v_mfma_f32_16x16x32_bf16 v[44:47], v[104:107], v[156:159], v[44:47]
    buffer_load_dwordx4 v[144:147], v6, s[16:19], s36 offen offset:768 sc1
    v_mfma_f32_16x16x32_bf16 v[48:51], v[108:111], v[156:159], v[48:51]
    ds_read_b64_tr_b16 v[156:157], v9 offset:4096
    ds_read_b64_tr_b16 v[158:159], v9 offset:5120
    s_waitcnt lgkmcnt(6)
    v_mfma_f32_16x16x32_bf16 v[52:55], v[92:95], v[160:163], v[52:55]
    v_mfma_f32_16x16x32_bf16 v[56:59], v[96:99], v[160:163], v[56:59]
    buffer_load_dwordx4 v[148:151], v6, s[16:19], s36 offen offset:1024 sc1
    s_add_u32 s36, s36, 163840
    v_mfma_f32_16x16x32_bf16 v[60:63], v[100:103], v[160:163], v[60:63]
    v_mfma_f32_16x16x32_bf16 v[64:67], v[104:107], v[160:163], v[64:67]
    v_mfma_f32_16x16x32_bf16 v[68:71], v[108:111], v[160:163], v[68:71]
    ds_read_b64_tr_b16 v[160:161], v10 offset:4096
    ds_read_b64_tr_b16 v[162:163], v10 offset:5120
    s_waitcnt lgkmcnt(6)
    v_mfma_f32_16x16x32_bf16 v[72:75], v[92:95], v[164:167], v[72:75]
    buffer_load_dwordx4 v5, s[12:15], s32 offen offset:0 lds
    v_mfma_f32_16x16x32_bf16 v[76:79], v[96:99], v[164:167], v[76:79]
    buffer_load_dwordx4 v5, s[12:15], s33 offen offset:1024 lds
    v_mfma_f32_16x16x32_bf16 v[80:83], v[100:103], v[164:167], v[80:83]
    buffer_load_dwordx4 v5, s[12:15], s34 offen offset:2048 lds
    v_mfma_f32_16x16x32_bf16 v[84:87], v[104:107], v[164:167], v[84:87]
    buffer_load_dwordx4 v5, s[12:15], s35 offen offset:3072 lds
    s_add_u32 s32, s32, 524288
    s_add_u32 s33, s33, 524288
    s_add_u32 s34, s34, 524288
    s_add_u32 s35, s35, 524288
    v_mfma_f32_16x16x32_bf16 v[88:91], v[108:111], v[164:167], v[88:91]
    ds_read_b64_tr_b16 v[164:165], v11 offset:4096
    ds_read_b64_tr_b16 v[166:167], v11 offset:5120
    s_sub_u32 s37, s37, 1
    s_cmp_eq_u32 s37, 0
    s_cbranch_scc0 parallel_sum__grouped_kv_mqa__mixer_token_mlp__prompt_kernel_b2l_loop
parallel_sum__grouped_kv_mqa__mixer_token_mlp__prompt_kernel_b2l_done:
    s_setprio 2
    v_and_b32 v4, 63, v0
    v_lshlrev_b32 v4, 4, v4
    v_add_u32 v4, s28, v4
    ds_write_b128 v4, v[48:51] offset:12288
    ds_write_b128 v4, v[52:55] offset:13312
    ds_write_b128 v4, v[56:59] offset:14336
    ds_write_b128 v4, v[60:63] offset:15360
    ds_write_b128 v4, v[64:67] offset:16384
    ds_write_b128 v4, v[68:71] offset:17408
    ds_write_b128 v4, v[72:75] offset:18432
    ds_write_b128 v4, v[76:79] offset:19456
    ds_write_b128 v4, v[80:83] offset:20480
    ds_write_b128 v4, v[84:87] offset:21504
    ds_write_b128 v4, v[88:91] offset:22528
    s_waitcnt vmcnt(0)
    ds_write_b128 v4, v[32:35] offset:8192
    ds_write_b128 v4, v[36:39] offset:9216
    ds_write_b128 v4, v[40:43] offset:10240
    ds_write_b128 v4, v[44:47] offset:11264
    v_and_b32 v112, 63, v0
    v_lshlrev_b32 v112, 4, v112
    v_and_b32 v5, 15, v0
    v_bfe_u32 v6, v0, 4, 2
    v_lshlrev_b32 v5, 4, v5
    v_lshl_add_u32 v1, v6, 15, v5
    v_mul_u32_u24 v2, 10240, v6
    v_add_u32 v2, v2, v5
    s_mul_i32 s21, s64, 1280
    s_mul_i32 s7, s6, 40960
    s_add_u32 s21, s21, s7
    s_add_u32 s21, s21, 10293248
    s_lshl_b32 s20, s60, 2
    s_add_u32 s20, s20, s6
    s_lshl_b32 s20, s20, 8
    s_add_u32 s20, s20, 7671808
    s_add_u32 s7, s21, 327680
    s_add_u32 m0, s28, 0
    s_nop 0
    buffer_load_dwordx4 v2, s[8:11], s7 offen offset:0 sc1 lds
    s_add_u32 m0, s28, 768
    s_nop 0
    buffer_load_dwordx4 v2, s[8:11], s7 offen offset:256 sc1 lds
    s_add_u32 m0, s28, 1536
    s_nop 0
    buffer_load_dwordx4 v2, s[8:11], s7 offen offset:512 sc1 lds
    s_add_u32 m0, s28, 2304
    s_nop 0
    buffer_load_dwordx4 v2, s[8:11], s7 offen offset:768 sc1 lds
    s_add_u32 m0, s28, 3072
    s_nop 0
    buffer_load_dwordx4 v2, s[8:11], s7 offen offset:1024 sc1 lds
    s_mul_i32 s7, s6, 40960
    s_add_u32 s21, s21, s7
    s_mov_b32 s22, s20
    s_sub_u32 s7, s6, 1
    s_and_b32 s7, s7, 3
    s_mul_i32 s7, s7, 23552
    s_add_u32 s7, s7, 57344
    v_add_u32 v114, s7, v112
    s_sub_u32 s7, s6, 2
    s_and_b32 s7, s7, 3
    s_mul_i32 s7, s7, 23552
    s_add_u32 s7, s7, 62464
    v_add_u32 v115, s7, v112
    s_sub_u32 s7, s6, 3
    s_and_b32 s7, s7, 3
    s_mul_i32 s7, s7, 23552
    s_add_u32 s7, s7, 67584
    v_add_u32 v116, s7, v112
    s_waitcnt lgkmcnt(0)
    v_mov_b32 v120, 162816
    s_mov_b64 exec, 1
    ds_add_u32 v120, v7 offset:144
    s_mov_b64 exec, -1
parallel_sum__grouped_kv_mqa__mixer_token_mlp__prompt_kernel_lw37:
    ds_read_b32 v122, v120 offset:144
    s_waitcnt lgkmcnt(0)
    v_cmp_gt_u32 s[84:85], 4, v122
    s_nop 1
    s_cmp_eq_u64 s[84:85], 0
    s_cbranch_scc0 parallel_sum__grouped_kv_mqa__mixer_token_mlp__prompt_kernel_lx37
    ds_read_b128 v[32:35], v114 offset:0
    ds_read_b128 v[36:39], v114 offset:1024
    ds_read_b128 v[40:43], v114 offset:2048
    ds_read_b128 v[44:47], v114 offset:3072
    ds_read_b128 v[48:51], v114 offset:4096
    ds_read_b128 v[52:55], v115 offset:0
    ds_read_b128 v[56:59], v115 offset:1024
    ds_read_b128 v[60:63], v115 offset:2048
    ds_read_b128 v[64:67], v115 offset:3072
    ds_read_b128 v[68:71], v115 offset:4096
    ds_read_b128 v[72:75], v116 offset:0
    ds_read_b128 v[76:79], v116 offset:1024
    ds_read_b128 v[80:83], v116 offset:2048
    ds_read_b128 v[84:87], v116 offset:3072
    ds_read_b128 v[88:91], v116 offset:4096
    s_waitcnt lgkmcnt(10)
    v_pk_add_f32 v[12:13], v[12:13], v[32:33]
    v_pk_add_f32 v[14:15], v[14:15], v[34:35]
    v_pk_add_f32 v[16:17], v[16:17], v[36:37]
    v_pk_add_f32 v[18:19], v[18:19], v[38:39]
    v_pk_add_f32 v[20:21], v[20:21], v[40:41]
    v_pk_add_f32 v[22:23], v[22:23], v[42:43]
    v_pk_add_f32 v[24:25], v[24:25], v[44:45]
    v_pk_add_f32 v[26:27], v[26:27], v[46:47]
    v_pk_add_f32 v[28:29], v[28:29], v[48:49]
    v_pk_add_f32 v[30:31], v[30:31], v[50:51]
    s_waitcnt lgkmcnt(5)
    v_pk_add_f32 v[12:13], v[12:13], v[52:53]
    v_pk_add_f32 v[14:15], v[14:15], v[54:55]
    v_pk_add_f32 v[16:17], v[16:17], v[56:57]
    v_pk_add_f32 v[18:19], v[18:19], v[58:59]
    v_pk_add_f32 v[20:21], v[20:21], v[60:61]
    v_pk_add_f32 v[22:23], v[22:23], v[62:63]
    v_pk_add_f32 v[24:25], v[24:25], v[64:65]
    v_pk_add_f32 v[26:27], v[26:27], v[66:67]
    v_pk_add_f32 v[28:29], v[28:29], v[68:69]
    v_pk_add_f32 v[30:31], v[30:31], v[70:71]
    s_waitcnt lgkmcnt(0)
    v_pk_add_f32 v[12:13], v[12:13], v[72:73]
    v_pk_add_f32 v[14:15], v[14:15], v[74:75]
    v_pk_add_f32 v[16:17], v[16:17], v[76:77]
    v_pk_add_f32 v[18:19], v[18:19], v[78:79]
    v_pk_add_f32 v[20:21], v[20:21], v[80:81]
    v_pk_add_f32 v[22:23], v[22:23], v[82:83]
    v_pk_add_f32 v[24:25], v[24:25], v[84:85]
    v_pk_add_f32 v[26:27], v[26:27], v[86:87]
    v_pk_add_f32 v[28:29], v[28:29], v[88:89]
    v_pk_add_f32 v[30:31], v[30:31], v[90:91]
    v_mov_b32 v120, 162816
    s_mov_b64 exec, 1
    ds_add_u32 v120, v7 offset:148
    s_mov_b64 exec, -1
    v_lshlrev_b32 v3, 16, v3
    v_add_f32 v12, v12, v3
    v_add_f32 v13, v13, v3
    v_add_f32 v14, v14, v3
    v_add_f32 v15, v15, v3
    v_add_f32 v16, v16, v3
    v_add_f32 v17, v17, v3
    v_add_f32 v18, v18, v3
    v_add_f32 v19, v19, v3
    v_add_f32 v20, v20, v3
    v_add_f32 v21, v21, v3
    v_add_f32 v22, v22, v3
    v_add_f32 v23, v23, v3
    v_add_f32 v24, v24, v3
    v_add_f32 v25, v25, v3
    v_add_f32 v26, v26, v3
    v_add_f32 v27, v27, v3
    v_add_f32 v28, v28, v3
    v_add_f32 v29, v29, v3
    v_add_f32 v30, v30, v3
    v_add_f32 v31, v31, v3
parallel_sum__grouped_kv_mqa__mixer_token_mlp__prompt_kernel_lw38:
    ds_read_b32 v122, v120 offset:148
    s_waitcnt lgkmcnt(0)
    v_cmp_gt_u32 s[84:85], 4, v122
    s_nop 1
    s_cmp_eq_u64 s[84:85], 0
    s_cbranch_scc0 parallel_sum__grouped_kv_mqa__mixer_token_mlp__prompt_kernel_lx38
    s_add_u32 s7, s21, 491520
    s_add_u32 m0, s28, 8192
    s_nop 0
    buffer_load_dwordx4 v2, s[8:11], s7 offen offset:0 sc1 lds
    s_add_u32 m0, s28, 8960
    s_nop 0
    buffer_load_dwordx4 v2, s[8:11], s7 offen offset:256 sc1 lds
    s_add_u32 m0, s28, 9728
    s_nop 0
    buffer_load_dwordx4 v2, s[8:11], s7 offen offset:512 sc1 lds
    s_add_u32 m0, s28, 10496
    s_nop 0
    buffer_load_dwordx4 v2, s[8:11], s7 offen offset:768 sc1 lds
    s_add_u32 m0, s28, 11264
    s_nop 0
    buffer_load_dwordx4 v2, s[8:11], s7 offen offset:1024 sc1 lds
    s_add_u32 s7, s21, 532480
    s_add_u32 m0, s28, 13312
    s_nop 0
    buffer_load_dwordx4 v2, s[8:11], s7 offen offset:0 sc1 lds
    s_add_u32 m0, s28, 14080
    s_nop 0
    buffer_load_dwordx4 v2, s[8:11], s7 offen offset:256 sc1 lds
    s_add_u32 m0, s28, 14848
    s_nop 0
    buffer_load_dwordx4 v2, s[8:11], s7 offen offset:512 sc1 lds
    s_add_u32 m0, s28, 15616
    s_nop 0
    buffer_load_dwordx4 v2, s[8:11], s7 offen offset:768 sc1 lds
    s_add_u32 m0, s28, 16384
    s_nop 0
    buffer_load_dwordx4 v2, s[8:11], s7 offen offset:1024 sc1 lds
    s_mov_b32 s24, s74
    s_and_b32 s25, s75, 0xffff
    s_mov_b32 s26, 2621440
    s_mov_b32 s27, 0x20000
    v_and_b32 v5, 63, v0
    v_lshlrev_b32 v5, 4, v5
    v_add_u32 v6, 0x10000, v5
    v_add_u32 v7, 0x20000, v5
    s_waitcnt vmcnt(0)
    s_barrier
    ds_read_b128 v[32:35], v7 offset:12288
    ds_read_b128 v[36:39], v7 offset:13312
    ds_read_b128 v[40:43], v7 offset:14336
    ds_read_b128 v[44:47], v7 offset:15360
    ds_read_b128 v[48:51], v7 offset:16384
    ds_read_b128 v[52:55], v7 offset:17408
    ds_read_b128 v[56:59], v7 offset:18432
    ds_read_b128 v[60:63], v7 offset:19456
    ds_read_b128 v[64:67], v7 offset:20480
    ds_read_b128 v[68:71], v7 offset:21504
    s_mov_b32 s62, 0
    buffer_load_dwordx4 v[92:95], v1, s[8:11], s20 offen sc1
    s_add_u32 s20, s20, 131072
    buffer_load_dwordx4 v[96:99], v1, s[8:11], s20 offen sc1
    s_add_u32 s20, s20, 131072
    buffer_load_dwordx4 v[100:103], v1, s[8:11], s20 offen sc1
    s_add_u32 s20, s20, 131072
    buffer_load_dwordx4 v[104:107], v1, s[8:11], s20 offen sc1
    s_add_u32 s20, s20, 131072
    buffer_load_dwordx4 v[108:111], v1, s[8:11], s20 offen sc1
    s_add_u32 s20, s20, 131072
    buffer_load_dwordx4 v[124:127], v1, s[8:11], s20 offen sc1
    s_add_u32 s20, s20, 131072
    buffer_load_dwordx4 v[128:131], v1, s[8:11], s20 offen sc1
    s_add_u32 s20, s20, 131072
    buffer_load_dwordx4 v[132:135], v1, s[8:11], s20 offen sc1
    s_add_u32 s20, s20, 131072
    buffer_load_dwordx4 v[136:139], v1, s[8:11], s20 offen sc1
    s_add_u32 s20, s20, 131072
    buffer_load_dwordx4 v[140:143], v1, s[8:11], s20 offen sc1
    s_add_u32 s20, s20, 131072
    buffer_load_dwordx4 v[144:147], v1, s[8:11], s20 offen sc1
    s_add_u32 s20, s20, 131072
    buffer_load_dwordx4 v[148:151], v1, s[8:11], s20 offen sc1
    s_add_u32 s20, s20, 131072
    buffer_load_dwordx4 v[152:155], v1, s[8:11], s20 offen sc1
    s_add_u32 s20, s20, 131072
    buffer_load_dwordx4 v[156:159], v1, s[8:11], s20 offen sc1
    s_add_u32 s20, s20, 131072
    buffer_load_dwordx4 v[160:163], v1, s[8:11], s20 offen sc1
    s_add_u32 s20, s20, 131072
    buffer_load_dwordx4 v[164:167], v1, s[8:11], s20 offen sc1
    s_add_u32 s20, s20, 131072
    buffer_load_dwordx4 v[8:11], v1, s[8:11], s20 offen sc1
    s_add_u32 s20, s20, 131072
    buffer_load_dwordx4 v[112:115], v1, s[8:11], s20 offen sc1
    s_add_u32 s20, s20, 131072
    buffer_load_dwordx4 v[116:119], v1, s[8:11], s20 offen sc1
    s_add_u32 s20, s20, 131072
    buffer_load_dwordx4 v[120:123], v1, s[8:11], s20 offen sc1
    s_add_u32 s20, s20, 131072
    s_waitcnt vmcnt(19)
    v_max3_u32 v2, v92, v93, v94
    v_max_u32 v2, v2, v95
    v_cmp_eq_u32 vcc, -1, v2
    s_nop 4
    s_cbranch_vccnz parallel_sum__grouped_kv_mqa__mixer_token_mlp__prompt_kernel_os0
parallel_sum__grouped_kv_mqa__mixer_token_mlp__prompt_kernel_ok0:
    s_waitcnt lgkmcnt(5)
    v_mfma_f32_16x16x32_bf16 v[12:15], v[32:35], v[92:95], v[12:15]
    ds_read_b128 v[72:75], v5 offset:0
    v_mfma_f32_16x16x32_bf16 v[16:19], v[36:39], v[92:95], v[16:19]
    ds_read_b128 v[76:79], v5 offset:1024
    s_waitcnt vmcnt(18)
    v_max3_u32 v2, v96, v97, v98
    v_max_u32 v2, v2, v99
    v_cmp_eq_u32 vcc, -1, v2
    v_mfma_f32_16x16x32_bf16 v[20:23], v[40:43], v[92:95], v[20:23]
    ds_read_b128 v[80:83], v5 offset:2048
    v_mfma_f32_16x16x32_bf16 v[24:27], v[44:47], v[92:95], v[24:27]
    ds_read_b128 v[84:87], v5 offset:3072
    v_mfma_f32_16x16x32_bf16 v[28:31], v[48:51], v[92:95], v[28:31]
    ds_read_b128 v[88:91], v5 offset:4096
    s_cbranch_vccnz parallel_sum__grouped_kv_mqa__mixer_token_mlp__prompt_kernel_os1
parallel_sum__grouped_kv_mqa__mixer_token_mlp__prompt_kernel_ok1:
    s_waitcnt lgkmcnt(5)
    v_mfma_f32_16x16x32_bf16 v[12:15], v[52:55], v[96:99], v[12:15]
    ds_read_b128 v[32:35], v5 offset:5120
    v_mfma_f32_16x16x32_bf16 v[16:19], v[56:59], v[96:99], v[16:19]
    ds_read_b128 v[36:39], v5 offset:6144
    s_waitcnt vmcnt(17)
    v_max3_u32 v2, v100, v101, v102
    v_max_u32 v2, v2, v103
    v_cmp_eq_u32 vcc, -1, v2
    v_mfma_f32_16x16x32_bf16 v[20:23], v[60:63], v[96:99], v[20:23]
    ds_read_b128 v[40:43], v5 offset:7168
    v_mfma_f32_16x16x32_bf16 v[24:27], v[64:67], v[96:99], v[24:27]
    ds_read_b128 v[44:47], v5 offset:8192
    v_mfma_f32_16x16x32_bf16 v[28:31], v[68:71], v[96:99], v[28:31]
    ds_read_b128 v[48:51], v5 offset:9216
    s_cbranch_vccnz parallel_sum__grouped_kv_mqa__mixer_token_mlp__prompt_kernel_os2
parallel_sum__grouped_kv_mqa__mixer_token_mlp__prompt_kernel_ok2:
    s_waitcnt lgkmcnt(5)
    v_mfma_f32_16x16x32_bf16 v[12:15], v[72:75], v[100:103], v[12:15]
    ds_read_b128 v[52:55], v5 offset:12288
    v_mfma_f32_16x16x32_bf16 v[16:19], v[76:79], v[100:103], v[16:19]
    ds_read_b128 v[56:59], v5 offset:13312
    s_waitcnt vmcnt(16)
    v_max3_u32 v2, v104, v105, v106
    v_max_u32 v2, v2, v107
    v_cmp_eq_u32 vcc, -1, v2
    v_mfma_f32_16x16x32_bf16 v[20:23], v[80:83], v[100:103], v[20:23]
    ds_read_b128 v[60:63], v5 offset:14336
    v_mfma_f32_16x16x32_bf16 v[24:27], v[84:87], v[100:103], v[24:27]
    ds_read_b128 v[64:67], v5 offset:15360
    v_mfma_f32_16x16x32_bf16 v[28:31], v[88:91], v[100:103], v[28:31]
    ds_read_b128 v[68:71], v5 offset:16384
    s_cbranch_vccnz parallel_sum__grouped_kv_mqa__mixer_token_mlp__prompt_kernel_os3
parallel_sum__grouped_kv_mqa__mixer_token_mlp__prompt_kernel_ok3:
    s_waitcnt lgkmcnt(5)
    v_mfma_f32_16x16x32_bf16 v[12:15], v[32:35], v[104:107], v[12:15]
    ds_read_b128 v[72:75], v5 offset:17408
    v_mfma_f32_16x16x32_bf16 v[16:19], v[36:39], v[104:107], v[16:19]
    ds_read_b128 v[76:79], v5 offset:18432
    s_waitcnt vmcnt(15)
    v_max3_u32 v2, v108, v109, v110
    v_max_u32 v2, v2, v111
    v_cmp_eq_u32 vcc, -1, v2
    v_mfma_f32_16x16x32_bf16 v[20:23], v[40:43], v[104:107], v[20:23]
    ds_read_b128 v[80:83], v5 offset:19456
    v_mfma_f32_16x16x32_bf16 v[24:27], v[44:47], v[104:107], v[24:27]
    ds_read_b128 v[84:87], v5 offset:20480
    v_mfma_f32_16x16x32_bf16 v[28:31], v[48:51], v[104:107], v[28:31]
    ds_read_b128 v[88:91], v5 offset:21504
    s_cbranch_vccnz parallel_sum__grouped_kv_mqa__mixer_token_mlp__prompt_kernel_os4
parallel_sum__grouped_kv_mqa__mixer_token_mlp__prompt_kernel_ok4:
    s_waitcnt lgkmcnt(5)
    v_mfma_f32_16x16x32_bf16 v[12:15], v[52:55], v[108:111], v[12:15]
    ds_read_b128 v[32:35], v5 offset:24576
    v_mfma_f32_16x16x32_bf16 v[16:19], v[56:59], v[108:111], v[16:19]
    ds_read_b128 v[36:39], v5 offset:25600
    s_waitcnt vmcnt(14)
    v_max3_u32 v2, v124, v125, v126
    v_max_u32 v2, v2, v127
    v_cmp_eq_u32 vcc, -1, v2
    v_mfma_f32_16x16x32_bf16 v[20:23], v[60:63], v[108:111], v[20:23]
    ds_read_b128 v[40:43], v5 offset:26624
    v_mfma_f32_16x16x32_bf16 v[24:27], v[64:67], v[108:111], v[24:27]
    ds_read_b128 v[44:47], v5 offset:27648
    v_mfma_f32_16x16x32_bf16 v[28:31], v[68:71], v[108:111], v[28:31]
    ds_read_b128 v[48:51], v5 offset:28672
    s_cbranch_vccnz parallel_sum__grouped_kv_mqa__mixer_token_mlp__prompt_kernel_os5
parallel_sum__grouped_kv_mqa__mixer_token_mlp__prompt_kernel_ok5:
    s_waitcnt lgkmcnt(5)
    v_mfma_f32_16x16x32_bf16 v[12:15], v[72:75], v[124:127], v[12:15]
    ds_read_b128 v[52:55], v5 offset:29696
    v_mfma_f32_16x16x32_bf16 v[16:19], v[76:79], v[124:127], v[16:19]
    ds_read_b128 v[56:59], v5 offset:30720
    s_waitcnt vmcnt(13)
    v_max3_u32 v2, v128, v129, v130
    v_max_u32 v2, v2, v131
    v_cmp_eq_u32 vcc, -1, v2
    v_mfma_f32_16x16x32_bf16 v[20:23], v[80:83], v[124:127], v[20:23]
    ds_read_b128 v[60:63], v5 offset:31744
    v_mfma_f32_16x16x32_bf16 v[24:27], v[84:87], v[124:127], v[24:27]
    ds_read_b128 v[64:67], v5 offset:32768
    v_mfma_f32_16x16x32_bf16 v[28:31], v[88:91], v[124:127], v[28:31]
    ds_read_b128 v[68:71], v5 offset:33792
    s_cbranch_vccnz parallel_sum__grouped_kv_mqa__mixer_token_mlp__prompt_kernel_os6
parallel_sum__grouped_kv_mqa__mixer_token_mlp__prompt_kernel_ok6:
    s_waitcnt lgkmcnt(5)
    v_mfma_f32_16x16x32_bf16 v[12:15], v[32:35], v[128:131], v[12:15]
    ds_read_b128 v[72:75], v5 offset:49152
    v_mfma_f32_16x16x32_bf16 v[16:19], v[36:39], v[128:131], v[16:19]
    ds_read_b128 v[76:79], v5 offset:50176
    s_waitcnt vmcnt(12)
    v_max3_u32 v2, v132, v133, v134
    v_max_u32 v2, v2, v135
    v_cmp_eq_u32 vcc, -1, v2
    v_mfma_f32_16x16x32_bf16 v[20:23], v[40:43], v[128:131], v[20:23]
    ds_read_b128 v[80:83], v5 offset:51200
    v_mfma_f32_16x16x32_bf16 v[24:27], v[44:47], v[128:131], v[24:27]
    ds_read_b128 v[84:87], v5 offset:52224
    v_mfma_f32_16x16x32_bf16 v[28:31], v[48:51], v[128:131], v[28:31]
    ds_read_b128 v[88:91], v5 offset:53248
    s_cbranch_vccnz parallel_sum__grouped_kv_mqa__mixer_token_mlp__prompt_kernel_os7
parallel_sum__grouped_kv_mqa__mixer_token_mlp__prompt_kernel_ok7:
    s_waitcnt lgkmcnt(5)
    v_mfma_f32_16x16x32_bf16 v[12:15], v[52:55], v[132:135], v[12:15]
    ds_read_b128 v[32:35], v6 offset:7168
    v_mfma_f32_16x16x32_bf16 v[16:19], v[56:59], v[132:135], v[16:19]
    ds_read_b128 v[36:39], v6 offset:8192
    s_waitcnt vmcnt(11)
    v_max3_u32 v2, v136, v137, v138
    v_max_u32 v2, v2, v139
    v_cmp_eq_u32 vcc, -1, v2
    v_mfma_f32_16x16x32_bf16 v[20:23], v[60:63], v[132:135], v[20:23]
    ds_read_b128 v[40:43], v6 offset:9216
    v_mfma_f32_16x16x32_bf16 v[24:27], v[64:67], v[132:135], v[24:27]
    ds_read_b128 v[44:47], v6 offset:10240
    v_mfma_f32_16x16x32_bf16 v[28:31], v[68:71], v[132:135], v[28:31]
    ds_read_b128 v[48:51], v6 offset:11264
    s_cbranch_vccnz parallel_sum__grouped_kv_mqa__mixer_token_mlp__prompt_kernel_os8
parallel_sum__grouped_kv_mqa__mixer_token_mlp__prompt_kernel_ok8:
    s_waitcnt lgkmcnt(5)
    v_mfma_f32_16x16x32_bf16 v[12:15], v[72:75], v[136:139], v[12:15]
    ds_read_b128 v[52:55], v6 offset:30720
    v_mfma_f32_16x16x32_bf16 v[16:19], v[76:79], v[136:139], v[16:19]
    ds_read_b128 v[56:59], v6 offset:31744
    s_waitcnt vmcnt(10)
    v_max3_u32 v2, v140, v141, v142
    v_max_u32 v2, v2, v143
    v_cmp_eq_u32 vcc, -1, v2
    v_mfma_f32_16x16x32_bf16 v[20:23], v[80:83], v[136:139], v[20:23]
    ds_read_b128 v[60:63], v6 offset:32768
    v_mfma_f32_16x16x32_bf16 v[24:27], v[84:87], v[136:139], v[24:27]
    ds_read_b128 v[64:67], v6 offset:33792
    v_mfma_f32_16x16x32_bf16 v[28:31], v[88:91], v[136:139], v[28:31]
    ds_read_b128 v[68:71], v6 offset:34816
    s_cbranch_vccnz parallel_sum__grouped_kv_mqa__mixer_token_mlp__prompt_kernel_os9
parallel_sum__grouped_kv_mqa__mixer_token_mlp__prompt_kernel_ok9:
    s_waitcnt lgkmcnt(5)
    v_mfma_f32_16x16x32_bf16 v[12:15], v[32:35], v[140:143], v[12:15]
    ds_read_b128 v[72:75], v6 offset:54272
    v_mfma_f32_16x16x32_bf16 v[16:19], v[36:39], v[140:143], v[16:19]
    ds_read_b128 v[76:79], v6 offset:55296
    s_waitcnt vmcnt(9)
    v_max3_u32 v2, v144, v145, v146
    v_max_u32 v2, v2, v147
    v_cmp_eq_u32 vcc, -1, v2
    v_mfma_f32_16x16x32_bf16 v[20:23], v[40:43], v[140:143], v[20:23]
    ds_read_b128 v[80:83], v6 offset:56320
    v_mfma_f32_16x16x32_bf16 v[24:27], v[44:47], v[140:143], v[24:27]
    ds_read_b128 v[84:87], v6 offset:57344
    v_mfma_f32_16x16x32_bf16 v[28:31], v[48:51], v[140:143], v[28:31]
    ds_read_b128 v[88:91], v6 offset:58368
    s_cbranch_vccnz parallel_sum__grouped_kv_mqa__mixer_token_mlp__prompt_kernel_os10
parallel_sum__grouped_kv_mqa__mixer_token_mlp__prompt_kernel_ok10:
    s_waitcnt lgkmcnt(5)
    v_mfma_f32_16x16x32_bf16 v[12:15], v[52:55], v[144:147], v[12:15]
    ds_read_b128 v[32:35], v5 offset:57344
    v_mfma_f32_16x16x32_bf16 v[16:19], v[56:59], v[144:147], v[16:19]
    ds_read_b128 v[36:39], v5 offset:58368
    s_waitcnt vmcnt(8)
    v_max3_u32 v2, v148, v149, v150
    v_max_u32 v2, v2, v151
    v_cmp_eq_u32 vcc, -1, v2
    v_mfma_f32_16x16x32_bf16 v[20:23], v[60:63], v[144:147], v[20:23]
    ds_read_b128 v[40:43], v5 offset:59392
    v_mfma_f32_16x16x32_bf16 v[24:27], v[64:67], v[144:147], v[24:27]
    ds_read_b128 v[44:47], v5 offset:60416
    v_mfma_f32_16x16x32_bf16 v[28:31], v[68:71], v[144:147], v[28:31]
    ds_read_b128 v[48:51], v5 offset:61440
    s_cbranch_vccnz parallel_sum__grouped_kv_mqa__mixer_token_mlp__prompt_kernel_os11
parallel_sum__grouped_kv_mqa__mixer_token_mlp__prompt_kernel_ok11:
    s_waitcnt lgkmcnt(5)
    v_mfma_f32_16x16x32_bf16 v[12:15], v[72:75], v[148:151], v[12:15]
    ds_read_b128 v[52:55], v5 offset:62464
    v_mfma_f32_16x16x32_bf16 v[16:19], v[76:79], v[148:151], v[16:19]
    ds_read_b128 v[56:59], v5 offset:63488
    s_waitcnt vmcnt(7)
    v_max3_u32 v2, v152, v153, v154
    v_max_u32 v2, v2, v155
    v_cmp_eq_u32 vcc, -1, v2
    v_mfma_f32_16x16x32_bf16 v[20:23], v[80:83], v[148:151], v[20:23]
    ds_read_b128 v[60:63], v5 offset:64512
    v_mfma_f32_16x16x32_bf16 v[24:27], v[84:87], v[148:151], v[24:27]
    ds_read_b128 v[64:67], v6 offset:0
    v_mfma_f32_16x16x32_bf16 v[28:31], v[88:91], v[148:151], v[28:31]
    ds_read_b128 v[68:71], v6 offset:1024
    s_cbranch_vccnz parallel_sum__grouped_kv_mqa__mixer_token_mlp__prompt_kernel_os12
parallel_sum__grouped_kv_mqa__mixer_token_mlp__prompt_kernel_ok12:
    s_waitcnt lgkmcnt(5)
    v_mfma_f32_16x16x32_bf16 v[12:15], v[32:35], v[152:155], v[12:15]
    ds_read_b128 v[72:75], v6 offset:15360
    v_mfma_f32_16x16x32_bf16 v[16:19], v[36:39], v[152:155], v[16:19]
    ds_read_b128 v[76:79], v6 offset:16384
    s_waitcnt vmcnt(6)
    v_max3_u32 v2, v156, v157, v158
    v_max_u32 v2, v2, v159
    v_cmp_eq_u32 vcc, -1, v2
    v_mfma_f32_16x16x32_bf16 v[20:23], v[40:43], v[152:155], v[20:23]
    ds_read_b128 v[80:83], v6 offset:17408
    v_mfma_f32_16x16x32_bf16 v[24:27], v[44:47], v[152:155], v[24:27]
    ds_read_b128 v[84:87], v6 offset:18432
    v_mfma_f32_16x16x32_bf16 v[28:31], v[48:51], v[152:155], v[28:31]
    ds_read_b128 v[88:91], v6 offset:19456
    s_cbranch_vccnz parallel_sum__grouped_kv_mqa__mixer_token_mlp__prompt_kernel_os13
parallel_sum__grouped_kv_mqa__mixer_token_mlp__prompt_kernel_ok13:
    s_waitcnt lgkmcnt(5)
    v_mfma_f32_16x16x32_bf16 v[12:15], v[52:55], v[156:159], v[12:15]
    ds_read_b128 v[32:35], v6 offset:20480
    v_mfma_f32_16x16x32_bf16 v[16:19], v[56:59], v[156:159], v[16:19]
    ds_read_b128 v[36:39], v6 offset:21504
    s_waitcnt vmcnt(5)
    v_max3_u32 v2, v160, v161, v162
    v_max_u32 v2, v2, v163
    v_cmp_eq_u32 vcc, -1, v2
    v_mfma_f32_16x16x32_bf16 v[20:23], v[60:63], v[156:159], v[20:23]
    ds_read_b128 v[40:43], v6 offset:22528
    v_mfma_f32_16x16x32_bf16 v[24:27], v[64:67], v[156:159], v[24:27]
    ds_read_b128 v[44:47], v6 offset:23552
    v_mfma_f32_16x16x32_bf16 v[28:31], v[68:71], v[156:159], v[28:31]
    ds_read_b128 v[48:51], v6 offset:24576
    s_cbranch_vccnz parallel_sum__grouped_kv_mqa__mixer_token_mlp__prompt_kernel_os14
parallel_sum__grouped_kv_mqa__mixer_token_mlp__prompt_kernel_ok14:
    s_waitcnt lgkmcnt(5)
    v_mfma_f32_16x16x32_bf16 v[12:15], v[72:75], v[160:163], v[12:15]
    ds_read_b128 v[52:55], v6 offset:38912
    v_mfma_f32_16x16x32_bf16 v[16:19], v[76:79], v[160:163], v[16:19]
    ds_read_b128 v[56:59], v6 offset:39936
    s_waitcnt vmcnt(4)
    v_max3_u32 v2, v164, v165, v166
    v_max_u32 v2, v2, v167
    v_cmp_eq_u32 vcc, -1, v2
    v_mfma_f32_16x16x32_bf16 v[20:23], v[80:83], v[160:163], v[20:23]
    ds_read_b128 v[60:63], v6 offset:40960
    v_mfma_f32_16x16x32_bf16 v[24:27], v[84:87], v[160:163], v[24:27]
    ds_read_b128 v[64:67], v6 offset:41984
    v_mfma_f32_16x16x32_bf16 v[28:31], v[88:91], v[160:163], v[28:31]
    ds_read_b128 v[68:71], v6 offset:43008
    s_cbranch_vccnz parallel_sum__grouped_kv_mqa__mixer_token_mlp__prompt_kernel_os15
parallel_sum__grouped_kv_mqa__mixer_token_mlp__prompt_kernel_ok15:
    s_waitcnt lgkmcnt(5)
    v_mfma_f32_16x16x32_bf16 v[12:15], v[32:35], v[164:167], v[12:15]
    ds_read_b128 v[72:75], v6 offset:44032
    v_mfma_f32_16x16x32_bf16 v[16:19], v[36:39], v[164:167], v[16:19]
    ds_read_b128 v[76:79], v6 offset:45056
    s_waitcnt vmcnt(3)
    v_max3_u32 v2, v8, v9, v10
    v_max_u32 v2, v2, v11
    v_cmp_eq_u32 vcc, -1, v2
    v_mfma_f32_16x16x32_bf16 v[20:23], v[40:43], v[164:167], v[20:23]
    ds_read_b128 v[80:83], v6 offset:46080
    v_mfma_f32_16x16x32_bf16 v[24:27], v[44:47], v[164:167], v[24:27]
    ds_read_b128 v[84:87], v6 offset:47104
    v_mfma_f32_16x16x32_bf16 v[28:31], v[48:51], v[164:167], v[28:31]
    ds_read_b128 v[88:91], v6 offset:48128
    s_cbranch_vccnz parallel_sum__grouped_kv_mqa__mixer_token_mlp__prompt_kernel_os16
parallel_sum__grouped_kv_mqa__mixer_token_mlp__prompt_kernel_ok16:
    s_waitcnt lgkmcnt(5)
    v_mfma_f32_16x16x32_bf16 v[12:15], v[52:55], v[8:11], v[12:15]
    ds_read_b128 v[32:35], v6 offset:62464
    v_mfma_f32_16x16x32_bf16 v[16:19], v[56:59], v[8:11], v[16:19]
    ds_read_b128 v[36:39], v6 offset:63488
    s_waitcnt vmcnt(2)
    v_max3_u32 v2, v112, v113, v114
    v_max_u32 v2, v2, v115
    v_cmp_eq_u32 vcc, -1, v2
    v_mfma_f32_16x16x32_bf16 v[20:23], v[60:63], v[8:11], v[20:23]
    ds_read_b128 v[40:43], v6 offset:64512
    v_mfma_f32_16x16x32_bf16 v[24:27], v[64:67], v[8:11], v[24:27]
    ds_read_b128 v[44:47], v7 offset:0
    v_mfma_f32_16x16x32_bf16 v[28:31], v[68:71], v[8:11], v[28:31]
    ds_read_b128 v[48:51], v7 offset:1024
    s_cbranch_vccnz parallel_sum__grouped_kv_mqa__mixer_token_mlp__prompt_kernel_os17
parallel_sum__grouped_kv_mqa__mixer_token_mlp__prompt_kernel_ok17:
    s_waitcnt lgkmcnt(5)
    v_mfma_f32_16x16x32_bf16 v[12:15], v[72:75], v[112:115], v[12:15]
    ds_read_b128 v[52:55], v7 offset:2048
    v_mfma_f32_16x16x32_bf16 v[16:19], v[76:79], v[112:115], v[16:19]
    ds_read_b128 v[56:59], v7 offset:3072
    s_waitcnt vmcnt(1)
    v_max3_u32 v2, v116, v117, v118
    v_max_u32 v2, v2, v119
    v_cmp_eq_u32 vcc, -1, v2
    v_mfma_f32_16x16x32_bf16 v[20:23], v[80:83], v[112:115], v[20:23]
    ds_read_b128 v[60:63], v7 offset:4096
    v_mfma_f32_16x16x32_bf16 v[24:27], v[84:87], v[112:115], v[24:27]
    ds_read_b128 v[64:67], v7 offset:5120
    v_mfma_f32_16x16x32_bf16 v[28:31], v[88:91], v[112:115], v[28:31]
    ds_read_b128 v[68:71], v7 offset:6144
    s_cbranch_vccnz parallel_sum__grouped_kv_mqa__mixer_token_mlp__prompt_kernel_os18
parallel_sum__grouped_kv_mqa__mixer_token_mlp__prompt_kernel_ok18:
    s_waitcnt lgkmcnt(5)
    v_mfma_f32_16x16x32_bf16 v[12:15], v[32:35], v[116:119], v[12:15]
    v_mfma_f32_16x16x32_bf16 v[16:19], v[36:39], v[116:119], v[16:19]
    s_waitcnt vmcnt(0)
    v_max3_u32 v2, v120, v121, v122
    v_max_u32 v2, v2, v123
    v_cmp_eq_u32 vcc, -1, v2
    v_mfma_f32_16x16x32_bf16 v[20:23], v[40:43], v[116:119], v[20:23]
    v_mfma_f32_16x16x32_bf16 v[24:27], v[44:47], v[116:119], v[24:27]
    v_mfma_f32_16x16x32_bf16 v[28:31], v[48:51], v[116:119], v[28:31]
    s_cbranch_vccnz parallel_sum__grouped_kv_mqa__mixer_token_mlp__prompt_kernel_os19
parallel_sum__grouped_kv_mqa__mixer_token_mlp__prompt_kernel_ok19:
    s_waitcnt lgkmcnt(0)
    v_mfma_f32_16x16x32_bf16 v[12:15], v[52:55], v[120:123], v[12:15]
    v_mfma_f32_16x16x32_bf16 v[16:19], v[56:59], v[120:123], v[16:19]
    v_mfma_f32_16x16x32_bf16 v[20:23], v[60:63], v[120:123], v[20:23]
    v_mfma_f32_16x16x32_bf16 v[24:27], v[64:67], v[120:123], v[24:27]
    v_mfma_f32_16x16x32_bf16 v[28:31], v[68:71], v[120:123], v[28:31]
    s_nop 4
    v_cvt_pk_bf16_f32 v52, v12, v13
    v_cvt_pk_bf16_f32 v53, v14, v15
    v_cvt_pk_bf16_f32 v54, v16, v17
    v_cvt_pk_bf16_f32 v55, v18, v19
    v_cvt_pk_bf16_f32 v56, v20, v21
    v_cvt_pk_bf16_f32 v57, v22, v23
    v_cvt_pk_bf16_f32 v58, v24, v25
    v_cvt_pk_bf16_f32 v59, v26, v27
    v_cvt_pk_bf16_f32 v60, v28, v29
    v_cvt_pk_bf16_f32 v61, v30, v31
    v_mov_b32 v62, v60
    v_mov_b32 v63, v61
    v_and_b32 v112, 15, v0
    v_bfe_u32 v113, v0, 4, 1
    v_bfe_u32 v114, v0, 5, 1
    v_mul_u32_u24 v112, 1280, v112
    v_lshl_add_u32 v112, v113, 5, v112
    v_lshl_add_u32 v112, v114, 4, v112
    v_permlane16_swap_b32 v52, v54
    v_permlane16_swap_b32 v53, v55
    v_permlane16_swap_b32 v56, v58
    v_permlane16_swap_b32 v57, v59
    v_permlane16_swap_b32 v60, v62
    v_permlane16_swap_b32 v61, v63
    s_nop 1
    buffer_store_dwordx4 v[52:55], v112, s[24:27], s53 offen offset:0 nt
    buffer_store_dwordx4 v[56:59], v112, s[24:27], s53 offen offset:64 nt
    s_mov_b32 exec_lo, 0xffff
    s_mov_b32 exec_hi, 0xffff
    buffer_store_dwordx4 v[60:63], v112, s[24:27], s53 offen offset:128 nt
    s_mov_b64 exec, -1
parallel_sum__grouped_kv_mqa__mixer_token_mlp__prompt_kernel_end:
    s_endpgm
parallel_sum__grouped_kv_mqa__mixer_token_mlp__prompt_kernel_ck0:
    s_setprio 2
parallel_sum__grouped_kv_mqa__mixer_token_mlp__prompt_kernel_ckp0:
    s_mov_b64 exec, 15
    global_load_dword v2, v1, s[4:5] sc1
    s_mov_b64 exec, -1
    s_waitcnt vmcnt(0)
    v_cmp_le_u32 vcc, 9, v2
    s_add_u32 s62, s62, 1
    s_cmp_ge_u32 s62, 1048576
    s_cbranch_scc1 parallel_sum__grouped_kv_mqa__mixer_token_mlp__prompt_kernel_ckr0
    s_and_b32 s66, vcc_lo, 7
    s_xor_b32 s67, s66, 15
    s_ff1_i32_b32 s67, s67
    s_mul_i32 s66, s67, 18
    s_cmp_eq_u32 s67, 3
    s_cselect_b32 s66, 64, s66
    s_cmp_lt_u32 s68, s66
    s_cbranch_scc1 parallel_sum__grouped_kv_mqa__mixer_token_mlp__prompt_kernel_ckr0
    s_sleep 8
    s_branch parallel_sum__grouped_kv_mqa__mixer_token_mlp__prompt_kernel_ckp0
parallel_sum__grouped_kv_mqa__mixer_token_mlp__prompt_kernel_ckr0:
    s_setprio 0
    s_branch parallel_sum__grouped_kv_mqa__mixer_token_mlp__prompt_kernel_ckb0
parallel_sum__grouped_kv_mqa__mixer_token_mlp__prompt_kernel_ck1:
    s_setprio 2
parallel_sum__grouped_kv_mqa__mixer_token_mlp__prompt_kernel_ckp1:
    s_mov_b64 exec, 15
    global_load_dword v2, v1, s[4:5] sc1
    s_mov_b64 exec, -1
    s_waitcnt vmcnt(0)
    v_cmp_le_u32 vcc, 9, v2
    s_add_u32 s62, s62, 1
    s_cmp_ge_u32 s62, 1048576
    s_cbranch_scc1 parallel_sum__grouped_kv_mqa__mixer_token_mlp__prompt_kernel_ckr1
    s_and_b32 s66, vcc_lo, 7
    s_xor_b32 s67, s66, 15
    s_ff1_i32_b32 s67, s67
    s_mul_i32 s66, s67, 18
    s_cmp_eq_u32 s67, 3
    s_cselect_b32 s66, 64, s66
    s_cmp_lt_u32 s68, s66
    s_cbranch_scc1 parallel_sum__grouped_kv_mqa__mixer_token_mlp__prompt_kernel_ckr1
    s_sleep 8
    s_branch parallel_sum__grouped_kv_mqa__mixer_token_mlp__prompt_kernel_ckp1
parallel_sum__grouped_kv_mqa__mixer_token_mlp__prompt_kernel_ckr1:
    s_setprio 0
    s_branch parallel_sum__grouped_kv_mqa__mixer_token_mlp__prompt_kernel_ckb1
parallel_sum__grouped_kv_mqa__mixer_token_mlp__prompt_kernel_ck2:
    s_setprio 2
parallel_sum__grouped_kv_mqa__mixer_token_mlp__prompt_kernel_ckp2:
    s_mov_b64 exec, 15
    global_load_dword v2, v1, s[4:5] sc1
    s_mov_b64 exec, -1
    s_waitcnt vmcnt(0)
    v_cmp_le_u32 vcc, 9, v2
    s_add_u32 s62, s62, 1
    s_cmp_ge_u32 s62, 1048576
    s_cbranch_scc1 parallel_sum__grouped_kv_mqa__mixer_token_mlp__prompt_kernel_ckr2
    s_and_b32 s66, vcc_lo, 7
    s_xor_b32 s67, s66, 15
    s_ff1_i32_b32 s67, s67
    s_mul_i32 s66, s67, 18
    s_cmp_eq_u32 s67, 3
    s_cselect_b32 s66, 64, s66
    s_cmp_lt_u32 s68, s66
    s_cbranch_scc1 parallel_sum__grouped_kv_mqa__mixer_token_mlp__prompt_kernel_ckr2
    s_sleep 8
    s_branch parallel_sum__grouped_kv_mqa__mixer_token_mlp__prompt_kernel_ckp2
parallel_sum__grouped_kv_mqa__mixer_token_mlp__prompt_kernel_ckr2:
    s_setprio 0
    s_branch parallel_sum__grouped_kv_mqa__mixer_token_mlp__prompt_kernel_ckb2
parallel_sum__grouped_kv_mqa__mixer_token_mlp__prompt_kernel_ck3:
    s_setprio 2
parallel_sum__grouped_kv_mqa__mixer_token_mlp__prompt_kernel_ckp3:
    s_mov_b64 exec, 15
    global_load_dword v2, v1, s[4:5] sc1
    s_mov_b64 exec, -1
    s_waitcnt vmcnt(0)
    v_cmp_le_u32 vcc, 9, v2
    s_add_u32 s62, s62, 1
    s_cmp_ge_u32 s62, 1048576
    s_cbranch_scc1 parallel_sum__grouped_kv_mqa__mixer_token_mlp__prompt_kernel_ckr3
    s_and_b32 s66, vcc_lo, 7
    s_xor_b32 s67, s66, 15
    s_ff1_i32_b32 s67, s67
    s_mul_i32 s66, s67, 18
    s_cmp_eq_u32 s67, 3
    s_cselect_b32 s66, 64, s66
    s_cmp_lt_u32 s68, s66
    s_cbranch_scc1 parallel_sum__grouped_kv_mqa__mixer_token_mlp__prompt_kernel_ckr3
    s_sleep 8
    s_branch parallel_sum__grouped_kv_mqa__mixer_token_mlp__prompt_kernel_ckp3
parallel_sum__grouped_kv_mqa__mixer_token_mlp__prompt_kernel_ckr3:
    s_setprio 0
    s_branch parallel_sum__grouped_kv_mqa__mixer_token_mlp__prompt_kernel_ckb3
parallel_sum__grouped_kv_mqa__mixer_token_mlp__prompt_kernel_lx0:
    s_sleep 1
    s_branch parallel_sum__grouped_kv_mqa__mixer_token_mlp__prompt_kernel_lw0
parallel_sum__grouped_kv_mqa__mixer_token_mlp__prompt_kernel_lx1:
    s_sleep 1
    s_branch parallel_sum__grouped_kv_mqa__mixer_token_mlp__prompt_kernel_lw1
parallel_sum__grouped_kv_mqa__mixer_token_mlp__prompt_kernel_cx2:
    ds_read_b32 v8, v147 offset:44
    s_waitcnt lgkmcnt(0)
    v_cmp_gt_u32 vcc, 1, v8
    s_nop 4
    s_cbranch_vccz parallel_sum__grouped_kv_mqa__mixer_token_mlp__prompt_kernel_cb2
    s_sleep 1
    s_branch parallel_sum__grouped_kv_mqa__mixer_token_mlp__prompt_kernel_cx2
parallel_sum__grouped_kv_mqa__mixer_token_mlp__prompt_kernel_cx3:
    ds_read_b32 v8, v147 offset:48
    s_waitcnt lgkmcnt(0)
    v_cmp_gt_u32 vcc, 1, v8
    s_nop 4
    s_cbranch_vccz parallel_sum__grouped_kv_mqa__mixer_token_mlp__prompt_kernel_cb3
    s_sleep 1
    s_branch parallel_sum__grouped_kv_mqa__mixer_token_mlp__prompt_kernel_cx3
parallel_sum__grouped_kv_mqa__mixer_token_mlp__prompt_kernel_cx4:
    ds_read_b32 v8, v147 offset:52
    s_waitcnt lgkmcnt(0)
    v_cmp_gt_u32 vcc, 1, v8
    s_nop 4
    s_cbranch_vccz parallel_sum__grouped_kv_mqa__mixer_token_mlp__prompt_kernel_cb4
    s_sleep 1
    s_branch parallel_sum__grouped_kv_mqa__mixer_token_mlp__prompt_kernel_cx4
parallel_sum__grouped_kv_mqa__mixer_token_mlp__prompt_kernel_cx5:
    ds_read_b32 v8, v147 offset:56
    s_waitcnt lgkmcnt(0)
    v_cmp_gt_u32 vcc, 1, v8
    s_nop 4
    s_cbranch_vccz parallel_sum__grouped_kv_mqa__mixer_token_mlp__prompt_kernel_cb5
    s_sleep 1
    s_branch parallel_sum__grouped_kv_mqa__mixer_token_mlp__prompt_kernel_cx5
parallel_sum__grouped_kv_mqa__mixer_token_mlp__prompt_kernel_cx6:
    ds_read_b32 v8, v147 offset:60
    s_waitcnt lgkmcnt(0)
    v_cmp_gt_u32 vcc, 1, v8
    s_nop 4
    s_cbranch_vccz parallel_sum__grouped_kv_mqa__mixer_token_mlp__prompt_kernel_cb6
    s_sleep 1
    s_branch parallel_sum__grouped_kv_mqa__mixer_token_mlp__prompt_kernel_cx6
parallel_sum__grouped_kv_mqa__mixer_token_mlp__prompt_kernel_cx7:
    ds_read_b32 v8, v147 offset:64
    s_waitcnt lgkmcnt(0)
    v_cmp_gt_u32 vcc, 1, v8
    s_nop 4
    s_cbranch_vccz parallel_sum__grouped_kv_mqa__mixer_token_mlp__prompt_kernel_cb7
    s_sleep 1
    s_branch parallel_sum__grouped_kv_mqa__mixer_token_mlp__prompt_kernel_cx7
parallel_sum__grouped_kv_mqa__mixer_token_mlp__prompt_kernel_cx8:
    ds_read_b32 v8, v147 offset:68
    s_waitcnt lgkmcnt(0)
    v_cmp_gt_u32 vcc, 1, v8
    s_nop 4
    s_cbranch_vccz parallel_sum__grouped_kv_mqa__mixer_token_mlp__prompt_kernel_cb8
    s_sleep 1
    s_branch parallel_sum__grouped_kv_mqa__mixer_token_mlp__prompt_kernel_cx8
parallel_sum__grouped_kv_mqa__mixer_token_mlp__prompt_kernel_cx9:
    ds_read_b32 v8, v147 offset:72
    s_waitcnt lgkmcnt(0)
    v_cmp_gt_u32 vcc, 1, v8
    s_nop 4
    s_cbranch_vccz parallel_sum__grouped_kv_mqa__mixer_token_mlp__prompt_kernel_cb9
    s_sleep 1
    s_branch parallel_sum__grouped_kv_mqa__mixer_token_mlp__prompt_kernel_cx9
parallel_sum__grouped_kv_mqa__mixer_token_mlp__prompt_kernel_cx10:
    ds_read_b32 v8, v147 offset:76
    s_waitcnt lgkmcnt(0)
    v_cmp_gt_u32 vcc, 1, v8
    s_nop 4
    s_cbranch_vccz parallel_sum__grouped_kv_mqa__mixer_token_mlp__prompt_kernel_cb10
    s_sleep 1
    s_branch parallel_sum__grouped_kv_mqa__mixer_token_mlp__prompt_kernel_cx10
parallel_sum__grouped_kv_mqa__mixer_token_mlp__prompt_kernel_lx11:
    s_sleep 1
    s_branch parallel_sum__grouped_kv_mqa__mixer_token_mlp__prompt_kernel_lw11
parallel_sum__grouped_kv_mqa__mixer_token_mlp__prompt_kernel_lx12:
    s_sleep 1
    s_branch parallel_sum__grouped_kv_mqa__mixer_token_mlp__prompt_kernel_lw12
parallel_sum__grouped_kv_mqa__mixer_token_mlp__prompt_kernel_pf6:
    s_mov_b32 s24, s40
    s_and_b32 s25, s41, 0xffff
    s_mov_b32 s26, 7077888
    s_mov_b32 s27, 0x20000
    s_lshl_b32 s7, s2, 1
    s_add_u32 s7, s7, s6
    s_sub_u32 s7, s7, 2
    s_mul_i32 s7, s7, 13824
    v_and_b32 v2, 63, v0
    v_min_u32 v2, 53, v2
    v_lshlrev_b32 v2, 7, v2
    buffer_load_dword v4, v2, s[24:27], s7 offen
    s_add_u32 s7, s7, 6912
    buffer_load_dword v4, v2, s[24:27], s7 offen
    s_branch parallel_sum__grouped_kv_mqa__mixer_token_mlp__prompt_kernel_g
parallel_sum__grouped_kv_mqa__mixer_token_mlp__prompt_kernel_lx13:
    s_sleep 1
    s_branch parallel_sum__grouped_kv_mqa__mixer_token_mlp__prompt_kernel_lw13
parallel_sum__grouped_kv_mqa__mixer_token_mlp__prompt_kernel_lx14:
    s_sleep 2
    s_branch parallel_sum__grouped_kv_mqa__mixer_token_mlp__prompt_kernel_lw14
parallel_sum__grouped_kv_mqa__mixer_token_mlp__prompt_kernel_lx15:
    s_sleep 2
    s_branch parallel_sum__grouped_kv_mqa__mixer_token_mlp__prompt_kernel_lw15
parallel_sum__grouped_kv_mqa__mixer_token_mlp__prompt_kernel_gx17:
    s_cmp_ge_u32 s71, 1048576
    s_cbranch_scc1 parallel_sum__grouped_kv_mqa__mixer_token_mlp__prompt_kernel_gy17
    s_sleep 2
    s_branch parallel_sum__grouped_kv_mqa__mixer_token_mlp__prompt_kernel_gw17
parallel_sum__grouped_kv_mqa__mixer_token_mlp__prompt_kernel_gx18:
    s_cmp_ge_u32 s71, 1048576
    s_cbranch_scc1 parallel_sum__grouped_kv_mqa__mixer_token_mlp__prompt_kernel_gy18
    s_sleep 1
    s_branch parallel_sum__grouped_kv_mqa__mixer_token_mlp__prompt_kernel_gw18
parallel_sum__grouped_kv_mqa__mixer_token_mlp__prompt_kernel_sx20:
    s_cmp_ge_u32 s71, 1048576
    s_cbranch_scc1 parallel_sum__grouped_kv_mqa__mixer_token_mlp__prompt_kernel_sy20
    s_sleep 2
    s_branch parallel_sum__grouped_kv_mqa__mixer_token_mlp__prompt_kernel_sw20
parallel_sum__grouped_kv_mqa__mixer_token_mlp__prompt_kernel_lx21:
    s_sleep 2
    s_branch parallel_sum__grouped_kv_mqa__mixer_token_mlp__prompt_kernel_lw21
parallel_sum__grouped_kv_mqa__mixer_token_mlp__prompt_kernel_lx22:
    s_sleep 8
    s_branch parallel_sum__grouped_kv_mqa__mixer_token_mlp__prompt_kernel_lw22
parallel_sum__grouped_kv_mqa__mixer_token_mlp__prompt_kernel_gx23:
    s_cmp_ge_u32 s71, 1048576
    s_cbranch_scc1 parallel_sum__grouped_kv_mqa__mixer_token_mlp__prompt_kernel_gy23
    s_sleep 8
    s_branch parallel_sum__grouped_kv_mqa__mixer_token_mlp__prompt_kernel_gw23
parallel_sum__grouped_kv_mqa__mixer_token_mlp__prompt_kernel_lx24:
    s_sleep 8
    s_branch parallel_sum__grouped_kv_mqa__mixer_token_mlp__prompt_kernel_lw24
parallel_sum__grouped_kv_mqa__mixer_token_mlp__prompt_kernel_lx25:
    s_sleep 8
    s_branch parallel_sum__grouped_kv_mqa__mixer_token_mlp__prompt_kernel_lw25
parallel_sum__grouped_kv_mqa__mixer_token_mlp__prompt_kernel_lx26:
    s_sleep 8
    s_branch parallel_sum__grouped_kv_mqa__mixer_token_mlp__prompt_kernel_lw26
parallel_sum__grouped_kv_mqa__mixer_token_mlp__prompt_kernel_lx27:
    s_sleep 2
    s_branch parallel_sum__grouped_kv_mqa__mixer_token_mlp__prompt_kernel_lw27
parallel_sum__grouped_kv_mqa__mixer_token_mlp__prompt_kernel_lx28:
    s_sleep 2
    s_branch parallel_sum__grouped_kv_mqa__mixer_token_mlp__prompt_kernel_lw28
parallel_sum__grouped_kv_mqa__mixer_token_mlp__prompt_kernel_lx29:
    s_sleep 1
    s_branch parallel_sum__grouped_kv_mqa__mixer_token_mlp__prompt_kernel_lw29
parallel_sum__grouped_kv_mqa__mixer_token_mlp__prompt_kernel_lx30:
    s_sleep 4
    s_branch parallel_sum__grouped_kv_mqa__mixer_token_mlp__prompt_kernel_lw30
parallel_sum__grouped_kv_mqa__mixer_token_mlp__prompt_kernel_lx31:
    s_sleep 4
    s_branch parallel_sum__grouped_kv_mqa__mixer_token_mlp__prompt_kernel_lw31
parallel_sum__grouped_kv_mqa__mixer_token_mlp__prompt_kernel_gx33:
    s_cmp_ge_u32 s71, 1048576
    s_cbranch_scc1 parallel_sum__grouped_kv_mqa__mixer_token_mlp__prompt_kernel_gy33
    s_sleep 2
    s_branch parallel_sum__grouped_kv_mqa__mixer_token_mlp__prompt_kernel_gw33
parallel_sum__grouped_kv_mqa__mixer_token_mlp__prompt_kernel_lx34:
    s_sleep 4
    s_branch parallel_sum__grouped_kv_mqa__mixer_token_mlp__prompt_kernel_lw34
parallel_sum__grouped_kv_mqa__mixer_token_mlp__prompt_kernel_lx35:
    s_sleep 8
    s_branch parallel_sum__grouped_kv_mqa__mixer_token_mlp__prompt_kernel_lw35
parallel_sum__grouped_kv_mqa__mixer_token_mlp__prompt_kernel_lx36:
    s_sleep 1
    s_branch parallel_sum__grouped_kv_mqa__mixer_token_mlp__prompt_kernel_lw36
parallel_sum__grouped_kv_mqa__mixer_token_mlp__prompt_kernel_lx37:
    s_sleep 1
    s_branch parallel_sum__grouped_kv_mqa__mixer_token_mlp__prompt_kernel_lw37
parallel_sum__grouped_kv_mqa__mixer_token_mlp__prompt_kernel_lx38:
    s_sleep 1
    s_branch parallel_sum__grouped_kv_mqa__mixer_token_mlp__prompt_kernel_lw38
parallel_sum__grouped_kv_mqa__mixer_token_mlp__prompt_kernel_os0:
    s_mov_b32 s23, 0
    s_add_u32 s20, s22, 0
    s_add_u32 s62, s62, 1
    s_cmp_ge_u32 s62, 0x4000
    s_cbranch_scc1 parallel_sum__grouped_kv_mqa__mixer_token_mlp__prompt_kernel_ok0
    s_sleep 8
    s_branch parallel_sum__grouped_kv_mqa__mixer_token_mlp__prompt_kernel_ol0
parallel_sum__grouped_kv_mqa__mixer_token_mlp__prompt_kernel_oc0:
    s_waitcnt vmcnt(0)
    v_max3_u32 v2, v92, v93, v94
    v_max_u32 v2, v2, v95
    v_cmp_eq_u32 vcc, -1, v2
    s_nop 4
    s_cbranch_vccnz parallel_sum__grouped_kv_mqa__mixer_token_mlp__prompt_kernel_os0
    s_branch parallel_sum__grouped_kv_mqa__mixer_token_mlp__prompt_kernel_ok0
parallel_sum__grouped_kv_mqa__mixer_token_mlp__prompt_kernel_os1:
    s_mov_b32 s23, 1
    s_add_u32 s20, s22, 131072
    s_add_u32 s62, s62, 1
    s_cmp_ge_u32 s62, 0x4000
    s_cbranch_scc1 parallel_sum__grouped_kv_mqa__mixer_token_mlp__prompt_kernel_ok1
    s_sleep 8
    s_branch parallel_sum__grouped_kv_mqa__mixer_token_mlp__prompt_kernel_ol1
parallel_sum__grouped_kv_mqa__mixer_token_mlp__prompt_kernel_oc1:
    s_waitcnt vmcnt(0)
    v_max3_u32 v2, v96, v97, v98
    v_max_u32 v2, v2, v99
    v_cmp_eq_u32 vcc, -1, v2
    s_nop 4
    s_cbranch_vccnz parallel_sum__grouped_kv_mqa__mixer_token_mlp__prompt_kernel_os1
    s_branch parallel_sum__grouped_kv_mqa__mixer_token_mlp__prompt_kernel_ok1
parallel_sum__grouped_kv_mqa__mixer_token_mlp__prompt_kernel_os2:
    s_mov_b32 s23, 2
    s_add_u32 s20, s22, 262144
    s_add_u32 s62, s62, 1
    s_cmp_ge_u32 s62, 0x4000
    s_cbranch_scc1 parallel_sum__grouped_kv_mqa__mixer_token_mlp__prompt_kernel_ok2
    s_sleep 8
    s_branch parallel_sum__grouped_kv_mqa__mixer_token_mlp__prompt_kernel_ol2
parallel_sum__grouped_kv_mqa__mixer_token_mlp__prompt_kernel_oc2:
    s_waitcnt vmcnt(0)
    v_max3_u32 v2, v100, v101, v102
    v_max_u32 v2, v2, v103
    v_cmp_eq_u32 vcc, -1, v2
    s_nop 4
    s_cbranch_vccnz parallel_sum__grouped_kv_mqa__mixer_token_mlp__prompt_kernel_os2
    s_branch parallel_sum__grouped_kv_mqa__mixer_token_mlp__prompt_kernel_ok2
parallel_sum__grouped_kv_mqa__mixer_token_mlp__prompt_kernel_os3:
    s_mov_b32 s23, 3
    s_add_u32 s20, s22, 393216
    s_add_u32 s62, s62, 1
    s_cmp_ge_u32 s62, 0x4000
    s_cbranch_scc1 parallel_sum__grouped_kv_mqa__mixer_token_mlp__prompt_kernel_ok3
    s_sleep 8
    s_branch parallel_sum__grouped_kv_mqa__mixer_token_mlp__prompt_kernel_ol3
parallel_sum__grouped_kv_mqa__mixer_token_mlp__prompt_kernel_oc3:
    s_waitcnt vmcnt(0)
    v_max3_u32 v2, v104, v105, v106
    v_max_u32 v2, v2, v107
    v_cmp_eq_u32 vcc, -1, v2
    s_nop 4
    s_cbranch_vccnz parallel_sum__grouped_kv_mqa__mixer_token_mlp__prompt_kernel_os3
    s_branch parallel_sum__grouped_kv_mqa__mixer_token_mlp__prompt_kernel_ok3
parallel_sum__grouped_kv_mqa__mixer_token_mlp__prompt_kernel_os4:
    s_mov_b32 s23, 4
    s_add_u32 s20, s22, 524288
    s_add_u32 s62, s62, 1
    s_cmp_ge_u32 s62, 0x4000
    s_cbranch_scc1 parallel_sum__grouped_kv_mqa__mixer_token_mlp__prompt_kernel_ok4
    s_sleep 8
    s_branch parallel_sum__grouped_kv_mqa__mixer_token_mlp__prompt_kernel_ol4
parallel_sum__grouped_kv_mqa__mixer_token_mlp__prompt_kernel_oc4:
    s_waitcnt vmcnt(0)
    v_max3_u32 v2, v108, v109, v110
    v_max_u32 v2, v2, v111
    v_cmp_eq_u32 vcc, -1, v2
    s_nop 4
    s_cbranch_vccnz parallel_sum__grouped_kv_mqa__mixer_token_mlp__prompt_kernel_os4
    s_branch parallel_sum__grouped_kv_mqa__mixer_token_mlp__prompt_kernel_ok4
parallel_sum__grouped_kv_mqa__mixer_token_mlp__prompt_kernel_os5:
    s_mov_b32 s23, 5
    s_add_u32 s20, s22, 655360
    s_add_u32 s62, s62, 1
    s_cmp_ge_u32 s62, 0x4000
    s_cbranch_scc1 parallel_sum__grouped_kv_mqa__mixer_token_mlp__prompt_kernel_ok5
    s_sleep 8
    s_branch parallel_sum__grouped_kv_mqa__mixer_token_mlp__prompt_kernel_ol5
parallel_sum__grouped_kv_mqa__mixer_token_mlp__prompt_kernel_oc5:
    s_waitcnt vmcnt(0)
    v_max3_u32 v2, v124, v125, v126
    v_max_u32 v2, v2, v127
    v_cmp_eq_u32 vcc, -1, v2
    s_nop 4
    s_cbranch_vccnz parallel_sum__grouped_kv_mqa__mixer_token_mlp__prompt_kernel_os5
    s_branch parallel_sum__grouped_kv_mqa__mixer_token_mlp__prompt_kernel_ok5
parallel_sum__grouped_kv_mqa__mixer_token_mlp__prompt_kernel_os6:
    s_mov_b32 s23, 6
    s_add_u32 s20, s22, 786432
    s_add_u32 s62, s62, 1
    s_cmp_ge_u32 s62, 0x4000
    s_cbranch_scc1 parallel_sum__grouped_kv_mqa__mixer_token_mlp__prompt_kernel_ok6
    s_sleep 8
    s_branch parallel_sum__grouped_kv_mqa__mixer_token_mlp__prompt_kernel_ol6
parallel_sum__grouped_kv_mqa__mixer_token_mlp__prompt_kernel_oc6:
    s_waitcnt vmcnt(0)
    v_max3_u32 v2, v128, v129, v130
    v_max_u32 v2, v2, v131
    v_cmp_eq_u32 vcc, -1, v2
    s_nop 4
    s_cbranch_vccnz parallel_sum__grouped_kv_mqa__mixer_token_mlp__prompt_kernel_os6
    s_branch parallel_sum__grouped_kv_mqa__mixer_token_mlp__prompt_kernel_ok6
parallel_sum__grouped_kv_mqa__mixer_token_mlp__prompt_kernel_os7:
    s_mov_b32 s23, 7
    s_add_u32 s20, s22, 917504
    s_add_u32 s62, s62, 1
    s_cmp_ge_u32 s62, 0x4000
    s_cbranch_scc1 parallel_sum__grouped_kv_mqa__mixer_token_mlp__prompt_kernel_ok7
    s_sleep 8
    s_branch parallel_sum__grouped_kv_mqa__mixer_token_mlp__prompt_kernel_ol7
parallel_sum__grouped_kv_mqa__mixer_token_mlp__prompt_kernel_oc7:
    s_waitcnt vmcnt(0)
    v_max3_u32 v2, v132, v133, v134
    v_max_u32 v2, v2, v135
    v_cmp_eq_u32 vcc, -1, v2
    s_nop 4
    s_cbranch_vccnz parallel_sum__grouped_kv_mqa__mixer_token_mlp__prompt_kernel_os7
    s_branch parallel_sum__grouped_kv_mqa__mixer_token_mlp__prompt_kernel_ok7
parallel_sum__grouped_kv_mqa__mixer_token_mlp__prompt_kernel_os8:
    s_mov_b32 s23, 8
    s_add_u32 s20, s22, 1048576
    s_add_u32 s62, s62, 1
    s_cmp_ge_u32 s62, 0x4000
    s_cbranch_scc1 parallel_sum__grouped_kv_mqa__mixer_token_mlp__prompt_kernel_ok8
    s_sleep 8
    s_branch parallel_sum__grouped_kv_mqa__mixer_token_mlp__prompt_kernel_ol8
parallel_sum__grouped_kv_mqa__mixer_token_mlp__prompt_kernel_oc8:
    s_waitcnt vmcnt(0)
    v_max3_u32 v2, v136, v137, v138
    v_max_u32 v2, v2, v139
    v_cmp_eq_u32 vcc, -1, v2
    s_nop 4
    s_cbranch_vccnz parallel_sum__grouped_kv_mqa__mixer_token_mlp__prompt_kernel_os8
    s_branch parallel_sum__grouped_kv_mqa__mixer_token_mlp__prompt_kernel_ok8
parallel_sum__grouped_kv_mqa__mixer_token_mlp__prompt_kernel_os9:
    s_mov_b32 s23, 9
    s_add_u32 s20, s22, 1179648
    s_add_u32 s62, s62, 1
    s_cmp_ge_u32 s62, 0x4000
    s_cbranch_scc1 parallel_sum__grouped_kv_mqa__mixer_token_mlp__prompt_kernel_ok9
    s_sleep 8
    s_branch parallel_sum__grouped_kv_mqa__mixer_token_mlp__prompt_kernel_ol9
parallel_sum__grouped_kv_mqa__mixer_token_mlp__prompt_kernel_oc9:
    s_waitcnt vmcnt(0)
    v_max3_u32 v2, v140, v141, v142
    v_max_u32 v2, v2, v143
    v_cmp_eq_u32 vcc, -1, v2
    s_nop 4
    s_cbranch_vccnz parallel_sum__grouped_kv_mqa__mixer_token_mlp__prompt_kernel_os9
    s_branch parallel_sum__grouped_kv_mqa__mixer_token_mlp__prompt_kernel_ok9
parallel_sum__grouped_kv_mqa__mixer_token_mlp__prompt_kernel_os10:
    s_mov_b32 s23, 10
    s_add_u32 s20, s22, 1310720
    s_add_u32 s62, s62, 1
    s_cmp_ge_u32 s62, 0x4000
    s_cbranch_scc1 parallel_sum__grouped_kv_mqa__mixer_token_mlp__prompt_kernel_ok10
    s_sleep 8
    s_branch parallel_sum__grouped_kv_mqa__mixer_token_mlp__prompt_kernel_ol10
parallel_sum__grouped_kv_mqa__mixer_token_mlp__prompt_kernel_oc10:
    s_waitcnt vmcnt(0)
    v_max3_u32 v2, v144, v145, v146
    v_max_u32 v2, v2, v147
    v_cmp_eq_u32 vcc, -1, v2
    s_nop 4
    s_cbranch_vccnz parallel_sum__grouped_kv_mqa__mixer_token_mlp__prompt_kernel_os10
    s_branch parallel_sum__grouped_kv_mqa__mixer_token_mlp__prompt_kernel_ok10
parallel_sum__grouped_kv_mqa__mixer_token_mlp__prompt_kernel_os11:
    s_mov_b32 s23, 11
    s_add_u32 s20, s22, 1441792
    s_add_u32 s62, s62, 1
    s_cmp_ge_u32 s62, 0x4000
    s_cbranch_scc1 parallel_sum__grouped_kv_mqa__mixer_token_mlp__prompt_kernel_ok11
    s_sleep 8
    s_branch parallel_sum__grouped_kv_mqa__mixer_token_mlp__prompt_kernel_ol11
parallel_sum__grouped_kv_mqa__mixer_token_mlp__prompt_kernel_oc11:
    s_waitcnt vmcnt(0)
    v_max3_u32 v2, v148, v149, v150
    v_max_u32 v2, v2, v151
    v_cmp_eq_u32 vcc, -1, v2
    s_nop 4
    s_cbranch_vccnz parallel_sum__grouped_kv_mqa__mixer_token_mlp__prompt_kernel_os11
    s_branch parallel_sum__grouped_kv_mqa__mixer_token_mlp__prompt_kernel_ok11
parallel_sum__grouped_kv_mqa__mixer_token_mlp__prompt_kernel_os12:
    s_mov_b32 s23, 12
    s_add_u32 s20, s22, 1572864
    s_add_u32 s62, s62, 1
    s_cmp_ge_u32 s62, 0x4000
    s_cbranch_scc1 parallel_sum__grouped_kv_mqa__mixer_token_mlp__prompt_kernel_ok12
    s_sleep 8
    s_branch parallel_sum__grouped_kv_mqa__mixer_token_mlp__prompt_kernel_ol12
parallel_sum__grouped_kv_mqa__mixer_token_mlp__prompt_kernel_oc12:
    s_waitcnt vmcnt(0)
    v_max3_u32 v2, v152, v153, v154
    v_max_u32 v2, v2, v155
    v_cmp_eq_u32 vcc, -1, v2
    s_nop 4
    s_cbranch_vccnz parallel_sum__grouped_kv_mqa__mixer_token_mlp__prompt_kernel_os12
    s_branch parallel_sum__grouped_kv_mqa__mixer_token_mlp__prompt_kernel_ok12
parallel_sum__grouped_kv_mqa__mixer_token_mlp__prompt_kernel_os13:
    s_mov_b32 s23, 13
    s_add_u32 s20, s22, 1703936
    s_add_u32 s62, s62, 1
    s_cmp_ge_u32 s62, 0x4000
    s_cbranch_scc1 parallel_sum__grouped_kv_mqa__mixer_token_mlp__prompt_kernel_ok13
    s_sleep 8
    s_branch parallel_sum__grouped_kv_mqa__mixer_token_mlp__prompt_kernel_ol13
parallel_sum__grouped_kv_mqa__mixer_token_mlp__prompt_kernel_oc13:
    s_waitcnt vmcnt(0)
    v_max3_u32 v2, v156, v157, v158
    v_max_u32 v2, v2, v159
    v_cmp_eq_u32 vcc, -1, v2
    s_nop 4
    s_cbranch_vccnz parallel_sum__grouped_kv_mqa__mixer_token_mlp__prompt_kernel_os13
    s_branch parallel_sum__grouped_kv_mqa__mixer_token_mlp__prompt_kernel_ok13
parallel_sum__grouped_kv_mqa__mixer_token_mlp__prompt_kernel_os14:
    s_mov_b32 s23, 14
    s_add_u32 s20, s22, 1835008
    s_add_u32 s62, s62, 1
    s_cmp_ge_u32 s62, 0x4000
    s_cbranch_scc1 parallel_sum__grouped_kv_mqa__mixer_token_mlp__prompt_kernel_ok14
    s_sleep 8
    s_branch parallel_sum__grouped_kv_mqa__mixer_token_mlp__prompt_kernel_ol14
parallel_sum__grouped_kv_mqa__mixer_token_mlp__prompt_kernel_oc14:
    s_waitcnt vmcnt(0)
    v_max3_u32 v2, v160, v161, v162
    v_max_u32 v2, v2, v163
    v_cmp_eq_u32 vcc, -1, v2
    s_nop 4
    s_cbranch_vccnz parallel_sum__grouped_kv_mqa__mixer_token_mlp__prompt_kernel_os14
    s_branch parallel_sum__grouped_kv_mqa__mixer_token_mlp__prompt_kernel_ok14
parallel_sum__grouped_kv_mqa__mixer_token_mlp__prompt_kernel_os15:
    s_mov_b32 s23, 15
    s_add_u32 s20, s22, 1966080
    s_add_u32 s62, s62, 1
    s_cmp_ge_u32 s62, 0x4000
    s_cbranch_scc1 parallel_sum__grouped_kv_mqa__mixer_token_mlp__prompt_kernel_ok15
    s_sleep 8
    s_branch parallel_sum__grouped_kv_mqa__mixer_token_mlp__prompt_kernel_ol15
parallel_sum__grouped_kv_mqa__mixer_token_mlp__prompt_kernel_oc15:
    s_waitcnt vmcnt(0)
    v_max3_u32 v2, v164, v165, v166
    v_max_u32 v2, v2, v167
    v_cmp_eq_u32 vcc, -1, v2
    s_nop 4
    s_cbranch_vccnz parallel_sum__grouped_kv_mqa__mixer_token_mlp__prompt_kernel_os15
    s_branch parallel_sum__grouped_kv_mqa__mixer_token_mlp__prompt_kernel_ok15
parallel_sum__grouped_kv_mqa__mixer_token_mlp__prompt_kernel_os16:
    s_mov_b32 s23, 16
    s_add_u32 s20, s22, 2097152
    s_add_u32 s62, s62, 1
    s_cmp_ge_u32 s62, 0x4000
    s_cbranch_scc1 parallel_sum__grouped_kv_mqa__mixer_token_mlp__prompt_kernel_ok16
    s_sleep 8
    s_branch parallel_sum__grouped_kv_mqa__mixer_token_mlp__prompt_kernel_ol16
parallel_sum__grouped_kv_mqa__mixer_token_mlp__prompt_kernel_oc16:
    s_waitcnt vmcnt(0)
    v_max3_u32 v2, v8, v9, v10
    v_max_u32 v2, v2, v11
    v_cmp_eq_u32 vcc, -1, v2
    s_nop 4
    s_cbranch_vccnz parallel_sum__grouped_kv_mqa__mixer_token_mlp__prompt_kernel_os16
    s_branch parallel_sum__grouped_kv_mqa__mixer_token_mlp__prompt_kernel_ok16
parallel_sum__grouped_kv_mqa__mixer_token_mlp__prompt_kernel_os17:
    s_mov_b32 s23, 17
    s_add_u32 s20, s22, 2228224
    s_add_u32 s62, s62, 1
    s_cmp_ge_u32 s62, 0x4000
    s_cbranch_scc1 parallel_sum__grouped_kv_mqa__mixer_token_mlp__prompt_kernel_ok17
    s_sleep 8
    s_branch parallel_sum__grouped_kv_mqa__mixer_token_mlp__prompt_kernel_ol17
parallel_sum__grouped_kv_mqa__mixer_token_mlp__prompt_kernel_oc17:
    s_waitcnt vmcnt(0)
    v_max3_u32 v2, v112, v113, v114
    v_max_u32 v2, v2, v115
    v_cmp_eq_u32 vcc, -1, v2
    s_nop 4
    s_cbranch_vccnz parallel_sum__grouped_kv_mqa__mixer_token_mlp__prompt_kernel_os17
    s_branch parallel_sum__grouped_kv_mqa__mixer_token_mlp__prompt_kernel_ok17
parallel_sum__grouped_kv_mqa__mixer_token_mlp__prompt_kernel_os18:
    s_mov_b32 s23, 18
    s_add_u32 s20, s22, 2359296
    s_add_u32 s62, s62, 1
    s_cmp_ge_u32 s62, 0x4000
    s_cbranch_scc1 parallel_sum__grouped_kv_mqa__mixer_token_mlp__prompt_kernel_ok18
    s_sleep 8
    s_branch parallel_sum__grouped_kv_mqa__mixer_token_mlp__prompt_kernel_ol18
parallel_sum__grouped_kv_mqa__mixer_token_mlp__prompt_kernel_oc18:
    s_waitcnt vmcnt(0)
    v_max3_u32 v2, v116, v117, v118
    v_max_u32 v2, v2, v119
    v_cmp_eq_u32 vcc, -1, v2
    s_nop 4
    s_cbranch_vccnz parallel_sum__grouped_kv_mqa__mixer_token_mlp__prompt_kernel_os18
    s_branch parallel_sum__grouped_kv_mqa__mixer_token_mlp__prompt_kernel_ok18
parallel_sum__grouped_kv_mqa__mixer_token_mlp__prompt_kernel_os19:
    s_mov_b32 s23, 19
    s_add_u32 s20, s22, 2490368
    s_add_u32 s62, s62, 1
    s_cmp_ge_u32 s62, 0x4000
    s_cbranch_scc1 parallel_sum__grouped_kv_mqa__mixer_token_mlp__prompt_kernel_ok19
    s_sleep 8
    s_branch parallel_sum__grouped_kv_mqa__mixer_token_mlp__prompt_kernel_ol19
parallel_sum__grouped_kv_mqa__mixer_token_mlp__prompt_kernel_oc19:
    s_waitcnt vmcnt(0)
    v_max3_u32 v2, v120, v121, v122
    v_max_u32 v2, v2, v123
    v_cmp_eq_u32 vcc, -1, v2
    s_nop 4
    s_cbranch_vccnz parallel_sum__grouped_kv_mqa__mixer_token_mlp__prompt_kernel_os19
    s_branch parallel_sum__grouped_kv_mqa__mixer_token_mlp__prompt_kernel_ok19
parallel_sum__grouped_kv_mqa__mixer_token_mlp__prompt_kernel_ol0:
    buffer_load_dwordx4 v[92:95], v1, s[8:11], s20 offen sc1
    s_add_u32 s20, s20, 131072
parallel_sum__grouped_kv_mqa__mixer_token_mlp__prompt_kernel_ol1:
    buffer_load_dwordx4 v[96:99], v1, s[8:11], s20 offen sc1
    s_add_u32 s20, s20, 131072
parallel_sum__grouped_kv_mqa__mixer_token_mlp__prompt_kernel_ol2:
    buffer_load_dwordx4 v[100:103], v1, s[8:11], s20 offen sc1
    s_add_u32 s20, s20, 131072
parallel_sum__grouped_kv_mqa__mixer_token_mlp__prompt_kernel_ol3:
    buffer_load_dwordx4 v[104:107], v1, s[8:11], s20 offen sc1
    s_add_u32 s20, s20, 131072
parallel_sum__grouped_kv_mqa__mixer_token_mlp__prompt_kernel_ol4:
    buffer_load_dwordx4 v[108:111], v1, s[8:11], s20 offen sc1
    s_add_u32 s20, s20, 131072
parallel_sum__grouped_kv_mqa__mixer_token_mlp__prompt_kernel_ol5:
    buffer_load_dwordx4 v[124:127], v1, s[8:11], s20 offen sc1
    s_add_u32 s20, s20, 131072
parallel_sum__grouped_kv_mqa__mixer_token_mlp__prompt_kernel_ol6:
    buffer_load_dwordx4 v[128:131], v1, s[8:11], s20 offen sc1
    s_add_u32 s20, s20, 131072
parallel_sum__grouped_kv_mqa__mixer_token_mlp__prompt_kernel_ol7:
    buffer_load_dwordx4 v[132:135], v1, s[8:11], s20 offen sc1
    s_add_u32 s20, s20, 131072
parallel_sum__grouped_kv_mqa__mixer_token_mlp__prompt_kernel_ol8:
    buffer_load_dwordx4 v[136:139], v1, s[8:11], s20 offen sc1
    s_add_u32 s20, s20, 131072
parallel_sum__grouped_kv_mqa__mixer_token_mlp__prompt_kernel_ol9:
    buffer_load_dwordx4 v[140:143], v1, s[8:11], s20 offen sc1
    s_add_u32 s20, s20, 131072
parallel_sum__grouped_kv_mqa__mixer_token_mlp__prompt_kernel_ol10:
    buffer_load_dwordx4 v[144:147], v1, s[8:11], s20 offen sc1
    s_add_u32 s20, s20, 131072
parallel_sum__grouped_kv_mqa__mixer_token_mlp__prompt_kernel_ol11:
    buffer_load_dwordx4 v[148:151], v1, s[8:11], s20 offen sc1
    s_add_u32 s20, s20, 131072
parallel_sum__grouped_kv_mqa__mixer_token_mlp__prompt_kernel_ol12:
    buffer_load_dwordx4 v[152:155], v1, s[8:11], s20 offen sc1
    s_add_u32 s20, s20, 131072
parallel_sum__grouped_kv_mqa__mixer_token_mlp__prompt_kernel_ol13:
    buffer_load_dwordx4 v[156:159], v1, s[8:11], s20 offen sc1
    s_add_u32 s20, s20, 131072
parallel_sum__grouped_kv_mqa__mixer_token_mlp__prompt_kernel_ol14:
    buffer_load_dwordx4 v[160:163], v1, s[8:11], s20 offen sc1
    s_add_u32 s20, s20, 131072
parallel_sum__grouped_kv_mqa__mixer_token_mlp__prompt_kernel_ol15:
    buffer_load_dwordx4 v[164:167], v1, s[8:11], s20 offen sc1
    s_add_u32 s20, s20, 131072
parallel_sum__grouped_kv_mqa__mixer_token_mlp__prompt_kernel_ol16:
    buffer_load_dwordx4 v[8:11], v1, s[8:11], s20 offen sc1
    s_add_u32 s20, s20, 131072
parallel_sum__grouped_kv_mqa__mixer_token_mlp__prompt_kernel_ol17:
    buffer_load_dwordx4 v[112:115], v1, s[8:11], s20 offen sc1
    s_add_u32 s20, s20, 131072
parallel_sum__grouped_kv_mqa__mixer_token_mlp__prompt_kernel_ol18:
    buffer_load_dwordx4 v[116:119], v1, s[8:11], s20 offen sc1
    s_add_u32 s20, s20, 131072
parallel_sum__grouped_kv_mqa__mixer_token_mlp__prompt_kernel_ol19:
    buffer_load_dwordx4 v[120:123], v1, s[8:11], s20 offen sc1
    s_add_u32 s20, s20, 131072
    s_cmp_eq_u32 s23, 0
    s_cbranch_scc1 parallel_sum__grouped_kv_mqa__mixer_token_mlp__prompt_kernel_oc0
    s_cmp_eq_u32 s23, 1
    s_cbranch_scc1 parallel_sum__grouped_kv_mqa__mixer_token_mlp__prompt_kernel_oc1
    s_cmp_eq_u32 s23, 2
    s_cbranch_scc1 parallel_sum__grouped_kv_mqa__mixer_token_mlp__prompt_kernel_oc2
    s_cmp_eq_u32 s23, 3
    s_cbranch_scc1 parallel_sum__grouped_kv_mqa__mixer_token_mlp__prompt_kernel_oc3
    s_cmp_eq_u32 s23, 4
    s_cbranch_scc1 parallel_sum__grouped_kv_mqa__mixer_token_mlp__prompt_kernel_oc4
    s_cmp_eq_u32 s23, 5
    s_cbranch_scc1 parallel_sum__grouped_kv_mqa__mixer_token_mlp__prompt_kernel_oc5
    s_cmp_eq_u32 s23, 6
    s_cbranch_scc1 parallel_sum__grouped_kv_mqa__mixer_token_mlp__prompt_kernel_oc6
    s_cmp_eq_u32 s23, 7
    s_cbranch_scc1 parallel_sum__grouped_kv_mqa__mixer_token_mlp__prompt_kernel_oc7
    s_cmp_eq_u32 s23, 8
    s_cbranch_scc1 parallel_sum__grouped_kv_mqa__mixer_token_mlp__prompt_kernel_oc8
    s_cmp_eq_u32 s23, 9
    s_cbranch_scc1 parallel_sum__grouped_kv_mqa__mixer_token_mlp__prompt_kernel_oc9
    s_cmp_eq_u32 s23, 10
    s_cbranch_scc1 parallel_sum__grouped_kv_mqa__mixer_token_mlp__prompt_kernel_oc10
    s_cmp_eq_u32 s23, 11
    s_cbranch_scc1 parallel_sum__grouped_kv_mqa__mixer_token_mlp__prompt_kernel_oc11
    s_cmp_eq_u32 s23, 12
    s_cbranch_scc1 parallel_sum__grouped_kv_mqa__mixer_token_mlp__prompt_kernel_oc12
    s_cmp_eq_u32 s23, 13
    s_cbranch_scc1 parallel_sum__grouped_kv_mqa__mixer_token_mlp__prompt_kernel_oc13
    s_cmp_eq_u32 s23, 14
    s_cbranch_scc1 parallel_sum__grouped_kv_mqa__mixer_token_mlp__prompt_kernel_oc14
    s_cmp_eq_u32 s23, 15
    s_cbranch_scc1 parallel_sum__grouped_kv_mqa__mixer_token_mlp__prompt_kernel_oc15
    s_cmp_eq_u32 s23, 16
    s_cbranch_scc1 parallel_sum__grouped_kv_mqa__mixer_token_mlp__prompt_kernel_oc16
    s_cmp_eq_u32 s23, 17
    s_cbranch_scc1 parallel_sum__grouped_kv_mqa__mixer_token_mlp__prompt_kernel_oc17
    s_cmp_eq_u32 s23, 18
    s_cbranch_scc1 parallel_sum__grouped_kv_mqa__mixer_token_mlp__prompt_kernel_oc18
    s_branch parallel_sum__grouped_kv_mqa__mixer_token_mlp__prompt_kernel_oc19
code_end:
    s_endpgm
.section .rodata,"a"
.p2align 6
.amdhsa_kernel parallel_sum__grouped_kv_mqa__mixer_token_mlp__prompt_kernel
  .amdhsa_next_free_vgpr 168
  .amdhsa_next_free_sgpr 102
  .amdhsa_accum_offset 168
  .amdhsa_group_segment_fixed_size 0
  .amdhsa_kernarg_size 104
  .amdhsa_user_sgpr_count 2
  .amdhsa_user_sgpr_kernarg_segment_ptr 1
  .amdhsa_system_sgpr_workgroup_id_x 1
  .amdhsa_float_denorm_mode_32 3
.end_amdhsa_kernel
```
